```python
import torch

def _softmax(x, axis=-1):
    return torch.softmax(x, dim=axis)

def _gelu(x):
    return torch.nn.functional.gelu(x, approximate='tanh')

def _silu(x):
    return torch.nn.functional.silu(x)

def _sigmoid(x):
    return torch.sigmoid(x)

def _layernorm(x, axis=-1, eps=1e-05):
    m = x.mean(dim=axis, keepdim=True)
    v = x.var(dim=axis, keepdim=True, unbiased=False)
    return (x - m) / torch.sqrt(v + eps)

def _scatter_add(tgt, idx, src, axis=0):
    return tgt.clone().index_add_(axis, idx, src)

def _segment_sum(src, seg, n):
    out = torch.zeros((n,) + src.shape[1:], dtype=src.dtype)
    return out.index_add_(0, seg, src)

def _pad(x, pw):
    flat = tuple((v for pair in reversed(pw) for v in pair))
    return torch.nn.functional.pad(x, flat)
kernel_name = 'standalone__autoregressive_conv_wavernn__speech'

def setup_inputs():

    _w = lambda a: (lambda t: t.to(torch.bfloat16) if t.is_floating_point() else t)(torch.as_tensor(a))
    B, T, D, K = (2, 16000, 256, 5)
    return {'x': _w((lambda *s: torch.randn(*s, dtype=torch.bfloat16) * 0.1)(B, T, D)), 'w': _w((lambda *s: torch.randn(*s, dtype=torch.bfloat16) * 0.1)(K, D, 2 * D))}

def reference(x, w):
    B, T, D = x.shape
    K = w.shape[0]
    dil = 2
    pad = (K - 1) * dil
    xp = _pad(x, ((0, 0), (pad, 0), (0, 0)))
    h = torch.einsum('btd,de->bte', xp[:, 0:T, :], w[0])
    for i in range(1, K):
        h = h + torch.einsum('btd,de->bte', xp[:, i * dil:i * dil + T, :], w[i])
    f, g = (h[..., :D].clone(), h[..., D:].clone())
    return torch.tanh(f) * _sigmoid(g)
```

```asm
; @launch grid=(256,1,1) block=(256,1,1) lds=163840
.amdgcn_target "amdgcn-amd-amdhsa--gfx950"
.text
.globl standalone__autoregressive_conv_wavernn__speech_kernel
.p2align 8
.type standalone__autoregressive_conv_wavernn__speech_kernel,@function
standalone__autoregressive_conv_wavernn__speech_kernel:
s_cmp_ge_u32 s2, 256
s_cbranch_scc1 L_end
s_load_dwordx4 s[4:7], s[0:1], 0
s_getpc_b64 s[64:65]
L_pc:
s_mov_b32 s66, 4096
s_mov_b32 s67, 0x20000
v_lshlrev_b32 v246, 7, v0
buffer_load_dword v250, v246, s[64:67], 0 offen
s_lshr_b32 s33, s2, 3
s_and_b32 s32, s2, 7
s_lshl_b32 s32, s32, 4
s_lshr_b32 s3, s2, 4
s_add_u32 s32, s32, s3
s_and_b32 s30, s32, 63
s_mulk_i32 s30, 250
v_lshrrev_b32 v240, 4, v0
v_xor_b32 v242, v0, v240
v_and_b32 v241, 14, v240
v_bfe_u32 v243, v242, 3, 1
v_or_b32 v241, v241, v243
v_and_b32 v240, 1, v240
v_lshl_add_u32 v243, v241, 4, v240
v_add_lshl_u32 v243, v243, s30, 9
v_and_b32 v242, 4, v242
v_and_or_b32 v242, v0, 3, v242
v_lshl_add_u32 v2, v242, 4, v243
s_movk_i32 s36, 0x1000
v_bfrev_b32 v244, 1
v_subrev_u32 v1, s36, v2
v_cmp_gt_u32 vcc, s36, v2
s_lshr_b32 s3, s32, 6
s_mul_i32 s3, s3, 8192000
v_add_u32 v11, s36, v2
v_cndmask_b32 v1, v1, v244, vcc
v_cmp_eq_u32 vcc, 15, v241
s_mov_b32 s10, 8192000
s_mov_b32 s11, 0x20000
v_cndmask_b32 v182, v11, v244, vcc
s_waitcnt lgkmcnt(0)
s_add_u32 s8, s4, s3
s_addc_u32 s9, s5, 0
buffer_load_dwordx4 v[12:15], v1, s[8:11], 0 offen offset:1024
buffer_load_dwordx4 v[16:19], v1, s[8:11], 0 offen offset:3072
buffer_load_dwordx4 v[20:23], v2, s[8:11], 0 offen offset:1024
buffer_load_dwordx4 v[24:27], v2, s[8:11], 0 offen offset:3072
buffer_load_dwordx4 v[28:31], v182, s[8:11], 0 offen offset:1024
s_load_dwordx4 s[52:55], s[0:1], 16
s_load_dwordx2 s[16:17], s[0:1], 32
v_readfirstlane_b32 s28, v0
v_mov_b32 v247, v0
v_and_b32 v0, 63, v0
s_mov_b32 s12, s6
s_mov_b32 s13, s7
s_mov_b32 s14, 1310720
s_mov_b32 s15, 0x20000
s_lshr_b32 s28, s28, 6
s_and_b32 s29, s33, 1
v_lshrrev_b32 v245, 2, v0
v_and_b32 v246, 3, v0
v_lshlrev_b32 v245, 10, v245
v_lshl_add_u32 v245, v246, 4, v245
s_and_b32 s56, s32, 7
s_lshr_b32 s57, s32, 3
s_and_b32 s58, s57, 1
s_lshr_b32 s59, s57, 1
s_lshl_b32 s60, s58, 9
s_lshl_b32 s61, s59, 6
s_add_u32 s60, s60, s61
s_lshl_b32 s61, s56, 15
s_add_u32 s60, s60, s61
s_lshr_b32 s61, s28, 1
s_lshl_b32 s61, s61, 18
s_and_b32 s62, s28, 1
s_lshl_b32 s63, s62, 14
s_add_u32 s61, s61, s63
v_add_u32 v180, s60, v245
s_min_u32 s62, s28, 1
s_lshl_b32 s42, s28, 10
s_add_u32 m0, s42, 32768
s_add_u32 s63, s61, 0
buffer_load_dwordx4 v180, s[12:15], s63 offen lds
s_add_u32 m0, s42, 36864
s_add_u32 s63, s61, 524288
buffer_load_dwordx4 v180, s[12:15], s63 offen lds
s_lshl_b32 s63, s62, 10
s_add_u32 m0, s63, 40960
s_lshl_b32 s63, s62, 14
s_add_u32 s63, s63, 1048576
buffer_load_dwordx4 v180, s[12:15], s63 offen lds
s_lshl_b32 s61, s29, 8
s_lshl_b32 s62, s28, 6
s_add_u32 s51, s61, s62
v_add_u32 v234, s51, v245
s_lshl_b32 s31, s28, 13
s_add_u32 s31, s31, 0x10000
s_mov_b32 s34, 524288
s_add_u32 m0, s31, 32768
s_nop 0
buffer_load_dwordx4 v234, s[12:15], s34 offen offset:0 lds
s_mov_b32 s34, 540672
s_add_u32 m0, s31, 33792
s_nop 0
buffer_load_dwordx4 v234, s[12:15], s34 offen offset:0 lds
s_mov_b32 s34, 1048576
s_add_u32 m0, s31, 36864
s_nop 0
buffer_load_dwordx4 v234, s[12:15], s34 offen offset:0 lds
s_mov_b32 s34, 1064960
s_add_u32 m0, s31, 37888
s_nop 0
buffer_load_dwordx4 v234, s[12:15], s34 offen offset:0 lds
s_mov_b32 s34, 524288
s_add_u32 m0, s31, 34304
s_nop 0
buffer_load_dwordx4 v234, s[12:15], s34 offen offset:512 lds
s_mov_b32 s34, 540672
s_add_u32 m0, s31, 35328
s_nop 0
buffer_load_dwordx4 v234, s[12:15], s34 offen offset:512 lds
s_mov_b32 s34, 1048576
s_add_u32 m0, s31, 38400
s_nop 0
buffer_load_dwordx4 v234, s[12:15], s34 offen offset:512 lds
s_mov_b32 s34, 1064960
s_add_u32 m0, s31, 39424
s_nop 0
buffer_load_dwordx4 v234, s[12:15], s34 offen offset:512 lds
s_lshl_b32 s6, s28, 12
s_add_u32 s7, s6, 53244
v_lshl_add_u32 v235, v0, 2, s6
s_waitcnt lgkmcnt(0)
s_add_u32 s20, s52, s3
s_addc_u32 s21, s53, 0
s_mov_b32 s22, 8192000
s_mov_b32 s23, 0x20000
s_mov_b32 s24, s54
s_mov_b32 s25, s55
s_mov_b32 s26, 256
s_mov_b32 s27, 0x20000
s_add_u32 s16, s16, 1048576
s_addc_u32 s17, s17, 0
s_mov_b32 s18, 1310720
s_mov_b32 s19, 0x20000
s_mov_b32 s39, 0xffff0000
v_and_b32 v240, 15, v0
v_lshrrev_b32 v241, 4, v0
v_and_b32 v243, 1, v0
v_lshlrev_b32 v243, 6, v243
v_lshl_add_u32 v243, v241, 8, v243
v_lshrrev_b32 v242, 1, v240
s_movk_i32 s60, 0x1010
v_and_b32 v246, 1, v242
v_lshl_add_u32 v246, v246, 7, v243
v_bfe_u32 v3, v242, 1, 2
v_mad_u32_u24 v3, v3, s60, v246
v_add_u32 v242, 1, v242
v_and_b32 v246, 1, v242
v_lshl_add_u32 v246, v246, 7, v243
v_bfe_u32 v7, v242, 1, 2
v_mad_u32_u24 v7, v7, s60, v246
v_lshrrev_b32 v246, 3, v242
v_lshl_add_u32 v7, v246, 14, v7
v_xor_b32 v4, 16, v3
v_xor_b32 v5, 32, v3
v_xor_b32 v6, 48, v3
v_xor_b32 v8, 16, v7
v_bfe_u32 v242, v0, 3, 1
v_lshl_add_u32 v242, v242, 2, v241
v_bfe_u32 v246, v0, 2, 1
v_lshl_add_u32 v242, v242, 1, v246
v_and_b32 v243, 3, v0
v_lshlrev_b32 v243, 4, v243
v_lshl_add_u32 v242, v242, 6, v243
v_add_u32 v232, s31, v242
v_add_u32 v233, 0x10000, v232
s_lshl_b32 s60, s29, 3
s_add_u32 s60, s60, 0x8000
v_add_u32 v242, s60, v242
s_cmp_ge_u32 s28, 2
s_cselect_b32 s61, s28, -1
s_add_u32 s61, s61, 1
s_sub_u32 s62, 7, s61
s_cmp_ge_u32 s28, 2
s_cselect_b32 s62, s62, 1
s_cselect_b32 s63, s62, 2
v_lshl_add_u32 v175, s61, 11, v242
v_lshl_add_u32 v176, s62, 11, v242
v_lshl_add_u32 v177, s63, 11, v242
s_and_b32 s61, s28, 1
s_lshl_b32 s62, s61, 31
s_or_b32 s40, s62, 0x3f800000
s_cmp_ge_u32 s28, 2
s_cselect_b32 s4, 0, s40
s_mov_b32 s41, s40
s_mov_b32 s5, s4
s_lshl_b32 s62, s29, 2
s_add_u32 s62, s62, s28
s_mul_i32 s62, s62, 163840
v_lshlrev_b32 v243, 4, v0
v_add_u32 v9, s62, v243
s_mul_i32 s62, s59, 163840
s_lshl_b32 s63, s58, 1
s_add_u32 s63, s63, s29
s_lshl_b32 s63, s63, 10
s_add_u32 s62, s62, s63
s_lshl_b32 s63, s56, 1
s_add_u32 s63, s63, 1
s_sub_u32 s63, s63, s61
s_lshl_b32 s63, s63, 13
s_lshr_b32 s61, s28, 1
s_lshl_b32 s61, s61, 12
s_add_u32 s63, s63, s61
s_add_u32 s63, s63, s62
v_add_u32 v178, s63, v243
s_lshl_b32 s63, s56, 12
s_add_u32 s63, s63, 131072
s_add_u32 s63, s63, s62
s_cmp_eq_u32 s28, 0
s_cselect_b32 s63, s63, 0x80000000
v_add_u32 v179, s63, v243
s_lshl_b32 s61, s33, 3
s_lshl_b32 s62, s28, 1
s_add_u32 s61, s61, s62
v_add_u32 v10, s61, v0
v_cmp_gt_u32 vcc, 2, v0
v_lshlrev_b32 v10, 7, v10
s_mov_b32 s66, L_end-L_pc
v_cndmask_b32 v10, v244, v10, vcc
s_movk_i32 s60, 4096
buffer_load_dword v253, v10, s[64:67], s60 offen
buffer_load_dwordx4 v[32:35], v1, s[8:11], 0 offen offset:1152
buffer_load_dwordx4 v[36:39], v1, s[8:11], 0 offen offset:3200
buffer_load_dwordx4 v[40:43], v2, s[8:11], 0 offen offset:1152
buffer_load_dwordx4 v[44:47], v2, s[8:11], 0 offen offset:3200
buffer_load_dwordx4 v[168:171], v182, s[8:11], 0 offen offset:1152
s_waitcnt vmcnt(14)
s_barrier
ds_read_b64_tr_b16 v[184:185], v175 offset:0
ds_read_b64_tr_b16 v[186:187], v175 offset:1024
ds_read_b64_tr_b16 v[188:189], v176 offset:0
ds_read_b64_tr_b16 v[190:191], v176 offset:1024
ds_read_b64_tr_b16 v[192:193], v177 offset:0
ds_read_b64_tr_b16 v[194:195], v177 offset:1024
s_waitcnt lgkmcnt(5)
v_lshlrev_b32 v48, 16, v184
v_and_b32 v49, s39, v184
v_lshlrev_b32 v50, 16, v185
v_and_b32 v51, s39, v185
s_waitcnt lgkmcnt(4)
v_lshlrev_b32 v52, 16, v186
v_and_b32 v53, s39, v186
v_lshlrev_b32 v54, 16, v187
v_and_b32 v55, s39, v187
buffer_store_dwordx4 v[184:187], v179, s[16:19], 0 offen sc1
s_waitcnt lgkmcnt(3)
v_lshlrev_b32 v56, 16, v188
v_and_b32 v57, s39, v188
v_lshlrev_b32 v58, 16, v189
v_and_b32 v59, s39, v189
s_waitcnt lgkmcnt(2)
v_lshlrev_b32 v60, 16, v190
v_and_b32 v61, s39, v190
v_lshlrev_b32 v62, 16, v191
v_and_b32 v63, s39, v191
s_waitcnt lgkmcnt(1)
v_lshlrev_b32 v200, 16, v192
v_and_b32 v201, s39, v192
v_lshlrev_b32 v202, 16, v193
v_and_b32 v203, s39, v193
s_waitcnt lgkmcnt(0)
v_lshlrev_b32 v204, 16, v194
v_and_b32 v205, s39, v194
v_lshlrev_b32 v206, 16, v195
v_and_b32 v207, s39, v195
v_pk_fma_f32 v[48:49], v[48:49], s[40:41], v[56:57]
v_pk_fma_f32 v[50:51], v[50:51], s[40:41], v[58:59]
v_pk_fma_f32 v[52:53], v[52:53], s[40:41], v[60:61]
v_pk_fma_f32 v[54:55], v[54:55], s[40:41], v[62:63]
v_pk_fma_f32 v[48:49], v[200:201], s[4:5], v[48:49]
v_pk_fma_f32 v[50:51], v[202:203], s[4:5], v[50:51]
v_pk_fma_f32 v[52:53], v[204:205], s[4:5], v[52:53]
v_pk_fma_f32 v[54:55], v[206:207], s[4:5], v[54:55]
v_cvt_pk_bf16_f32 v196, v48, v49
v_cvt_pk_bf16_f32 v197, v50, v51
v_cvt_pk_bf16_f32 v198, v52, v53
v_cvt_pk_bf16_f32 v199, v54, v55
buffer_store_dwordx4 v[196:199], v178, s[16:19], 0 offen sc1
v_lshlrev_b32 v48, 16, v12
v_and_b32 v49, s39, v12
v_lshlrev_b32 v50, 16, v13
v_and_b32 v51, s39, v13
v_lshlrev_b32 v52, 16, v14
v_and_b32 v53, s39, v14
v_lshlrev_b32 v54, 16, v15
v_and_b32 v55, s39, v15
s_mov_b32 m0, s6
v_lshlrev_b32 v56, 16, v16
v_and_b32 v57, s39, v16
v_lshlrev_b32 v58, 16, v17
v_and_b32 v59, s39, v17
v_lshlrev_b32 v60, 16, v18
v_and_b32 v61, s39, v18
v_lshlrev_b32 v62, 16, v19
v_and_b32_e64 v63, s39, v19
v_pk_add_f32 v[200:201], v[56:57], v[48:49] neg_lo:[0,1] neg_hi:[0,1]
v_pk_add_f32 v[202:203], v[58:59], v[50:51] neg_lo:[0,1] neg_hi:[0,1]
v_pk_add_f32 v[204:205], v[60:61], v[52:53] neg_lo:[0,1] neg_hi:[0,1]
v_pk_add_f32 v[206:207], v[62:63], v[54:55] neg_lo:[0,1] neg_hi:[0,1]
v_cvt_pk_bf16_f32 v69, v200, v201
v_cvt_pk_bf16_f32 v70, v202, v203
v_cvt_pk_bf16_f32 v71, v204, v205
v_cvt_pk_bf16_f32 v72, v206, v207
ds_write_addtid_b32 v69 offset:0
ds_write_addtid_b32 v70 offset:256
ds_write_addtid_b32 v71 offset:512
ds_write_addtid_b32 v72 offset:768
v_lshlrev_b32 v48, 16, v20
v_and_b32 v49, s39, v20
v_lshlrev_b32 v50, 16, v21
v_and_b32 v51, s39, v21
v_lshlrev_b32 v52, 16, v22
v_and_b32 v53, s39, v22
v_lshlrev_b32 v54, 16, v23
v_and_b32 v55, s39, v23
v_pk_add_f32 v[200:201], v[48:49], v[56:57] neg_lo:[0,1] neg_hi:[0,1]
v_pk_add_f32 v[202:203], v[50:51], v[58:59] neg_lo:[0,1] neg_hi:[0,1]
v_pk_add_f32 v[204:205], v[52:53], v[60:61] neg_lo:[0,1] neg_hi:[0,1]
v_pk_add_f32 v[206:207], v[54:55], v[62:63] neg_lo:[0,1] neg_hi:[0,1]
v_cvt_pk_bf16_f32 v73, v200, v201
v_cvt_pk_bf16_f32 v74, v202, v203
v_cvt_pk_bf16_f32 v75, v204, v205
v_cvt_pk_bf16_f32 v68, v206, v207
ds_write_addtid_b32 v73 offset:1024
ds_write_addtid_b32 v74 offset:1280
ds_write_addtid_b32 v75 offset:1536
ds_write_addtid_b32 v68 offset:1792
v_lshlrev_b32 v56, 16, v24
v_and_b32 v57, s39, v24
v_lshlrev_b32 v58, 16, v25
v_and_b32 v59, s39, v25
v_lshlrev_b32 v60, 16, v26
v_and_b32 v61, s39, v26
v_lshlrev_b32 v62, 16, v27
v_and_b32 v63, s39, v27
v_pk_add_f32 v[200:201], v[56:57], v[48:49] neg_lo:[0,1] neg_hi:[0,1]
v_pk_add_f32 v[202:203], v[58:59], v[50:51] neg_lo:[0,1] neg_hi:[0,1]
v_pk_add_f32 v[204:205], v[60:61], v[52:53] neg_lo:[0,1] neg_hi:[0,1]
v_pk_add_f32 v[206:207], v[62:63], v[54:55] neg_lo:[0,1] neg_hi:[0,1]
v_cvt_pk_bf16_f32 v69, v200, v201
v_cvt_pk_bf16_f32 v70, v202, v203
v_cvt_pk_bf16_f32 v71, v204, v205
v_cvt_pk_bf16_f32 v72, v206, v207
ds_write_addtid_b32 v69 offset:2048
ds_write_addtid_b32 v70 offset:2304
ds_write_addtid_b32 v71 offset:2560
ds_write_addtid_b32 v72 offset:2816
v_lshlrev_b32 v48, 16, v28
v_and_b32 v49, s39, v28
v_lshlrev_b32 v50, 16, v29
v_and_b32 v51, s39, v29
v_lshlrev_b32 v52, 16, v30
v_and_b32 v53, s39, v30
v_lshlrev_b32 v54, 16, v31
v_and_b32 v55, s39, v31
v_pk_add_f32 v[200:201], v[48:49], v[56:57] neg_lo:[0,1] neg_hi:[0,1]
v_pk_add_f32 v[202:203], v[50:51], v[58:59] neg_lo:[0,1] neg_hi:[0,1]
v_pk_add_f32 v[204:205], v[52:53], v[60:61] neg_lo:[0,1] neg_hi:[0,1]
v_pk_add_f32 v[206:207], v[54:55], v[62:63] neg_lo:[0,1] neg_hi:[0,1]
v_cvt_pk_bf16_f32 v73, v200, v201
v_cvt_pk_bf16_f32 v74, v202, v203
v_cvt_pk_bf16_f32 v75, v204, v205
v_cvt_pk_bf16_f32 v68, v206, v207
ds_write_addtid_b32 v73 offset:3072
ds_write_addtid_b32 v74 offset:3328
ds_write_addtid_b32 v75 offset:3584
ds_write_addtid_b32 v68 offset:3840
s_mov_b32 s34, 557056
s_add_u32 m0, s31, 65536
s_nop 0
buffer_load_dwordx4 v234, s[12:15], s34 offen offset:0 lds
s_mov_b32 s34, 573440
s_add_u32 m0, s31, 66560
s_nop 0
buffer_load_dwordx4 v234, s[12:15], s34 offen offset:0 lds
s_mov_b32 s34, 1081344
s_add_u32 m0, s31, 69632
s_nop 0
buffer_load_dwordx4 v234, s[12:15], s34 offen offset:0 lds
s_mov_b32 s34, 1097728
s_add_u32 m0, s31, 70656
s_nop 0
buffer_load_dwordx4 v234, s[12:15], s34 offen offset:0 lds
s_mov_b32 s34, 557056
s_add_u32 m0, s31, 67072
s_nop 0
buffer_load_dwordx4 v234, s[12:15], s34 offen offset:512 lds
s_mov_b32 s34, 573440
s_add_u32 m0, s31, 68096
s_nop 0
buffer_load_dwordx4 v234, s[12:15], s34 offen offset:512 lds
s_mov_b32 s34, 1081344
s_add_u32 m0, s31, 71168
s_nop 0
buffer_load_dwordx4 v234, s[12:15], s34 offen offset:512 lds
s_mov_b32 s34, 1097728
s_add_u32 m0, s31, 72192
s_nop 0
buffer_load_dwordx4 v234, s[12:15], s34 offen offset:512 lds
s_waitcnt vmcnt(22)
ds_read_b64_tr_b16 a[128:129], v232 offset:32768
ds_read_b64_tr_b16 a[130:131], v232 offset:33792
s_waitcnt vmcnt(20)
ds_read_b64_tr_b16 a[144:145], v232 offset:36864
ds_read_b64_tr_b16 a[146:147], v232 offset:37888
ds_read_b64_tr_b16 a[132:133], v232 offset:32776
ds_read_b64_tr_b16 a[134:135], v232 offset:33800
ds_read_b64_tr_b16 a[148:149], v232 offset:36872
ds_read_b64_tr_b16 a[150:151], v232 offset:37896
s_waitcnt vmcnt(18)
ds_read_b64_tr_b16 a[136:137], v232 offset:34816
ds_read_b64_tr_b16 a[138:139], v232 offset:35840
s_waitcnt vmcnt(16)
ds_read_b64_tr_b16 a[152:153], v232 offset:38912
ds_read_b64_tr_b16 a[154:155], v232 offset:39936
ds_read_b64_tr_b16 a[140:141], v232 offset:34824
ds_read_b64_tr_b16 a[142:143], v232 offset:35848
ds_read_b64_tr_b16 a[156:157], v232 offset:38920
ds_read_b64_tr_b16 a[158:159], v232 offset:39944
s_waitcnt lgkmcnt(15)
s_barrier
ds_read_b128 a[80:83], v3 offset:0
ds_read_b128 a[84:87], v3 offset:1024
ds_read_b128 a[88:91], v3 offset:2048
ds_read_b128 a[92:95], v3 offset:3072
ds_read_b128 a[96:99], v5 offset:0
ds_read_b128 a[100:103], v5 offset:1024
ds_read_b128 a[104:107], v5 offset:2048
ds_read_b128 a[108:111], v5 offset:3072
ds_read_b128 a[112:115], v7 offset:0
s_waitcnt lgkmcnt(8)
v_mfma_f32_16x16x32_bf16 v[80:83], a[128:131], a[80:83], 0
s_waitcnt lgkmcnt(7)
s_lshr_b32 s63, s59, 2
s_lshl_b32 s63, s63, 7
v_mfma_f32_16x16x32_bf16 v[80:83], a[144:147], a[84:87], v[80:83]
v_mov_b32 v183, s63
v_cmp_eq_u32 vcc, 0, v247
v_mfma_f32_16x16x32_bf16 v[88:91], a[128:131], a[84:87], 0
s_waitcnt lgkmcnt(6)
v_mfma_f32_16x16x32_bf16 v[88:91], a[144:147], a[88:91], v[88:91]
v_mfma_f32_16x16x32_bf16 v[96:99], a[128:131], a[88:91], 0
s_waitcnt lgkmcnt(5)
v_mfma_f32_16x16x32_bf16 v[96:99], a[144:147], a[92:95], v[96:99]
v_mfma_f32_16x16x32_bf16 v[104:107], a[128:131], a[92:95], 0
s_waitcnt lgkmcnt(4)
v_mfma_f32_16x16x32_bf16 v[104:107], a[144:147], a[96:99], v[104:107]
v_mfma_f32_16x16x32_bf16 v[112:115], a[128:131], a[96:99], 0
s_waitcnt lgkmcnt(3)
s_mov_b32 s34, 589824
s_add_u32 m0, s31, 0
v_mfma_f32_16x16x32_bf16 v[112:115], a[144:147], a[100:103], v[112:115]
buffer_load_dwordx4 v234, s[12:15], s34 offen offset:0 lds
v_mfma_f32_16x16x32_bf16 v[120:123], a[128:131], a[100:103], 0
s_waitcnt vmcnt(15) lgkmcnt(2)
v_lshlrev_b32 v48, 16, v32
v_and_b32 v49, s39, v32
v_mfma_f32_16x16x32_bf16 v[120:123], a[144:147], a[104:107], v[120:123]
v_mfma_f32_16x16x32_bf16 v[128:131], a[128:131], a[104:107], 0
s_waitcnt lgkmcnt(1)
v_lshlrev_b32 v50, 16, v33
v_and_b32 v51, s39, v33
v_mfma_f32_16x16x32_bf16 v[128:131], a[144:147], a[108:111], v[128:131]
v_mfma_f32_16x16x32_bf16 v[136:139], a[128:131], a[108:111], 0
s_waitcnt lgkmcnt(0)
v_lshlrev_b32 v52, 16, v34
v_and_b32 v53, s39, v34
v_mfma_f32_16x16x32_bf16 v[136:139], a[144:147], a[112:115], v[136:139]
s_mov_b32 s34, 606208
s_add_u32 m0, s31, 1024
v_mfma_f32_16x16x32_bf16 v[84:87], a[132:135], a[80:83], 0
buffer_load_dwordx4 v234, s[12:15], s34 offen offset:0 lds
v_mfma_f32_16x16x32_bf16 v[84:87], a[148:151], a[84:87], v[84:87]
v_lshlrev_b32 v54, 16, v35
v_and_b32 v55, s39, v35
v_mfma_f32_16x16x32_bf16 v[92:95], a[132:135], a[84:87], 0
s_waitcnt vmcnt(15)
v_lshlrev_b32 v56, 16, v36
v_and_b32 v57, s39, v36
v_mfma_f32_16x16x32_bf16 v[92:95], a[148:151], a[88:91], v[92:95]
v_mfma_f32_16x16x32_bf16 v[100:103], a[132:135], a[88:91], 0
v_lshlrev_b32 v58, 16, v37
v_and_b32 v59, s39, v37
v_mfma_f32_16x16x32_bf16 v[100:103], a[148:151], a[92:95], v[100:103]
s_mov_b32 s34, 1114112
s_add_u32 m0, s31, 4096
v_mfma_f32_16x16x32_bf16 v[108:111], a[132:135], a[92:95], 0
buffer_load_dwordx4 v234, s[12:15], s34 offen offset:0 lds
v_mfma_f32_16x16x32_bf16 v[108:111], a[148:151], a[96:99], v[108:111]
v_lshlrev_b32 v60, 16, v38
v_and_b32 v61, s39, v38
v_mfma_f32_16x16x32_bf16 v[116:119], a[132:135], a[96:99], 0
v_lshlrev_b32 v62, 16, v39
v_and_b32 v63, s39, v39
v_mfma_f32_16x16x32_bf16 v[116:119], a[148:151], a[100:103], v[116:119]
v_sub_f32 v66, v56, v48
v_sub_f32 v67, v57, v49
v_mfma_f32_16x16x32_bf16 v[124:127], a[132:135], a[100:103], 0
buffer_load_dwordx4 v[12:15], v1, s[8:11], 0 offen offset:1280
v_mfma_f32_16x16x32_bf16 v[124:127], a[148:151], a[104:107], v[124:127]
v_cvt_pk_bf16_f32 v69, v66, v67
v_sub_f32 v66, v58, v50
v_mfma_f32_16x16x32_bf16 v[132:135], a[132:135], a[104:107], 0
s_mov_b32 s34, 1130496
s_add_u32 m0, s31, 5120
v_mfma_f32_16x16x32_bf16 v[132:135], a[148:151], a[108:111], v[132:135]
s_lshl_b32 s62, s29, 7
v_sub_f32 v67, v59, v51
v_cvt_pk_bf16_f32 v70, v66, v67
v_mfma_f32_16x16x32_bf16 v[140:143], a[132:135], a[108:111], 0
buffer_load_dwordx4 v234, s[12:15], s34 offen offset:0 lds
v_mfma_f32_16x16x32_bf16 v[140:143], a[148:151], a[112:115], v[140:143]
ds_write2st64_b32 v235, v69, v70 offset0:64 offset1:65
v_mfma_f32_16x16x32_bf16 a[0:3], a[136:139], a[80:83], 0
v_mov_b32 v249, s62
v_mov_b32 v248, 1
v_mfma_f32_16x16x32_bf16 a[0:3], a[152:155], a[84:87], a[0:3]
v_sub_f32 v66, v60, v52
v_sub_f32 v67, v61, v53
v_mfma_f32_16x16x32_bf16 a[8:11], a[136:139], a[84:87], 0
s_mov_b32 s34, 589824
s_add_u32 m0, s31, 1536
v_mfma_f32_16x16x32_bf16 a[8:11], a[152:155], a[88:91], a[8:11]
buffer_load_dwordx4 v234, s[12:15], s34 offen offset:512 lds
v_mfma_f32_16x16x32_bf16 a[16:19], a[136:139], a[88:91], 0
v_cvt_pk_bf16_f32 v71, v66, v67
v_sub_f32 v66, v62, v54
v_mfma_f32_16x16x32_bf16 a[16:19], a[152:155], a[92:95], a[16:19]
v_sub_f32 v67, v63, v55
v_cvt_pk_bf16_f32 v72, v66, v67
v_mfma_f32_16x16x32_bf16 a[24:27], a[136:139], a[92:95], 0
ds_write2st64_b32 v235, v71, v72 offset0:66 offset1:67
v_mfma_f32_16x16x32_bf16 a[24:27], a[152:155], a[96:99], a[24:27]
buffer_load_dwordx4 v[16:19], v1, s[8:11], 0 offen offset:3328
v_mfma_f32_16x16x32_bf16 a[32:35], a[136:139], a[96:99], 0
s_waitcnt vmcnt(13)
ds_read_b64_tr_b16 a[160:161], v233 offset:0
ds_read_b64_tr_b16 a[162:163], v233 offset:1024
v_mfma_f32_16x16x32_bf16 a[32:35], a[152:155], a[100:103], a[32:35]
s_mov_b32 s34, 606208
s_add_u32 m0, s31, 2560
v_lshlrev_b32 v48, 16, v40
v_mfma_f32_16x16x32_bf16 v[144:147], a[136:139], a[100:103], 0
v_and_b32 v49, s39, v40
v_lshlrev_b32 v50, 16, v41
v_mfma_f32_16x16x32_bf16 v[144:147], a[152:155], a[104:107], v[144:147]
buffer_load_dwordx4 v234, s[12:15], s34 offen offset:512 lds
v_mfma_f32_16x16x32_bf16 v[152:155], a[136:139], a[104:107], 0
v_and_b32 v51, s39, v41
v_lshlrev_b32 v52, 16, v42
v_mfma_f32_16x16x32_bf16 v[152:155], a[152:155], a[108:111], v[152:155]
v_and_b32 v53, s39, v42
v_lshlrev_b32 v54, 16, v43
v_mfma_f32_16x16x32_bf16 v[160:163], a[136:139], a[108:111], 0
v_mfma_f32_16x16x32_bf16 v[160:163], a[152:155], a[112:115], v[160:163]
s_mov_b32 s34, 1114112
ds_read_b128 a[116:119], v4 offset:0
s_add_u32 m0, s31, 5632
v_mfma_f32_16x16x32_bf16 a[4:7], a[140:143], a[80:83], 0
s_waitcnt vmcnt(12)
ds_read_b128 a[80:83], v4 offset:1024
ds_read_b64_tr_b16 a[176:177], v233 offset:4096
v_mfma_f32_16x16x32_bf16 a[4:7], a[156:159], a[84:87], a[4:7]
buffer_load_dwordx4 v234, s[12:15], s34 offen offset:512 lds
v_mfma_f32_16x16x32_bf16 a[12:15], a[140:143], a[84:87], 0
ds_read_b128 a[84:87], v4 offset:2048
v_and_b32 v55, s39, v43
v_mfma_f32_16x16x32_bf16 a[12:15], a[156:159], a[88:91], a[12:15]
v_sub_f32 v66, v48, v56
v_sub_f32 v67, v49, v57
v_mfma_f32_16x16x32_bf16 a[20:23], a[140:143], a[88:91], 0
ds_read_b128 a[88:91], v4 offset:3072
ds_read_b64_tr_b16 a[178:179], v233 offset:5120
v_mfma_f32_16x16x32_bf16 a[20:23], a[156:159], a[92:95], a[20:23]
buffer_load_dwordx4 v[20:23], v2, s[8:11], 0 offen offset:1280
v_mfma_f32_16x16x32_bf16 a[28:31], a[140:143], a[92:95], 0
s_mov_b32 s34, 1130496
ds_read_b128 a[92:95], v6 offset:0
s_add_u32 m0, s31, 6656
v_mfma_f32_16x16x32_bf16 a[28:31], a[156:159], a[96:99], a[28:31]
ds_read_b64_tr_b16 a[164:165], v233 offset:8
ds_read_b64_tr_b16 a[166:167], v233 offset:1032
v_mfma_f32_16x16x32_bf16 a[36:39], a[140:143], a[96:99], 0
ds_read_b128 a[96:99], v6 offset:1024
v_cvt_pk_bf16_f32 v73, v66, v67
v_mfma_f32_16x16x32_bf16 a[36:39], a[156:159], a[100:103], a[36:39]
buffer_load_dwordx4 v234, s[12:15], s34 offen offset:512 lds
v_mfma_f32_16x16x32_bf16 v[148:151], a[140:143], a[100:103], 0
ds_read_b128 a[100:103], v6 offset:2048
v_sub_f32 v66, v50, v58
v_mfma_f32_16x16x32_bf16 v[148:151], a[156:159], a[104:107], v[148:151]
v_sub_f32 v67, v51, v59
v_cvt_pk_bf16_f32 v74, v66, v67
v_mfma_f32_16x16x32_bf16 v[156:159], a[140:143], a[104:107], 0
s_mov_b32 s34, 622592
ds_read_b128 a[104:107], v6 offset:3072
v_cndmask_b32 v183, v244, v183, vcc
v_mfma_f32_16x16x32_bf16 v[156:159], a[156:159], a[108:111], v[156:159]
s_add_u32 m0, s31, 32768
buffer_load_dwordx4 v[24:27], v2, s[8:11], 0 offen offset:3328
v_mfma_f32_16x16x32_bf16 v[164:167], a[140:143], a[108:111], 0
ds_read_b128 a[108:111], v8 offset:0
v_mfma_f32_16x16x32_bf16 v[164:167], a[156:159], a[112:115], v[164:167]
s_waitcnt lgkmcnt(12)
ds_read_b64_tr_b16 a[180:181], v233 offset:4104
ds_read_b64_tr_b16 a[182:183], v233 offset:5128
v_mfma_f32_16x16x32_bf16 v[80:83], a[160:163], a[116:119], v[80:83]
s_waitcnt lgkmcnt(9)
ds_write2st64_b32 v235, v73, v74 offset0:68 offset1:69
v_mfma_f32_16x16x32_bf16 v[80:83], a[176:179], a[80:83], v[80:83]
buffer_load_dwordx4 v[28:31], v182, s[8:11], 0 offen offset:1280
v_mfma_f32_16x16x32_bf16 v[88:91], a[160:163], a[80:83], v[88:91]
v_sub_f32 v66, v52, v60
v_sub_f32 v67, v53, v61
v_mfma_f32_16x16x32_bf16 v[88:91], a[176:179], a[84:87], v[88:91]
v_cvt_pk_bf16_f32 v75, v66, v67
v_sub_f32 v66, v54, v62
v_mfma_f32_16x16x32_bf16 v[96:99], a[160:163], a[84:87], v[96:99]
v_sub_f32 v67, v55, v63
v_cvt_pk_bf16_f32 v68, v66, v67
v_mfma_f32_16x16x32_bf16 v[96:99], a[176:179], a[88:91], v[96:99]
ds_write2st64_b32 v235, v75, v68 offset0:70 offset1:71
v_mfma_f32_16x16x32_bf16 v[104:107], a[160:163], a[88:91], v[104:107]
s_waitcnt vmcnt(15) lgkmcnt(10)
ds_read_b64_tr_b16 a[168:169], v233 offset:2048
ds_read_b64_tr_b16 a[170:171], v233 offset:3072
v_mfma_f32_16x16x32_bf16 v[104:107], a[176:179], a[92:95], v[104:107]
v_lshlrev_b32 v56, 16, v44
v_and_b32 v57, s39, v44
v_mfma_f32_16x16x32_bf16 v[112:115], a[160:163], a[92:95], v[112:115]
s_waitcnt lgkmcnt(9)
v_lshlrev_b32 v58, 16, v45
v_and_b32 v59, s39, v45
v_mfma_f32_16x16x32_bf16 v[112:115], a[176:179], a[96:99], v[112:115]
s_lshl_b32 s63, s29, 31
v_lshlrev_b32 v60, 16, v46
v_and_b32 v61, s39, v46
v_mfma_f32_16x16x32_bf16 v[120:123], a[160:163], a[96:99], v[120:123]
s_waitcnt lgkmcnt(8)
v_lshlrev_b32 v62, 16, v47
v_and_b32 v63, s39, v47
v_mfma_f32_16x16x32_bf16 v[120:123], a[176:179], a[100:103], v[120:123]
v_sub_f32 v66, v56, v48
v_sub_f32 v67, v57, v49
v_mfma_f32_16x16x32_bf16 v[128:131], a[160:163], a[100:103], v[128:131]
s_waitcnt lgkmcnt(7)
v_cvt_pk_bf16_f32 v69, v66, v67
v_sub_f32 v66, v58, v50
v_mfma_f32_16x16x32_bf16 v[128:131], a[176:179], a[104:107], v[128:131]
v_sub_f32 v67, v59, v51
v_cvt_pk_bf16_f32 v70, v66, v67
v_mfma_f32_16x16x32_bf16 v[136:139], a[160:163], a[104:107], v[136:139]
s_waitcnt vmcnt(13) lgkmcnt(6)
ds_read_b64_tr_b16 a[184:185], v233 offset:6144
ds_read_b64_tr_b16 a[186:187], v233 offset:7168
v_mfma_f32_16x16x32_bf16 v[136:139], a[176:179], a[108:111], v[136:139]
ds_write2st64_b32 v235, v69, v70 offset0:72 offset1:73
v_mfma_f32_16x16x32_bf16 v[84:87], a[164:167], a[116:119], v[84:87]
s_waitcnt lgkmcnt(7)
v_sub_f32 v66, v60, v52
v_sub_f32 v67, v61, v53
v_mfma_f32_16x16x32_bf16 v[84:87], a[180:183], a[80:83], v[84:87]
v_cvt_pk_bf16_f32 v71, v66, v67
v_sub_f32 v66, v62, v54
v_mfma_f32_16x16x32_bf16 v[92:95], a[164:167], a[80:83], v[92:95]
v_sub_f32 v67, v63, v55
v_cvt_pk_bf16_f32 v72, v66, v67
v_mfma_f32_16x16x32_bf16 v[92:95], a[180:183], a[84:87], v[92:95]
ds_write2st64_b32 v235, v71, v72 offset0:74 offset1:75
v_mfma_f32_16x16x32_bf16 v[100:103], a[164:167], a[84:87], v[100:103]
v_or_b32 v239, s63, v183
v_mfma_f32_16x16x32_bf16 v[100:103], a[180:183], a[88:91], v[100:103]
v_lshlrev_b32 v48, 16, v168
v_and_b32 v49, s39, v168
v_mfma_f32_16x16x32_bf16 v[108:111], a[164:167], a[88:91], v[108:111]
s_xor_b32 s62, s63, 0x80000000
ds_read_b64_tr_b16 a[172:173], v233 offset:2056
ds_read_b64_tr_b16 a[174:175], v233 offset:3080
v_mfma_f32_16x16x32_bf16 v[108:111], a[180:183], a[92:95], v[108:111]
v_lshlrev_b32 v50, 16, v169
v_and_b32 v51, s39, v169
v_mfma_f32_16x16x32_bf16 v[116:119], a[164:167], a[92:95], v[116:119]
v_or_b32 v183, s62, v183
v_mfma_f32_16x16x32_bf16 v[116:119], a[180:183], a[96:99], v[116:119]
v_lshlrev_b32 v52, 16, v170
v_and_b32 v53, s39, v170
v_mfma_f32_16x16x32_bf16 v[124:127], a[164:167], a[96:99], v[124:127]
buffer_load_dwordx4 v234, s[12:15], s34 offen offset:0 lds
v_mfma_f32_16x16x32_bf16 v[124:127], a[180:183], a[100:103], v[124:127]
s_mov_b32 s34, 638976
v_lshlrev_b32 v54, 16, v171
v_and_b32 v55, s39, v171
v_mfma_f32_16x16x32_bf16 v[132:135], a[164:167], a[100:103], v[132:135]
s_add_u32 m0, s31, 33792
v_mfma_f32_16x16x32_bf16 v[132:135], a[180:183], a[104:107], v[132:135]
ds_read_b64_tr_b16 a[188:189], v233 offset:6152
ds_read_b64_tr_b16 a[190:191], v233 offset:7176
v_mfma_f32_16x16x32_bf16 v[140:143], a[164:167], a[104:107], v[140:143]
v_sub_f32 v66, v48, v56
v_sub_f32 v67, v49, v57
v_mfma_f32_16x16x32_bf16 v[140:143], a[180:183], a[108:111], v[140:143]
s_waitcnt lgkmcnt(8)
v_cvt_pk_bf16_f32 v73, v66, v67
v_sub_f32 v66, v50, v58
v_mfma_f32_16x16x32_bf16 a[0:3], a[168:171], a[116:119], a[0:3]
s_waitcnt lgkmcnt(6)
v_sub_f32 v67, v51, v59
v_cvt_pk_bf16_f32 v74, v66, v67
v_mfma_f32_16x16x32_bf16 a[0:3], a[184:187], a[80:83], a[0:3]
buffer_load_dwordx4 v234, s[12:15], s34 offen offset:0 lds
v_mfma_f32_16x16x32_bf16 a[8:11], a[168:171], a[80:83], a[8:11]
s_mov_b32 s34, 1146880
ds_write2st64_b32 v235, v73, v74 offset0:76 offset1:77
v_mfma_f32_16x16x32_bf16 a[8:11], a[184:187], a[84:87], a[8:11]
s_add_u32 m0, s31, 36864
v_mfma_f32_16x16x32_bf16 a[16:19], a[168:171], a[84:87], a[16:19]
v_sub_f32 v66, v52, v60
v_sub_f32 v67, v53, v61
v_mfma_f32_16x16x32_bf16 a[16:19], a[184:187], a[88:91], a[16:19]
buffer_load_dwordx4 v234, s[12:15], s34 offen offset:0 lds
v_mfma_f32_16x16x32_bf16 a[24:27], a[168:171], a[88:91], a[24:27]
s_mov_b32 s34, 1163264
v_cvt_pk_bf16_f32 v75, v66, v67
v_sub_f32 v66, v54, v62
v_mfma_f32_16x16x32_bf16 a[24:27], a[184:187], a[92:95], a[24:27]
s_add_u32 m0, s31, 37888
v_mfma_f32_16x16x32_bf16 a[32:35], a[168:171], a[92:95], a[32:35]
v_sub_f32 v67, v55, v63
v_cvt_pk_bf16_f32 v68, v66, v67
v_mfma_f32_16x16x32_bf16 a[32:35], a[184:187], a[96:99], a[32:35]
s_waitcnt vmcnt(14)
ds_read_b64_tr_b16 a[128:129], v232 offset:0
ds_read_b64_tr_b16 a[130:131], v232 offset:1024
v_mfma_f32_16x16x32_bf16 v[144:147], a[168:171], a[96:99], v[144:147]
ds_write2st64_b32 v235, v75, v68 offset0:78 offset1:79
v_mfma_f32_16x16x32_bf16 v[144:147], a[184:187], a[100:103], v[144:147]
buffer_load_dwordx4 v234, s[12:15], s34 offen offset:0 lds
v_mfma_f32_16x16x32_bf16 v[152:155], a[168:171], a[100:103], v[152:155]
s_mov_b32 s34, 622592
s_add_u32 m0, s31, 34304
v_mfma_f32_16x16x32_bf16 v[152:155], a[184:187], a[104:107], v[152:155]
v_mfma_f32_16x16x32_bf16 v[160:163], a[168:171], a[104:107], v[160:163]
s_waitcnt lgkmcnt(0)
s_barrier
v_mfma_f32_16x16x32_bf16 v[160:163], a[184:187], a[108:111], v[160:163]
s_waitcnt vmcnt(13)
ds_read_b128 a[112:115], v3 offset:16384
v_lshlrev_b32 v48, 16, v12
v_mfma_f32_16x16x32_bf16 a[4:7], a[172:175], a[116:119], a[4:7]
ds_read_b128 a[116:119], v3 offset:17408
buffer_atomic_add v248, v183, s[24:27], 0 offen sc1
v_mfma_f32_16x16x32_bf16 a[4:7], a[188:191], a[80:83], a[4:7]
s_waitcnt vmcnt(13)
ds_read_b64_tr_b16 a[144:145], v232 offset:4096
ds_read_b64_tr_b16 a[146:147], v232 offset:5120
v_mfma_f32_16x16x32_bf16 a[12:15], a[172:175], a[80:83], a[12:15]
ds_read_b128 a[80:83], v3 offset:18432
v_and_b32 v49, s39, v12
v_mfma_f32_16x16x32_bf16 a[12:15], a[188:191], a[84:87], a[12:15]
v_lshlrev_b32 v50, 16, v13
v_and_b32 v51, s39, v13
v_mfma_f32_16x16x32_bf16 a[20:23], a[172:175], a[84:87], a[20:23]
ds_read_b128 a[84:87], v3 offset:19456
v_lshlrev_b32 v52, 16, v14
v_mfma_f32_16x16x32_bf16 a[20:23], a[188:191], a[88:91], a[20:23]
buffer_load_dwordx4 v234, s[12:15], s34 offen offset:512 lds
v_mfma_f32_16x16x32_bf16 a[28:31], a[172:175], a[88:91], a[28:31]
s_mov_b32 s34, 638976
ds_read_b128 a[88:91], v5 offset:16384
s_add_u32 m0, s31, 35328
v_mfma_f32_16x16x32_bf16 a[28:31], a[188:191], a[92:95], a[28:31]
buffer_load_dwordx4 v234, s[12:15], s34 offen offset:512 lds
v_mfma_f32_16x16x32_bf16 a[36:39], a[172:175], a[92:95], a[36:39]
s_mov_b32 s34, 1146880
ds_read_b128 a[92:95], v5 offset:17408
s_add_u32 m0, s31, 38400
v_mfma_f32_16x16x32_bf16 a[36:39], a[188:191], a[96:99], a[36:39]
buffer_load_dwordx4 v234, s[12:15], s34 offen offset:512 lds
v_mfma_f32_16x16x32_bf16 v[148:151], a[172:175], a[96:99], v[148:151]
s_mov_b32 s34, 1163264
ds_read_b128 a[96:99], v5 offset:18432
s_add_u32 m0, s31, 39424
v_mfma_f32_16x16x32_bf16 v[148:151], a[188:191], a[100:103], v[148:151]
buffer_load_dwordx4 v234, s[12:15], s34 offen offset:512 lds
v_mfma_f32_16x16x32_bf16 v[156:159], a[172:175], a[100:103], v[156:159]
s_mov_b32 s34, 655360
ds_read_b128 a[100:103], v5 offset:19456
ds_read_b64_tr_b16 a[132:133], v232 offset:8
v_mfma_f32_16x16x32_bf16 v[156:159], a[188:191], a[104:107], v[156:159]
s_add_u32 m0, s31, 65536
ds_read_b64_tr_b16 a[134:135], v232 offset:1032
ds_read_b64_tr_b16 a[148:149], v232 offset:4104
v_mfma_f32_16x16x32_bf16 v[164:167], a[172:175], a[104:107], v[164:167]
ds_read_b128 a[104:107], v7 offset:16384
v_and_b32 v53, s39, v14
v_mfma_f32_16x16x32_bf16 v[164:167], a[188:191], a[108:111], v[164:167]
s_waitcnt lgkmcnt(13)
buffer_load_dwordx4 v234, s[12:15], s34 offen offset:0 lds
v_mfma_f32_16x16x32_bf16 v[80:83], a[128:131], a[112:115], v[80:83]
s_waitcnt lgkmcnt(10)
v_lshlrev_b32 v54, 16, v15
v_and_b32 v55, s39, v15
v_mfma_f32_16x16x32_bf16 v[80:83], a[144:147], a[116:119], v[80:83]
s_waitcnt vmcnt(16)
v_lshlrev_b32 v56, 16, v16
v_and_b32 v57, s39, v16
v_mfma_f32_16x16x32_bf16 v[88:91], a[128:131], a[116:119], v[88:91]
s_waitcnt lgkmcnt(9)
v_lshlrev_b32 v58, 16, v17
v_and_b32 v59, s39, v17
v_mfma_f32_16x16x32_bf16 v[88:91], a[144:147], a[80:83], v[88:91]
ds_read_b64_tr_b16 a[150:151], v232 offset:5128
v_lshlrev_b32 v60, 16, v18
v_mfma_f32_16x16x32_bf16 v[96:99], a[128:131], a[80:83], v[96:99]
s_waitcnt lgkmcnt(9)
s_mov_b32 s34, 671744
s_add_u32 m0, s31, 66560
v_mfma_f32_16x16x32_bf16 v[96:99], a[144:147], a[84:87], v[96:99]
buffer_load_dwordx4 v234, s[12:15], s34 offen offset:0 lds
v_mfma_f32_16x16x32_bf16 v[104:107], a[128:131], a[84:87], v[104:107]
s_waitcnt vmcnt(16) lgkmcnt(8)
ds_read_b64_tr_b16 a[136:137], v232 offset:2048
ds_read_b64_tr_b16 a[138:139], v232 offset:3072
v_mfma_f32_16x16x32_bf16 v[104:107], a[144:147], a[88:91], v[104:107]
v_and_b32 v61, s39, v18
v_lshlrev_b32 v62, 16, v19
v_mfma_f32_16x16x32_bf16 v[112:115], a[128:131], a[88:91], v[112:115]
s_waitcnt lgkmcnt(9)
v_and_b32 v63, s39, v19
v_mfma_f32_16x16x32_bf16 v[112:115], a[144:147], a[92:95], v[112:115]
buffer_load_dwordx4 v[32:35], v1, s[8:11], 0 offen offset:1408
v_mfma_f32_16x16x32_bf16 v[120:123], a[128:131], a[92:95], v[120:123]
s_waitcnt lgkmcnt(8)
v_mfma_f32_16x16x32_bf16 v[120:123], a[144:147], a[96:99], v[120:123]
v_mfma_f32_16x16x32_bf16 v[128:131], a[128:131], a[96:99], v[128:131]
s_waitcnt lgkmcnt(7)
s_mov_b32 s34, 1179648
s_add_u32 m0, s31, 69632
v_mfma_f32_16x16x32_bf16 v[128:131], a[144:147], a[100:103], v[128:131]
buffer_load_dwordx4 v234, s[12:15], s34 offen offset:0 lds
v_mfma_f32_16x16x32_bf16 v[136:139], a[128:131], a[100:103], v[136:139]
s_waitcnt vmcnt(15) lgkmcnt(3)
ds_read_b64_tr_b16 a[152:153], v232 offset:6144
ds_read_b64_tr_b16 a[154:155], v232 offset:7168
v_mfma_f32_16x16x32_bf16 v[136:139], a[144:147], a[104:107], v[136:139]
v_mfma_f32_16x16x32_bf16 v[84:87], a[132:135], a[112:115], v[84:87]
s_waitcnt lgkmcnt(4)
v_mfma_f32_16x16x32_bf16 v[84:87], a[148:151], a[116:119], v[84:87]
buffer_load_dwordx4 v[36:39], v1, s[8:11], 0 offen offset:3456
v_mfma_f32_16x16x32_bf16 v[92:95], a[132:135], a[116:119], v[92:95]
v_mfma_f32_16x16x32_bf16 v[92:95], a[148:151], a[80:83], v[92:95]
v_mfma_f32_16x16x32_bf16 v[100:103], a[132:135], a[80:83], v[100:103]
s_mov_b32 s34, 1196032
s_add_u32 m0, s31, 70656
v_mfma_f32_16x16x32_bf16 v[100:103], a[148:151], a[84:87], v[100:103]
ds_read_b64_tr_b16 a[140:141], v232 offset:2056
ds_read_b64_tr_b16 a[142:143], v232 offset:3080
v_mfma_f32_16x16x32_bf16 v[108:111], a[132:135], a[84:87], v[108:111]
buffer_load_dwordx4 v234, s[12:15], s34 offen offset:0 lds
v_mfma_f32_16x16x32_bf16 v[108:111], a[148:151], a[88:91], v[108:111]
v_mfma_f32_16x16x32_bf16 v[116:119], a[132:135], a[88:91], v[116:119]
v_mfma_f32_16x16x32_bf16 v[116:119], a[148:151], a[92:95], v[116:119]
v_mfma_f32_16x16x32_bf16 v[124:127], a[132:135], a[92:95], v[124:127]
buffer_load_dwordx4 v[16:19], v1, s[8:11], 0 offen offset:2048
v_mfma_f32_16x16x32_bf16 v[124:127], a[148:151], a[96:99], v[124:127]
v_sub_f32 v66, v56, v48
v_sub_f32 v67, v57, v49
v_mfma_f32_16x16x32_bf16 v[132:135], a[132:135], a[96:99], v[132:135]
s_mov_b32 s34, 655360
s_add_u32 m0, s31, 67072
v_cvt_pk_bf16_f32 v69, v66, v67
v_mfma_f32_16x16x32_bf16 v[132:135], a[148:151], a[100:103], v[132:135]
ds_read_b64_tr_b16 a[156:157], v232 offset:6152
ds_read_b64_tr_b16 a[158:159], v232 offset:7176
v_mfma_f32_16x16x32_bf16 v[140:143], a[132:135], a[100:103], v[140:143]
buffer_load_dwordx4 v234, s[12:15], s34 offen offset:512 lds
v_mfma_f32_16x16x32_bf16 v[140:143], a[148:151], a[104:107], v[140:143]
s_waitcnt lgkmcnt(6)
v_sub_f32 v66, v58, v50
v_sub_f32 v67, v59, v51
v_mfma_f32_16x16x32_bf16 a[0:3], a[136:139], a[112:115], a[0:3]
s_waitcnt lgkmcnt(4)
v_cvt_pk_bf16_f32 v70, v66, v67
v_mfma_f32_16x16x32_bf16 a[0:3], a[152:155], a[116:119], a[0:3]
ds_write2st64_b32 v235, v69, v70 offset0:0 offset1:1
v_mfma_f32_16x16x32_bf16 a[8:11], a[136:139], a[116:119], a[8:11]
buffer_load_dwordx4 v[40:43], v2, s[8:11], 0 offen offset:1408
v_mfma_f32_16x16x32_bf16 a[8:11], a[152:155], a[80:83], a[8:11]
v_sub_f32 v66, v60, v52
v_sub_f32 v67, v61, v53
v_mfma_f32_16x16x32_bf16 a[16:19], a[136:139], a[80:83], a[16:19]
s_mov_b32 s34, 671744
s_add_u32 m0, s31, 68096
v_cvt_pk_bf16_f32 v71, v66, v67
v_mfma_f32_16x16x32_bf16 a[16:19], a[152:155], a[84:87], a[16:19]
v_sub_f32 v66, v62, v54
v_sub_f32 v67, v63, v55
v_mfma_f32_16x16x32_bf16 a[24:27], a[136:139], a[84:87], a[24:27]
buffer_load_dwordx4 v234, s[12:15], s34 offen offset:512 lds
v_mfma_f32_16x16x32_bf16 a[24:27], a[152:155], a[88:91], a[24:27]
v_cvt_pk_bf16_f32 v72, v66, v67
v_mfma_f32_16x16x32_bf16 a[32:35], a[136:139], a[88:91], a[32:35]
s_waitcnt vmcnt(17)
ds_read_b64_tr_b16 a[160:161], v232 offset:32768
ds_read_b64_tr_b16 a[162:163], v232 offset:33792
v_mfma_f32_16x16x32_bf16 a[32:35], a[152:155], a[92:95], a[32:35]
ds_write2st64_b32 v235, v71, v72 offset0:2 offset1:3
v_mfma_f32_16x16x32_bf16 v[144:147], a[136:139], a[92:95], v[144:147]
buffer_atomic_add v248, v239, s[24:27], 0 offen sc1
v_mfma_f32_16x16x32_bf16 v[144:147], a[152:155], a[96:99], v[144:147]
v_lshlrev_b32 v48, 16, v20
v_and_b32 v49, s39, v20
v_mfma_f32_16x16x32_bf16 v[152:155], a[136:139], a[96:99], v[152:155]
s_mov_b32 s34, 1179648
s_add_u32 m0, s31, 71168
v_lshlrev_b32 v50, 16, v21
v_mfma_f32_16x16x32_bf16 v[152:155], a[152:155], a[100:103], v[152:155]
v_and_b32 v51, s39, v21
v_lshlrev_b32 v52, 16, v22
v_mfma_f32_16x16x32_bf16 v[160:163], a[136:139], a[100:103], v[160:163]
buffer_load_dwordx4 v234, s[12:15], s34 offen offset:512 lds
v_mfma_f32_16x16x32_bf16 v[160:163], a[152:155], a[104:107], v[160:163]
s_waitcnt lgkmcnt(6)
ds_read_b128 a[108:111], v4 offset:16384
v_and_b32 v53, s39, v22
v_mfma_f32_16x16x32_bf16 a[4:7], a[140:143], a[112:115], a[4:7]
s_waitcnt vmcnt(17) lgkmcnt(5)
ds_read_b128 a[112:115], v4 offset:17408
ds_read_b64_tr_b16 a[176:177], v232 offset:36864
v_mfma_f32_16x16x32_bf16 a[4:7], a[156:159], a[116:119], a[4:7]
v_lshlrev_b32 v54, 16, v23
v_and_b32 v55, s39, v23
v_mfma_f32_16x16x32_bf16 a[12:15], a[140:143], a[116:119], a[12:15]
ds_read_b128 a[116:119], v4 offset:18432
v_mfma_f32_16x16x32_bf16 a[12:15], a[156:159], a[80:83], a[12:15]
buffer_load_dwordx4 v[44:47], v2, s[8:11], 0 offen offset:3456
v_mfma_f32_16x16x32_bf16 a[20:23], a[140:143], a[80:83], a[20:23]
s_mov_b32 s34, 1196032
ds_read_b128 a[80:83], v4 offset:19456
ds_read_b64_tr_b16 a[178:179], v232 offset:37888
v_mfma_f32_16x16x32_bf16 a[20:23], a[156:159], a[84:87], a[20:23]
s_add_u32 m0, s31, 72192
v_mfma_f32_16x16x32_bf16 a[28:31], a[140:143], a[84:87], a[28:31]
ds_read_b128 a[84:87], v6 offset:16384
v_mfma_f32_16x16x32_bf16 a[28:31], a[156:159], a[88:91], a[28:31]
buffer_load_dwordx4 v234, s[12:15], s34 offen offset:512 lds
v_mfma_f32_16x16x32_bf16 a[36:39], a[140:143], a[88:91], a[36:39]
ds_read_b128 a[88:91], v6 offset:17408
ds_read_b64_tr_b16 a[164:165], v232 offset:32776
v_mfma_f32_16x16x32_bf16 a[36:39], a[156:159], a[92:95], a[36:39]
v_mfma_f32_16x16x32_bf16 v[148:151], a[140:143], a[92:95], v[148:151]
ds_read_b128 a[92:95], v6 offset:18432
v_mfma_f32_16x16x32_bf16 v[148:151], a[156:159], a[96:99], v[148:151]
buffer_load_dwordx4 v[168:171], v182, s[8:11], 0 offen offset:1408
v_mfma_f32_16x16x32_bf16 v[156:159], a[140:143], a[96:99], v[156:159]
s_mov_b32 s34, 688128
ds_read_b128 a[96:99], v6 offset:19456
ds_read_b64_tr_b16 a[166:167], v232 offset:33800
v_mfma_f32_16x16x32_bf16 v[156:159], a[156:159], a[100:103], v[156:159]
s_add_u32 m0, s31, 0
v_mfma_f32_16x16x32_bf16 v[164:167], a[140:143], a[100:103], v[164:167]
ds_read_b128 a[100:103], v8 offset:16384
v_mfma_f32_16x16x32_bf16 v[164:167], a[156:159], a[104:107], v[164:167]
s_waitcnt lgkmcnt(12)
ds_read_b64_tr_b16 a[180:181], v232 offset:36872
ds_read_b64_tr_b16 a[182:183], v232 offset:37896
v_mfma_f32_16x16x32_bf16 v[80:83], a[160:163], a[108:111], v[80:83]
s_waitcnt lgkmcnt(9)
buffer_load_dwordx4 v[20:23], v1, s[8:11], 0 offen offset:1024
v_mfma_f32_16x16x32_bf16 v[80:83], a[176:179], a[112:115], v[80:83]
v_sub_f32 v66, v48, v56
v_sub_f32 v67, v49, v57
v_mfma_f32_16x16x32_bf16 v[88:91], a[160:163], a[112:115], v[88:91]
v_cvt_pk_bf16_f32 v73, v66, v67
v_sub_f32 v66, v50, v58
v_mfma_f32_16x16x32_bf16 v[88:91], a[176:179], a[116:119], v[88:91]
v_sub_f32 v67, v51, v59
v_cvt_pk_bf16_f32 v74, v66, v67
v_mfma_f32_16x16x32_bf16 v[96:99], a[160:163], a[116:119], v[96:99]
ds_write2st64_b32 v235, v73, v74 offset0:4 offset1:5
v_mfma_f32_16x16x32_bf16 v[96:99], a[176:179], a[80:83], v[96:99]
v_sub_f32 v66, v52, v60
v_sub_f32 v67, v53, v61
v_mfma_f32_16x16x32_bf16 v[104:107], a[160:163], a[80:83], v[104:107]
s_waitcnt lgkmcnt(9)
v_cvt_pk_bf16_f32 v75, v66, v67
v_sub_f32 v66, v54, v62
v_mfma_f32_16x16x32_bf16 v[104:107], a[176:179], a[84:87], v[104:107]
v_sub_f32 v67, v55, v63
v_cvt_pk_bf16_f32 v68, v66, v67
v_mfma_f32_16x16x32_bf16 v[112:115], a[160:163], a[84:87], v[112:115]
s_waitcnt lgkmcnt(8)
ds_write2st64_b32 v235, v75, v68 offset0:6 offset1:7
v_mfma_f32_16x16x32_bf16 v[112:115], a[176:179], a[88:91], v[112:115]
v_lshlrev_b32 v56, 16, v24
v_and_b32 v57, s39, v24
v_mfma_f32_16x16x32_bf16 v[120:123], a[160:163], a[88:91], v[120:123]
s_waitcnt lgkmcnt(7)
v_lshlrev_b32 v58, 16, v25
v_and_b32 v59, s39, v25
v_mfma_f32_16x16x32_bf16 v[120:123], a[176:179], a[92:95], v[120:123]
s_waitcnt vmcnt(18)
ds_read_b64_tr_b16 a[168:169], v232 offset:34816
ds_read_b64_tr_b16 a[170:171], v232 offset:35840
v_mfma_f32_16x16x32_bf16 v[128:131], a[160:163], a[92:95], v[128:131]
s_waitcnt lgkmcnt(8)
v_lshlrev_b32 v60, 16, v26
v_and_b32 v61, s39, v26
v_mfma_f32_16x16x32_bf16 v[128:131], a[176:179], a[96:99], v[128:131]
v_lshlrev_b32 v62, 16, v27
v_and_b32 v63, s39, v27
v_mfma_f32_16x16x32_bf16 v[136:139], a[160:163], a[96:99], v[136:139]
s_waitcnt vmcnt(16) lgkmcnt(6)
ds_read_b64_tr_b16 a[184:185], v232 offset:38912
ds_read_b64_tr_b16 a[186:187], v232 offset:39936
v_mfma_f32_16x16x32_bf16 v[136:139], a[176:179], a[100:103], v[136:139]
buffer_load_dwordx4 v[24:27], v2, s[8:11], 0 offen offset:0
v_mfma_f32_16x16x32_bf16 v[84:87], a[164:167], a[108:111], v[84:87]
s_waitcnt lgkmcnt(6)
v_sub_f32 v66, v56, v48
v_sub_f32 v67, v57, v49
v_mfma_f32_16x16x32_bf16 v[84:87], a[180:183], a[112:115], v[84:87]
v_cvt_pk_bf16_f32 v69, v66, v67
v_sub_f32 v66, v58, v50
v_mfma_f32_16x16x32_bf16 v[92:95], a[164:167], a[112:115], v[92:95]
v_sub_f32 v67, v59, v51
v_cvt_pk_bf16_f32 v70, v66, v67
v_mfma_f32_16x16x32_bf16 v[92:95], a[180:183], a[116:119], v[92:95]
ds_write2st64_b32 v235, v69, v70 offset0:8 offset1:9
v_mfma_f32_16x16x32_bf16 v[100:103], a[164:167], a[116:119], v[100:103]
v_sub_f32 v66, v60, v52
v_sub_f32 v67, v61, v53
v_mfma_f32_16x16x32_bf16 v[100:103], a[180:183], a[80:83], v[100:103]
v_cvt_pk_bf16_f32 v71, v66, v67
v_sub_f32 v66, v62, v54
v_mfma_f32_16x16x32_bf16 v[108:111], a[164:167], a[80:83], v[108:111]
v_sub_f32 v67, v63, v55
v_cvt_pk_bf16_f32 v72, v66, v67
v_mfma_f32_16x16x32_bf16 v[108:111], a[180:183], a[84:87], v[108:111]
ds_write2st64_b32 v235, v71, v72 offset0:10 offset1:11
v_mfma_f32_16x16x32_bf16 v[116:119], a[164:167], a[84:87], v[116:119]
v_lshlrev_b32 v48, 16, v28
v_and_b32 v49, s39, v28
v_mfma_f32_16x16x32_bf16 v[116:119], a[180:183], a[88:91], v[116:119]
v_lshlrev_b32 v50, 16, v29
v_and_b32 v51, s39, v29
v_mfma_f32_16x16x32_bf16 v[124:127], a[164:167], a[88:91], v[124:127]
v_lshlrev_b32 v52, 16, v30
v_and_b32 v53, s39, v30
v_mfma_f32_16x16x32_bf16 v[124:127], a[180:183], a[92:95], v[124:127]
v_lshlrev_b32 v54, 16, v31
v_and_b32 v55, s39, v31
v_mfma_f32_16x16x32_bf16 v[132:135], a[164:167], a[92:95], v[132:135]
ds_read_b64_tr_b16 a[172:173], v232 offset:34824
ds_read_b64_tr_b16 a[174:175], v232 offset:35848
v_mfma_f32_16x16x32_bf16 v[132:135], a[180:183], a[96:99], v[132:135]
buffer_load_dwordx4 v[28:31], v1, s[8:11], 0 offen offset:3072
v_mfma_f32_16x16x32_bf16 v[140:143], a[164:167], a[96:99], v[140:143]
ds_read_b64_tr_b16 a[188:189], v232 offset:38920
ds_read_b64_tr_b16 a[190:191], v232 offset:39944
v_mfma_f32_16x16x32_bf16 v[140:143], a[180:183], a[100:103], v[140:143]
s_waitcnt lgkmcnt(8)
v_sub_f32 v66, v48, v56
v_sub_f32 v67, v49, v57
v_mfma_f32_16x16x32_bf16 a[0:3], a[168:171], a[108:111], a[0:3]
s_waitcnt lgkmcnt(6)
v_cvt_pk_bf16_f32 v73, v66, v67
v_sub_f32 v66, v50, v58
v_mfma_f32_16x16x32_bf16 a[0:3], a[184:187], a[112:115], a[0:3]
v_sub_f32 v67, v51, v59
v_cvt_pk_bf16_f32 v74, v66, v67
v_mfma_f32_16x16x32_bf16 a[8:11], a[168:171], a[112:115], a[8:11]
ds_write2st64_b32 v235, v73, v74 offset0:12 offset1:13
v_mfma_f32_16x16x32_bf16 a[8:11], a[184:187], a[116:119], a[8:11]
v_sub_f32 v66, v52, v60
v_sub_f32 v67, v53, v61
v_mfma_f32_16x16x32_bf16 a[16:19], a[168:171], a[116:119], a[16:19]
buffer_load_dwordx4 v234, s[12:15], s34 offen offset:0 lds
v_mfma_f32_16x16x32_bf16 a[16:19], a[184:187], a[80:83], a[16:19]
s_mov_b32 s34, 704512
v_cvt_pk_bf16_f32 v75, v66, v67
v_sub_f32 v66, v54, v62
v_mfma_f32_16x16x32_bf16 a[24:27], a[168:171], a[80:83], a[24:27]
s_add_u32 m0, s31, 1024
v_mfma_f32_16x16x32_bf16 a[24:27], a[184:187], a[84:87], a[24:27]
v_sub_f32 v67, v55, v63
v_cvt_pk_bf16_f32 v68, v66, v67
v_mfma_f32_16x16x32_bf16 a[32:35], a[168:171], a[84:87], a[32:35]
buffer_load_dwordx4 v234, s[12:15], s34 offen offset:0 lds
v_mfma_f32_16x16x32_bf16 a[32:35], a[184:187], a[88:91], a[32:35]
s_mov_b32 s34, 1212416
ds_write2st64_b32 v235, v75, v68 offset0:14 offset1:15
v_mfma_f32_16x16x32_bf16 v[144:147], a[168:171], a[88:91], v[144:147]
s_waitcnt vmcnt(18)
s_add_u32 m0, s31, 4096
ds_read_b64_tr_b16 a[128:129], v233 offset:0
ds_read_b64_tr_b16 a[130:131], v233 offset:1024
v_mfma_f32_16x16x32_bf16 v[144:147], a[184:187], a[92:95], v[144:147]
v_mfma_f32_16x16x32_bf16 v[152:155], a[168:171], a[92:95], v[152:155]
buffer_load_dwordx4 v234, s[12:15], s34 offen offset:0 lds
v_mfma_f32_16x16x32_bf16 v[152:155], a[184:187], a[96:99], v[152:155]
s_mov_b32 s34, 1228800
s_add_u32 m0, s31, 5120
v_mfma_f32_16x16x32_bf16 v[160:163], a[168:171], a[96:99], v[160:163]
s_waitcnt lgkmcnt(2)
s_barrier
v_mfma_f32_16x16x32_bf16 v[160:163], a[184:187], a[100:103], v[160:163]
s_waitcnt vmcnt(18)
ds_read_b128 a[104:107], v3 offset:0
v_lshlrev_b32 v48, 16, v32
v_mfma_f32_16x16x32_bf16 a[4:7], a[172:175], a[108:111], a[4:7]
s_waitcnt vmcnt(15)
ds_read_b128 a[108:111], v3 offset:1024
ds_read_b64_tr_b16 a[144:145], v233 offset:4096
v_mfma_f32_16x16x32_bf16 a[4:7], a[188:191], a[112:115], a[4:7]
buffer_load_dwordx4 v234, s[12:15], s34 offen offset:0 lds
v_mfma_f32_16x16x32_bf16 a[12:15], a[172:175], a[112:115], a[12:15]
s_mov_b32 s34, 688128
ds_read_b128 a[112:115], v3 offset:2048
s_add_u32 m0, s31, 1536
v_mfma_f32_16x16x32_bf16 a[12:15], a[188:191], a[116:119], a[12:15]
v_and_b32 v49, s39, v32
v_lshlrev_b32 v50, 16, v33
v_mfma_f32_16x16x32_bf16 a[20:23], a[172:175], a[116:119], a[20:23]
ds_read_b128 a[116:119], v3 offset:3072
ds_read_b64_tr_b16 a[146:147], v233 offset:5120
v_mfma_f32_16x16x32_bf16 a[20:23], a[188:191], a[80:83], a[20:23]
buffer_load_dwordx4 v234, s[12:15], s34 offen offset:512 lds
v_mfma_f32_16x16x32_bf16 a[28:31], a[172:175], a[80:83], a[28:31]
s_mov_b32 s34, 704512
ds_read_b128 a[80:83], v5 offset:0
s_add_u32 m0, s31, 2560
v_mfma_f32_16x16x32_bf16 a[28:31], a[188:191], a[84:87], a[28:31]
buffer_load_dwordx4 v234, s[12:15], s34 offen offset:512 lds
v_mfma_f32_16x16x32_bf16 a[36:39], a[172:175], a[84:87], a[36:39]
s_mov_b32 s34, 1212416
ds_read_b128 a[84:87], v5 offset:1024
s_add_u32 m0, s31, 5632
v_mfma_f32_16x16x32_bf16 a[36:39], a[188:191], a[88:91], a[36:39]
buffer_load_dwordx4 v234, s[12:15], s34 offen offset:512 lds
s_mov_b32 s34, 1228800
s_add_u32 m0, s31, 6656
s_nop 0
buffer_load_dwordx4 v234, s[12:15], s34 offen offset:512 lds
v_mfma_f32_16x16x32_bf16 v[148:151], a[172:175], a[88:91], v[148:151]
s_mov_b32 s34, 720896
ds_read_b128 a[88:91], v5 offset:2048
ds_read_b64_tr_b16 a[132:133], v233 offset:8
v_mfma_f32_16x16x32_bf16 v[148:151], a[188:191], a[92:95], v[148:151]
s_add_u32 m0, s31, 32768
ds_read_b64_tr_b16 a[134:135], v233 offset:1032
ds_read_b64_tr_b16 a[148:149], v233 offset:4104
v_mfma_f32_16x16x32_bf16 v[156:159], a[172:175], a[92:95], v[156:159]
ds_read_b128 a[92:95], v5 offset:3072
v_and_b32 v51, s39, v33
v_mfma_f32_16x16x32_bf16 v[156:159], a[188:191], a[96:99], v[156:159]
buffer_load_dwordx4 v234, s[12:15], s34 offen offset:0 lds
v_mfma_f32_16x16x32_bf16 v[164:167], a[172:175], a[96:99], v[164:167]
ds_read_b128 a[96:99], v7 offset:0
v_lshlrev_b32 v52, 16, v34
v_mfma_f32_16x16x32_bf16 v[164:167], a[188:191], a[100:103], v[164:167]
s_waitcnt lgkmcnt(13)
v_and_b32 v53, s39, v34
v_lshlrev_b32 v54, 16, v35
v_mfma_f32_16x16x32_bf16 v[80:83], a[128:131], a[104:107], v[80:83]
s_waitcnt lgkmcnt(8)
v_and_b32 v55, s39, v35
v_mfma_f32_16x16x32_bf16 v[80:83], a[144:147], a[108:111], v[80:83]
buffer_load_dwordx4 v[32:35], v2, s[8:11], 0 offen offset:2048
v_mfma_f32_16x16x32_bf16 v[88:91], a[128:131], a[108:111], v[88:91]
s_mov_b32 s34, 737280
s_add_u32 m0, s31, 33792
v_mfma_f32_16x16x32_bf16 v[88:91], a[144:147], a[112:115], v[88:91]
ds_read_b64_tr_b16 a[150:151], v233 offset:5128
v_lshlrev_b32 v56, 16, v36
v_mfma_f32_16x16x32_bf16 v[96:99], a[128:131], a[112:115], v[96:99]
v_and_b32 v57, s39, v36
v_lshlrev_b32 v58, 16, v37
v_mfma_f32_16x16x32_bf16 v[96:99], a[144:147], a[116:119], v[96:99]
buffer_load_dwordx4 v234, s[12:15], s34 offen offset:0 lds
v_mfma_f32_16x16x32_bf16 v[104:107], a[128:131], a[116:119], v[104:107]
s_waitcnt vmcnt(19) lgkmcnt(8)
ds_read_b64_tr_b16 a[136:137], v233 offset:2048
ds_read_b64_tr_b16 a[138:139], v233 offset:3072
v_mfma_f32_16x16x32_bf16 v[104:107], a[144:147], a[80:83], v[104:107]
v_and_b32 v59, s39, v37
v_lshlrev_b32 v60, 16, v38
v_mfma_f32_16x16x32_bf16 v[112:115], a[128:131], a[80:83], v[112:115]
s_waitcnt lgkmcnt(9)
v_and_b32 v61, s39, v38
v_lshlrev_b32 v62, 16, v39
v_mfma_f32_16x16x32_bf16 v[112:115], a[144:147], a[84:87], v[112:115]
v_and_b32 v63, s39, v39
v_mfma_f32_16x16x32_bf16 v[120:123], a[128:131], a[84:87], v[120:123]
s_waitcnt lgkmcnt(8)
s_mov_b32 s34, 1245184
s_add_u32 m0, s31, 36864
v_mfma_f32_16x16x32_bf16 v[120:123], a[144:147], a[88:91], v[120:123]
buffer_load_dwordx4 v234, s[12:15], s34 offen offset:0 lds
v_mfma_f32_16x16x32_bf16 v[128:131], a[128:131], a[88:91], v[128:131]
s_waitcnt lgkmcnt(4)
v_mfma_f32_16x16x32_bf16 v[128:131], a[144:147], a[92:95], v[128:131]
v_mfma_f32_16x16x32_bf16 v[136:139], a[128:131], a[92:95], v[136:139]
s_waitcnt vmcnt(16) lgkmcnt(3)
ds_read_b64_tr_b16 a[152:153], v233 offset:6144
ds_read_b64_tr_b16 a[154:155], v233 offset:7168
v_mfma_f32_16x16x32_bf16 v[136:139], a[144:147], a[96:99], v[136:139]
buffer_load_dwordx4 v[36:39], v2, s[8:11], 0 offen offset:1024
v_mfma_f32_16x16x32_bf16 v[84:87], a[132:135], a[104:107], v[84:87]
s_waitcnt lgkmcnt(4)
v_sub_f32 v66, v56, v48
v_sub_f32 v67, v57, v49
v_mfma_f32_16x16x32_bf16 v[84:87], a[148:151], a[108:111], v[84:87]
v_cvt_pk_bf16_f32 v69, v66, v67
v_sub_f32 v66, v58, v50
v_mfma_f32_16x16x32_bf16 v[92:95], a[132:135], a[108:111], v[92:95]
s_mov_b32 s34, 1261568
s_add_u32 m0, s31, 37888
v_sub_f32 v67, v59, v51
v_mfma_f32_16x16x32_bf16 v[92:95], a[148:151], a[112:115], v[92:95]
buffer_load_dwordx4 v234, s[12:15], s34 offen offset:0 lds
v_mfma_f32_16x16x32_bf16 v[100:103], a[132:135], a[112:115], v[100:103]
v_cvt_pk_bf16_f32 v70, v66, v67
v_mfma_f32_16x16x32_bf16 v[100:103], a[148:151], a[116:119], v[100:103]
ds_read_b64_tr_b16 a[140:141], v233 offset:2056
ds_read_b64_tr_b16 a[142:143], v233 offset:3080
v_mfma_f32_16x16x32_bf16 v[108:111], a[132:135], a[116:119], v[108:111]
ds_write2st64_b32 v235, v69, v70 offset0:64 offset1:65
v_mfma_f32_16x16x32_bf16 v[108:111], a[148:151], a[80:83], v[108:111]
v_sub_f32 v66, v60, v52
v_sub_f32 v67, v61, v53
v_mfma_f32_16x16x32_bf16 v[116:119], a[132:135], a[80:83], v[116:119]
v_cvt_pk_bf16_f32 v71, v66, v67
v_sub_f32 v66, v62, v54
v_mfma_f32_16x16x32_bf16 v[116:119], a[148:151], a[84:87], v[116:119]
v_sub_f32 v67, v63, v55
v_cvt_pk_bf16_f32 v72, v66, v67
v_mfma_f32_16x16x32_bf16 v[124:127], a[132:135], a[84:87], v[124:127]
s_mov_b32 s34, 720896
s_add_u32 m0, s31, 34304
v_mfma_f32_16x16x32_bf16 v[124:127], a[148:151], a[88:91], v[124:127]
buffer_load_dwordx4 v234, s[12:15], s34 offen offset:512 lds
v_mfma_f32_16x16x32_bf16 v[132:135], a[132:135], a[88:91], v[132:135]
ds_write2st64_b32 v235, v71, v72 offset0:66 offset1:67
v_mfma_f32_16x16x32_bf16 v[132:135], a[148:151], a[92:95], v[132:135]
ds_read_b64_tr_b16 a[156:157], v233 offset:6152
ds_read_b64_tr_b16 a[158:159], v233 offset:7176
v_mfma_f32_16x16x32_bf16 v[140:143], a[132:135], a[92:95], v[140:143]
v_lshlrev_b32 v48, 16, v40
v_and_b32 v49, s39, v40
v_mfma_f32_16x16x32_bf16 v[140:143], a[148:151], a[96:99], v[140:143]
s_waitcnt lgkmcnt(8)
v_lshlrev_b32 v50, 16, v41
v_and_b32 v51, s39, v41
v_mfma_f32_16x16x32_bf16 a[0:3], a[136:139], a[104:107], a[0:3]
s_waitcnt lgkmcnt(6)
v_lshlrev_b32 v52, 16, v42
v_and_b32 v53, s39, v42
v_mfma_f32_16x16x32_bf16 a[0:3], a[152:155], a[108:111], a[0:3]
v_lshlrev_b32 v54, 16, v43
v_and_b32 v55, s39, v43
v_mfma_f32_16x16x32_bf16 a[8:11], a[136:139], a[108:111], a[8:11]
s_mov_b32 s34, 737280
s_add_u32 m0, s31, 35328
v_mfma_f32_16x16x32_bf16 a[8:11], a[152:155], a[112:115], a[8:11]
buffer_load_dwordx4 v234, s[12:15], s34 offen offset:512 lds
v_mfma_f32_16x16x32_bf16 a[16:19], a[136:139], a[112:115], a[16:19]
v_mfma_f32_16x16x32_bf16 a[16:19], a[152:155], a[116:119], a[16:19]
v_mfma_f32_16x16x32_bf16 a[24:27], a[136:139], a[116:119], a[24:27]
v_mfma_f32_16x16x32_bf16 a[24:27], a[152:155], a[80:83], a[24:27]
buffer_load_dwordx4 v[40:43], v11, s[8:11], 0 offen offset:0
v_mfma_f32_16x16x32_bf16 a[32:35], a[136:139], a[80:83], a[32:35]
s_waitcnt vmcnt(15)
ds_read_b64_tr_b16 a[160:161], v232 offset:0
ds_read_b64_tr_b16 a[162:163], v232 offset:1024
v_mfma_f32_16x16x32_bf16 a[32:35], a[152:155], a[84:87], a[32:35]
v_sub_f32 v66, v48, v56
v_sub_f32 v67, v49, v57
v_mfma_f32_16x16x32_bf16 v[144:147], a[136:139], a[84:87], v[144:147]
s_mov_b32 s34, 1245184
s_add_u32 m0, s31, 38400
v_cvt_pk_bf16_f32 v73, v66, v67
v_mfma_f32_16x16x32_bf16 v[144:147], a[152:155], a[88:91], v[144:147]
buffer_load_dwordx4 v234, s[12:15], s34 offen offset:512 lds
v_mfma_f32_16x16x32_bf16 v[152:155], a[136:139], a[88:91], v[152:155]
v_sub_f32 v66, v50, v58
v_sub_f32 v67, v51, v59
v_mfma_f32_16x16x32_bf16 v[152:155], a[152:155], a[92:95], v[152:155]
v_cvt_pk_bf16_f32 v74, v66, v67
v_mfma_f32_16x16x32_bf16 v[160:163], a[136:139], a[92:95], v[160:163]
ds_write2st64_b32 v235, v73, v74 offset0:68 offset1:69
v_mfma_f32_16x16x32_bf16 v[160:163], a[152:155], a[96:99], v[160:163]
s_waitcnt lgkmcnt(7)
ds_read_b128 a[100:103], v4 offset:0
v_sub_f32 v66, v52, v60
v_mfma_f32_16x16x32_bf16 a[4:7], a[140:143], a[104:107], a[4:7]
s_waitcnt vmcnt(14) lgkmcnt(4)
ds_read_b128 a[104:107], v4 offset:1024
ds_read_b64_tr_b16 a[176:177], v232 offset:4096
v_mfma_f32_16x16x32_bf16 a[4:7], a[156:159], a[108:111], a[4:7]
v_sub_f32 v67, v53, v61
v_cvt_pk_bf16_f32 v75, v66, v67
v_mfma_f32_16x16x32_bf16 a[12:15], a[140:143], a[108:111], a[12:15]
s_mov_b32 s34, 1261568
ds_read_b128 a[108:111], v4 offset:2048
s_add_u32 m0, s31, 39424
v_mfma_f32_16x16x32_bf16 a[12:15], a[156:159], a[112:115], a[12:15]
buffer_load_dwordx4 v234, s[12:15], s34 offen offset:512 lds
v_mfma_f32_16x16x32_bf16 a[20:23], a[140:143], a[112:115], a[20:23]
ds_read_b128 a[112:115], v4 offset:3072
ds_read_b64_tr_b16 a[178:179], v232 offset:5120
v_mfma_f32_16x16x32_bf16 a[20:23], a[156:159], a[116:119], a[20:23]
v_sub_f32 v66, v54, v62
v_sub_f32 v67, v55, v63
v_mfma_f32_16x16x32_bf16 a[28:31], a[140:143], a[116:119], a[28:31]
ds_read_b128 a[116:119], v6 offset:0
v_cvt_pk_bf16_f32 v68, v66, v67
v_mfma_f32_16x16x32_bf16 a[28:31], a[156:159], a[80:83], a[28:31]
ds_read_b64_tr_b16 a[164:165], v232 offset:8
ds_read_b64_tr_b16 a[166:167], v232 offset:1032
v_mfma_f32_16x16x32_bf16 a[36:39], a[140:143], a[80:83], a[36:39]
ds_read_b128 a[80:83], v6 offset:1024
v_mfma_f32_16x16x32_bf16 a[36:39], a[156:159], a[84:87], a[36:39]
ds_write2st64_b32 v235, v75, v68 offset0:70 offset1:71
v_mfma_f32_16x16x32_bf16 v[148:151], a[140:143], a[84:87], v[148:151]
s_mov_b32 s34, 753664
ds_read_b128 a[84:87], v6 offset:2048
v_lshlrev_b32 v56, 16, v44
v_mfma_f32_16x16x32_bf16 v[148:151], a[156:159], a[88:91], v[148:151]
s_add_u32 m0, s31, 65536
v_and_b32 v57, s39, v44
v_lshlrev_b32 v58, 16, v45
v_mfma_f32_16x16x32_bf16 v[156:159], a[140:143], a[88:91], v[156:159]
ds_read_b128 a[88:91], v6 offset:3072
v_and_b32 v59, s39, v45
v_mfma_f32_16x16x32_bf16 v[156:159], a[156:159], a[92:95], v[156:159]
v_lshlrev_b32 v60, 16, v46
v_and_b32 v61, s39, v46
v_mfma_f32_16x16x32_bf16 v[164:167], a[140:143], a[92:95], v[164:167]
ds_read_b128 a[92:95], v8 offset:0
v_lshlrev_b32 v62, 16, v47
v_mfma_f32_16x16x32_bf16 v[164:167], a[156:159], a[96:99], v[164:167]
s_waitcnt lgkmcnt(13)
ds_read_b64_tr_b16 a[180:181], v232 offset:4104
ds_read_b64_tr_b16 a[182:183], v232 offset:5128
v_mfma_f32_16x16x32_bf16 v[80:83], a[160:163], a[100:103], v[80:83]
s_waitcnt lgkmcnt(10)
v_and_b32 v63, s39, v47
v_mfma_f32_16x16x32_bf16 v[80:83], a[176:179], a[104:107], v[80:83]
buffer_load_dwordx4 v[44:47], v2, s[8:11], 0 offen offset:3072
v_mfma_f32_16x16x32_bf16 v[88:91], a[160:163], a[104:107], v[88:91]
v_sub_f32 v66, v56, v48
v_sub_f32 v67, v57, v49
v_mfma_f32_16x16x32_bf16 v[88:91], a[176:179], a[108:111], v[88:91]
v_cvt_pk_bf16_f32 v69, v66, v67
v_sub_f32 v66, v58, v50
v_mfma_f32_16x16x32_bf16 v[96:99], a[160:163], a[108:111], v[96:99]
v_sub_f32 v67, v59, v51
v_cvt_pk_bf16_f32 v70, v66, v67
v_mfma_f32_16x16x32_bf16 v[96:99], a[176:179], a[112:115], v[96:99]
buffer_load_dwordx4 v234, s[12:15], s34 offen offset:0 lds
v_mfma_f32_16x16x32_bf16 v[104:107], a[160:163], a[112:115], v[104:107]
s_waitcnt vmcnt(15) lgkmcnt(9)
ds_read_b64_tr_b16 a[168:169], v232 offset:2048
ds_read_b64_tr_b16 a[170:171], v232 offset:3072
v_mfma_f32_16x16x32_bf16 v[104:107], a[176:179], a[116:119], v[104:107]
s_mov_b32 s34, 770048
ds_write2st64_b32 v235, v69, v70 offset0:72 offset1:73
v_mfma_f32_16x16x32_bf16 v[112:115], a[160:163], a[116:119], v[112:115]
s_waitcnt lgkmcnt(9)
v_sub_f32 v66, v60, v52
v_sub_f32 v67, v61, v53
v_mfma_f32_16x16x32_bf16 v[112:115], a[176:179], a[80:83], v[112:115]
s_add_u32 m0, s31, 66560
v_mfma_f32_16x16x32_bf16 v[120:123], a[160:163], a[80:83], v[120:123]
s_waitcnt lgkmcnt(7)
v_cvt_pk_bf16_f32 v71, v66, v67
v_sub_f32 v66, v62, v54
v_mfma_f32_16x16x32_bf16 v[120:123], a[176:179], a[84:87], v[120:123]
buffer_load_dwordx4 v234, s[12:15], s34 offen offset:0 lds
v_mfma_f32_16x16x32_bf16 v[128:131], a[160:163], a[84:87], v[128:131]
s_waitcnt lgkmcnt(6)
v_sub_f32 v67, v63, v55
v_cvt_pk_bf16_f32 v72, v66, v67
v_mfma_f32_16x16x32_bf16 v[128:131], a[176:179], a[88:91], v[128:131]
s_mov_b32 s34, 1277952
s_add_u32 m0, s31, 69632
v_mfma_f32_16x16x32_bf16 v[136:139], a[160:163], a[88:91], v[136:139]
s_waitcnt vmcnt(14) lgkmcnt(5)
ds_read_b64_tr_b16 a[184:185], v232 offset:6144
ds_read_b64_tr_b16 a[186:187], v232 offset:7168
v_mfma_f32_16x16x32_bf16 v[136:139], a[176:179], a[92:95], v[136:139]
ds_write2st64_b32 v235, v71, v72 offset0:74 offset1:75
v_mfma_f32_16x16x32_bf16 v[84:87], a[164:167], a[100:103], v[84:87]
s_waitcnt lgkmcnt(6)
buffer_load_dwordx4 v234, s[12:15], s34 offen offset:0 lds
v_mfma_f32_16x16x32_bf16 v[84:87], a[180:183], a[104:107], v[84:87]
v_lshlrev_b32 v48, 16, v168
v_and_b32 v49, s39, v168
v_mfma_f32_16x16x32_bf16 v[92:95], a[164:167], a[104:107], v[92:95]
s_mov_b32 s34, 1294336
s_add_u32 m0, s31, 70656
v_mfma_f32_16x16x32_bf16 v[92:95], a[180:183], a[108:111], v[92:95]
v_lshlrev_b32 v50, 16, v169
v_and_b32 v51, s39, v169
v_mfma_f32_16x16x32_bf16 v[100:103], a[164:167], a[108:111], v[100:103]
buffer_load_dwordx4 v234, s[12:15], s34 offen offset:0 lds
v_mfma_f32_16x16x32_bf16 v[100:103], a[180:183], a[112:115], v[100:103]
v_lshlrev_b32 v52, 16, v170
v_and_b32 v53, s39, v170
v_mfma_f32_16x16x32_bf16 v[108:111], a[164:167], a[112:115], v[108:111]
ds_read_b64_tr_b16 a[172:173], v232 offset:2056
ds_read_b64_tr_b16 a[174:175], v232 offset:3080
v_mfma_f32_16x16x32_bf16 v[108:111], a[180:183], a[116:119], v[108:111]
v_mfma_f32_16x16x32_bf16 v[116:119], a[164:167], a[116:119], v[116:119]
v_lshlrev_b32 v54, 16, v171
v_and_b32 v55, s39, v171
v_mfma_f32_16x16x32_bf16 v[116:119], a[180:183], a[80:83], v[116:119]
v_mfma_f32_16x16x32_bf16 v[124:127], a[164:167], a[80:83], v[124:127]
s_mov_b32 s34, 753664
v_sub_f32 v66, v48, v56
v_sub_f32 v67, v49, v57
v_mfma_f32_16x16x32_bf16 v[124:127], a[180:183], a[84:87], v[124:127]
s_add_u32 m0, s31, 67072
v_mfma_f32_16x16x32_bf16 v[132:135], a[164:167], a[84:87], v[132:135]
v_cvt_pk_bf16_f32 v73, v66, v67
v_sub_f32 v66, v50, v58
v_mfma_f32_16x16x32_bf16 v[132:135], a[180:183], a[88:91], v[132:135]
ds_read_b64_tr_b16 a[188:189], v232 offset:6152
ds_read_b64_tr_b16 a[190:191], v232 offset:7176
v_mfma_f32_16x16x32_bf16 v[140:143], a[164:167], a[88:91], v[140:143]
v_sub_f32 v67, v51, v59
v_cvt_pk_bf16_f32 v74, v66, v67
v_mfma_f32_16x16x32_bf16 v[140:143], a[180:183], a[92:95], v[140:143]
s_waitcnt lgkmcnt(8)
buffer_load_dwordx4 v234, s[12:15], s34 offen offset:512 lds
v_mfma_f32_16x16x32_bf16 a[0:3], a[168:171], a[100:103], a[0:3]
s_waitcnt lgkmcnt(5)
ds_write2st64_b32 v235, v73, v74 offset0:76 offset1:77
v_mfma_f32_16x16x32_bf16 a[0:3], a[184:187], a[104:107], a[0:3]
v_mfma_f32_16x16x32_bf16 a[8:11], a[168:171], a[104:107], a[8:11]
s_mov_b32 s34, 770048
s_add_u32 m0, s31, 68096
v_mfma_f32_16x16x32_bf16 a[8:11], a[184:187], a[108:111], a[8:11]
v_sub_f32 v66, v52, v60
v_sub_f32 v67, v53, v61
v_mfma_f32_16x16x32_bf16 a[16:19], a[168:171], a[108:111], a[16:19]
buffer_load_dwordx4 v234, s[12:15], s34 offen offset:512 lds
v_mfma_f32_16x16x32_bf16 a[16:19], a[184:187], a[112:115], a[16:19]
v_cvt_pk_bf16_f32 v75, v66, v67
v_sub_f32 v66, v54, v62
v_mfma_f32_16x16x32_bf16 a[24:27], a[168:171], a[112:115], a[24:27]
v_mfma_f32_16x16x32_bf16 a[24:27], a[184:187], a[116:119], a[24:27]
v_sub_f32 v67, v55, v63
v_cvt_pk_bf16_f32 v68, v66, v67
v_mfma_f32_16x16x32_bf16 a[32:35], a[168:171], a[116:119], a[32:35]
s_waitcnt vmcnt(15)
ds_read_b64_tr_b16 a[128:129], v232 offset:32768
ds_read_b64_tr_b16 a[130:131], v232 offset:33792
v_mfma_f32_16x16x32_bf16 a[32:35], a[184:187], a[80:83], a[32:35]
ds_write2st64_b32 v235, v75, v68 offset0:78 offset1:79
v_mfma_f32_16x16x32_bf16 v[144:147], a[168:171], a[80:83], v[144:147]
s_mov_b32 s34, 1277952
s_add_u32 m0, s31, 71168
v_mfma_f32_16x16x32_bf16 v[144:147], a[184:187], a[84:87], v[144:147]
buffer_load_dwordx4 v234, s[12:15], s34 offen offset:512 lds
v_mfma_f32_16x16x32_bf16 v[152:155], a[168:171], a[84:87], v[152:155]
buffer_load_dword v248, v249, s[24:27], 0 offen sc1
v_mfma_f32_16x16x32_bf16 v[152:155], a[184:187], a[88:91], v[152:155]
v_mfma_f32_16x16x32_bf16 v[160:163], a[168:171], a[88:91], v[160:163]
s_waitcnt lgkmcnt(0)
s_barrier
v_mfma_f32_16x16x32_bf16 v[160:163], a[184:187], a[92:95], v[160:163]
ds_read_b128 a[96:99], v3 offset:16384
v_mfma_f32_16x16x32_bf16 a[4:7], a[172:175], a[100:103], a[4:7]
s_waitcnt vmcnt(14)
ds_read_b128 a[100:103], v3 offset:17408
ds_read_b64_tr_b16 a[144:145], v232 offset:36864
v_mfma_f32_16x16x32_bf16 a[4:7], a[188:191], a[104:107], a[4:7]
buffer_load_dwordx4 v[12:15], v1, s[8:11], 0 offen offset:128
v_mfma_f32_16x16x32_bf16 a[12:15], a[172:175], a[104:107], a[12:15]
s_mov_b32 s34, 1294336
ds_read_b128 a[104:107], v3 offset:18432
s_add_u32 m0, s31, 72192
v_mfma_f32_16x16x32_bf16 a[12:15], a[188:191], a[108:111], a[12:15]
v_lshlrev_b32 v56, 16, v16
v_and_b32 v57, s39, v16
v_mfma_f32_16x16x32_bf16 a[20:23], a[172:175], a[108:111], a[20:23]
ds_read_b128 a[108:111], v3 offset:19456
ds_read_b64_tr_b16 a[146:147], v232 offset:37888
v_mfma_f32_16x16x32_bf16 a[20:23], a[188:191], a[112:115], a[20:23]
buffer_load_dwordx4 v234, s[12:15], s34 offen offset:512 lds
v_mfma_f32_16x16x32_bf16 a[28:31], a[172:175], a[112:115], a[28:31]
ds_read_b128 a[112:115], v5 offset:16384
v_lshlrev_b32 v58, 16, v17
v_mfma_f32_16x16x32_bf16 a[28:31], a[188:191], a[116:119], a[28:31]
ds_read_b64_tr_b16 a[132:133], v232 offset:32776
ds_read_b64_tr_b16 a[134:135], v232 offset:33800
v_mfma_f32_16x16x32_bf16 a[36:39], a[172:175], a[116:119], a[36:39]
ds_read_b128 a[116:119], v5 offset:17408
v_and_b32 v59, s39, v17
v_mfma_f32_16x16x32_bf16 a[36:39], a[188:191], a[80:83], a[36:39]
v_lshlrev_b32 v60, 16, v18
v_and_b32 v61, s39, v18
v_mfma_f32_16x16x32_bf16 v[148:151], a[172:175], a[80:83], v[148:151]
ds_read_b128 a[80:83], v5 offset:18432
v_lshlrev_b32 v62, 16, v19
v_mfma_f32_16x16x32_bf16 v[148:151], a[188:191], a[84:87], v[148:151]
v_and_b32 v63, s39, v19
v_mfma_f32_16x16x32_bf16 v[156:159], a[172:175], a[84:87], v[156:159]
ds_read_b128 a[84:87], v5 offset:19456
v_mfma_f32_16x16x32_bf16 v[156:159], a[188:191], a[88:91], v[156:159]
buffer_load_dwordx4 v[16:19], v1, s[8:11], 0 offen offset:2176
v_mfma_f32_16x16x32_bf16 v[164:167], a[172:175], a[88:91], v[164:167]
ds_read_b128 a[88:91], v7 offset:16384
v_lshlrev_b32 v64, 16, v20
v_mfma_f32_16x16x32_bf16 v[164:167], a[188:191], a[92:95], v[164:167]
s_waitcnt lgkmcnt(12)
ds_read_b64_tr_b16 a[148:149], v232 offset:36872
ds_read_b64_tr_b16 a[150:151], v232 offset:37896
v_mfma_f32_16x16x32_bf16 v[80:83], a[128:131], a[96:99], v[80:83]
s_waitcnt lgkmcnt(9)
v_and_b32 v65, s39, v20
v_sub_f32 v66, v56, v64
v_mfma_f32_16x16x32_bf16 v[80:83], a[144:147], a[100:103], v[80:83]
v_sub_f32 v67, v57, v65
v_cvt_pk_bf16_f32 v69, v66, v67
v_mfma_f32_16x16x32_bf16 v[88:91], a[128:131], a[100:103], v[88:91]
v_add_f32 v66, v56, v64
v_add_f32 v67, v57, v65
v_mfma_f32_16x16x32_bf16 v[88:91], a[144:147], a[104:107], v[88:91]
v_cvt_pk_bf16_f32 v70, v66, v67
v_lshlrev_b32 v64, 16, v21
v_mfma_f32_16x16x32_bf16 v[96:99], a[128:131], a[104:107], v[96:99]
v_and_b32 v65, s39, v21
v_sub_f32 v66, v58, v64
v_mfma_f32_16x16x32_bf16 v[96:99], a[144:147], a[108:111], v[96:99]
v_sub_f32 v67, v59, v65
v_cvt_pk_bf16_f32 v71, v66, v67
v_mfma_f32_16x16x32_bf16 v[104:107], a[128:131], a[108:111], v[104:107]
s_waitcnt vmcnt(3) lgkmcnt(8)
v_readfirstlane_b32 s68, v248
ds_read_b64_tr_b16 a[136:137], v232 offset:34816
v_mfma_f32_16x16x32_bf16 v[104:107], a[144:147], a[112:115], v[104:107]
s_cmp_lt_u32 s68, 128
s_cbranch_scc1 L_slow
L_back:
v_mfma_f32_16x16x32_bf16 v[112:115], a[128:131], a[112:115], v[112:115]
s_waitcnt lgkmcnt(6)
s_mov_b32 s35, 0
s_mov_b32 s69, 4096
v_mfma_f32_16x16x32_bf16 v[112:115], a[144:147], a[116:119], v[112:115]
buffer_load_dwordx4 a[192:195], v9, s[16:19], s35 offen offset:0 sc1
v_mfma_f32_16x16x32_bf16 v[120:123], a[128:131], a[116:119], v[120:123]
s_waitcnt lgkmcnt(5)
ds_write2st64_b32 v235, v69, v71 offset0:128 offset1:129
v_mfma_f32_16x16x32_bf16 v[120:123], a[144:147], a[80:83], v[120:123]
v_add_f32 v66, v58, v64
v_add_f32 v67, v59, v65
v_mfma_f32_16x16x32_bf16 v[128:131], a[128:131], a[80:83], v[128:131]
s_waitcnt lgkmcnt(5)
v_cvt_pk_bf16_f32 v72, v66, v67
ds_read_b64_tr_b16 a[138:139], v232 offset:35840
v_mfma_f32_16x16x32_bf16 v[128:131], a[144:147], a[84:87], v[128:131]
ds_write2st64_b32 v235, v70, v72 offset0:192 offset1:193
v_mfma_f32_16x16x32_bf16 v[136:139], a[128:131], a[84:87], v[136:139]
s_waitcnt lgkmcnt(6)
buffer_load_dwordx4 a[208:211], v9, s[16:19], s69 offen offset:0 sc1
v_mfma_f32_16x16x32_bf16 v[136:139], a[144:147], a[88:91], v[136:139]
v_lshlrev_b32 v64, 16, v22
v_and_b32 v65, s39, v22
v_mfma_f32_16x16x32_bf16 v[84:87], a[132:135], a[96:99], v[84:87]
s_waitcnt lgkmcnt(4)
v_sub_f32 v66, v60, v64
v_sub_f32 v67, v61, v65
v_mfma_f32_16x16x32_bf16 v[84:87], a[148:151], a[100:103], v[84:87]
ds_read_b64_tr_b16 a[152:153], v232 offset:38912
ds_read_b64_tr_b16 a[154:155], v232 offset:39936
v_mfma_f32_16x16x32_bf16 v[92:95], a[132:135], a[100:103], v[92:95]
v_cvt_pk_bf16_f32 v73, v66, v67
v_add_f32 v66, v60, v64
v_mfma_f32_16x16x32_bf16 v[92:95], a[148:151], a[104:107], v[92:95]
v_add_f32 v67, v61, v65
v_cvt_pk_bf16_f32 v74, v66, v67
v_mfma_f32_16x16x32_bf16 v[100:103], a[132:135], a[104:107], v[100:103]
v_lshlrev_b32 v64, 16, v23
v_and_b32 v65, s39, v23
v_mfma_f32_16x16x32_bf16 v[100:103], a[148:151], a[108:111], v[100:103]
v_sub_f32 v66, v62, v64
v_sub_f32 v67, v63, v65
v_mfma_f32_16x16x32_bf16 v[108:111], a[132:135], a[108:111], v[108:111]
buffer_load_dwordx4 a[196:199], v9, s[16:19], s35 offen offset:1024 sc1
v_mfma_f32_16x16x32_bf16 v[108:111], a[148:151], a[112:115], v[108:111]
v_cvt_pk_bf16_f32 v75, v66, v67
ds_read_b64_tr_b16 a[140:141], v232 offset:34824
v_mfma_f32_16x16x32_bf16 v[116:119], a[132:135], a[112:115], v[116:119]
ds_write2st64_b32 v235, v73, v75 offset0:130 offset1:131
v_mfma_f32_16x16x32_bf16 v[116:119], a[148:151], a[116:119], v[116:119]
v_add_f32 v66, v62, v64
v_add_f32 v67, v63, v65
v_mfma_f32_16x16x32_bf16 v[124:127], a[132:135], a[116:119], v[124:127]
v_cvt_pk_bf16_f32 v68, v66, v67
ds_read_b64_tr_b16 a[142:143], v232 offset:35848
v_mfma_f32_16x16x32_bf16 v[124:127], a[148:151], a[80:83], v[124:127]
ds_write2st64_b32 v235, v74, v68 offset0:194 offset1:195
v_mfma_f32_16x16x32_bf16 v[132:135], a[132:135], a[80:83], v[132:135]
buffer_load_dwordx4 v[20:23], v1, s[8:11], 0 offen offset:1152
v_mfma_f32_16x16x32_bf16 v[132:135], a[148:151], a[84:87], v[132:135]
buffer_load_dwordx4 a[212:215], v9, s[16:19], s69 offen offset:1024 sc1
v_mfma_f32_16x16x32_bf16 v[140:143], a[132:135], a[84:87], v[140:143]
v_lshlrev_b32 v48, 16, v24
v_and_b32 v49, s39, v24
v_mfma_f32_16x16x32_bf16 v[140:143], a[148:151], a[88:91], v[140:143]
s_waitcnt lgkmcnt(7)
v_lshlrev_b32 v50, 16, v25
v_and_b32 v51, s39, v25
v_mfma_f32_16x16x32_bf16 a[0:3], a[136:139], a[96:99], a[0:3]
s_waitcnt lgkmcnt(4)
v_lshlrev_b32 v52, 16, v26
v_and_b32 v53, s39, v26
v_mfma_f32_16x16x32_bf16 a[0:3], a[152:155], a[100:103], a[0:3]
v_lshlrev_b32 v54, 16, v27
v_and_b32 v55, s39, v27
v_mfma_f32_16x16x32_bf16 a[8:11], a[136:139], a[100:103], a[8:11]
buffer_load_dwordx4 v[24:27], v2, s[8:11], 0 offen offset:128
v_mfma_f32_16x16x32_bf16 a[8:11], a[152:155], a[104:107], a[8:11]
ds_read_b64_tr_b16 a[156:157], v232 offset:38920
ds_read_b64_tr_b16 a[158:159], v232 offset:39944
v_mfma_f32_16x16x32_bf16 a[16:19], a[136:139], a[104:107], a[16:19]
v_lshlrev_b32 v64, 16, v28
v_and_b32 v65, s39, v28
v_mfma_f32_16x16x32_bf16 a[16:19], a[152:155], a[108:111], a[16:19]
buffer_load_dwordx4 a[200:203], v9, s[16:19], s35 offen offset:2048 sc1
v_mfma_f32_16x16x32_bf16 a[24:27], a[136:139], a[108:111], a[24:27]
v_sub_f32 v66, v48, v64
v_sub_f32 v67, v49, v65
v_mfma_f32_16x16x32_bf16 a[24:27], a[152:155], a[112:115], a[24:27]
v_cvt_pk_bf16_f32 v69, v66, v67
v_add_f32 v66, v48, v64
v_mfma_f32_16x16x32_bf16 a[32:35], a[136:139], a[112:115], a[32:35]
v_add_f32 v67, v49, v65
v_cvt_pk_bf16_f32 v70, v66, v67
v_mfma_f32_16x16x32_bf16 a[32:35], a[152:155], a[116:119], a[32:35]
v_lshlrev_b32 v64, 16, v29
v_and_b32 v65, s39, v29
v_mfma_f32_16x16x32_bf16 v[144:147], a[136:139], a[116:119], v[144:147]
v_sub_f32 v66, v50, v64
v_sub_f32 v67, v51, v65
v_mfma_f32_16x16x32_bf16 v[144:147], a[152:155], a[80:83], v[144:147]
v_cvt_pk_bf16_f32 v71, v66, v67
ds_read_b64_tr_b16 a[160:161], v233 offset:0
v_mfma_f32_16x16x32_bf16 v[152:155], a[136:139], a[80:83], v[152:155]
ds_write2st64_b32 v235, v69, v71 offset0:132 offset1:133
v_mfma_f32_16x16x32_bf16 v[152:155], a[152:155], a[84:87], v[152:155]
buffer_load_dwordx4 a[216:219], v9, s[16:19], s69 offen offset:2048 sc1
v_mfma_f32_16x16x32_bf16 v[160:163], a[136:139], a[84:87], v[160:163]
v_add_f32 v66, v50, v64
v_add_f32 v67, v51, v65
v_mfma_f32_16x16x32_bf16 v[160:163], a[152:155], a[88:91], v[160:163]
s_waitcnt lgkmcnt(5)
ds_read_b128 a[92:95], v4 offset:16384
v_cvt_pk_bf16_f32 v72, v66, v67
v_mfma_f32_16x16x32_bf16 a[4:7], a[140:143], a[96:99], a[4:7]
s_waitcnt lgkmcnt(3)
ds_read_b128 a[96:99], v4 offset:17408
ds_read_b64_tr_b16 a[162:163], v233 offset:1024
v_mfma_f32_16x16x32_bf16 a[4:7], a[156:159], a[100:103], a[4:7]
ds_write2st64_b32 v235, v70, v72 offset0:196 offset1:197
v_mfma_f32_16x16x32_bf16 a[12:15], a[140:143], a[100:103], a[12:15]
ds_read_b128 a[100:103], v4 offset:18432
v_lshlrev_b32 v64, 16, v30
v_mfma_f32_16x16x32_bf16 a[12:15], a[156:159], a[104:107], a[12:15]
v_and_b32 v65, s39, v30
v_sub_f32 v66, v52, v64
v_mfma_f32_16x16x32_bf16 a[20:23], a[140:143], a[104:107], a[20:23]
ds_read_b128 a[104:107], v4 offset:19456
v_sub_f32 v67, v53, v65
v_mfma_f32_16x16x32_bf16 a[20:23], a[156:159], a[108:111], a[20:23]
buffer_load_dwordx4 a[204:207], v9, s[16:19], s35 offen offset:3072 sc1
v_mfma_f32_16x16x32_bf16 a[28:31], a[140:143], a[108:111], a[28:31]
ds_read_b128 a[108:111], v6 offset:16384
ds_read_b64_tr_b16 a[176:177], v233 offset:4096
ds_read_b64_tr_b16 a[178:179], v233 offset:5120
v_mfma_f32_16x16x32_bf16 a[28:31], a[156:159], a[112:115], a[28:31]
v_cvt_pk_bf16_f32 v73, v66, v67
v_add_f32 v66, v52, v64
v_mfma_f32_16x16x32_bf16 a[36:39], a[140:143], a[112:115], a[36:39]
ds_read_b128 a[112:115], v6 offset:17408
v_add_f32 v67, v53, v65
v_mfma_f32_16x16x32_bf16 a[36:39], a[156:159], a[116:119], a[36:39]
v_cvt_pk_bf16_f32 v74, v66, v67
v_lshlrev_b32 v64, 16, v31
v_mfma_f32_16x16x32_bf16 v[148:151], a[140:143], a[116:119], v[148:151]
ds_read_b128 a[116:119], v6 offset:18432
v_and_b32 v65, s39, v31
v_mfma_f32_16x16x32_bf16 v[148:151], a[156:159], a[80:83], v[148:151]
v_sub_f32 v66, v54, v64
v_sub_f32 v67, v55, v65
v_mfma_f32_16x16x32_bf16 v[156:159], a[140:143], a[80:83], v[156:159]
ds_read_b128 a[80:83], v6 offset:19456
v_cvt_pk_bf16_f32 v75, v66, v67
v_mfma_f32_16x16x32_bf16 v[156:159], a[156:159], a[84:87], v[156:159]
buffer_load_dwordx4 a[220:223], v9, s[16:19], s69 offen offset:3072 sc1
v_mfma_f32_16x16x32_bf16 v[164:167], a[140:143], a[84:87], v[164:167]
s_mov_b32 s35, 8192
ds_read_b128 a[84:87], v8 offset:16384
ds_read_b64_tr_b16 a[164:165], v233 offset:8
v_mfma_f32_16x16x32_bf16 v[164:167], a[156:159], a[88:91], v[164:167]
s_waitcnt lgkmcnt(11)
ds_write2st64_b32 v235, v73, v75 offset0:134 offset1:135
v_mfma_f32_16x16x32_bf16 v[80:83], a[160:163], a[92:95], v[80:83]
s_waitcnt lgkmcnt(6)
v_add_f32 v66, v54, v64
v_add_f32 v67, v55, v65
v_mfma_f32_16x16x32_bf16 v[80:83], a[176:179], a[96:99], v[80:83]
s_mov_b32 s69, 12288
v_cvt_pk_bf16_f32 v68, v66, v67
ds_read_b64_tr_b16 a[166:167], v233 offset:1032
v_mfma_f32_16x16x32_bf16 v[88:91], a[160:163], a[96:99], v[88:91]
ds_write2st64_b32 v235, v74, v68 offset0:198 offset1:199
v_mfma_f32_16x16x32_bf16 v[88:91], a[176:179], a[100:103], v[88:91]
buffer_load_dwordx4 v[28:31], v1, s[8:11], 0 offen offset:3200
v_mfma_f32_16x16x32_bf16 v[96:99], a[160:163], a[100:103], v[96:99]
v_lshlrev_b32 v56, 16, v32
v_and_b32 v57, s39, v32
v_mfma_f32_16x16x32_bf16 v[96:99], a[176:179], a[104:107], v[96:99]
ds_read_b64_tr_b16 a[180:181], v233 offset:4104
ds_read_b64_tr_b16 a[182:183], v233 offset:5128
buffer_load_dwordx4 a[224:227], v9, s[16:19], s35 offen offset:0 sc1
v_mfma_f32_16x16x32_bf16 v[104:107], a[160:163], a[104:107], v[104:107]
v_lshlrev_b32 v58, 16, v33
v_and_b32 v59, s39, v33
v_mfma_f32_16x16x32_bf16 v[104:107], a[176:179], a[108:111], v[104:107]
v_lshlrev_b32 v60, 16, v34
v_and_b32 v61, s39, v34
v_mfma_f32_16x16x32_bf16 v[112:115], a[160:163], a[108:111], v[112:115]
s_waitcnt lgkmcnt(9)
v_lshlrev_b32 v62, 16, v35
v_and_b32 v63, s39, v35
v_mfma_f32_16x16x32_bf16 v[112:115], a[176:179], a[112:115], v[112:115]
buffer_load_dwordx4 v[32:35], v2, s[8:11], 0 offen offset:2176
v_mfma_f32_16x16x32_bf16 v[120:123], a[160:163], a[112:115], v[120:123]
s_waitcnt lgkmcnt(8)
v_lshlrev_b32 v64, 16, v36
v_and_b32 v65, s39, v36
v_mfma_f32_16x16x32_bf16 v[120:123], a[176:179], a[116:119], v[120:123]
v_sub_f32 v66, v56, v64
v_sub_f32 v67, v57, v65
v_mfma_f32_16x16x32_bf16 v[128:131], a[160:163], a[116:119], v[128:131]
s_waitcnt lgkmcnt(7)
v_cvt_pk_bf16_f32 v69, v66, v67
v_add_f32 v66, v56, v64
v_mfma_f32_16x16x32_bf16 v[128:131], a[176:179], a[80:83], v[128:131]
buffer_load_dwordx4 a[240:243], v9, s[16:19], s69 offen offset:0 sc1
v_mfma_f32_16x16x32_bf16 v[136:139], a[160:163], a[80:83], v[136:139]
s_waitcnt lgkmcnt(6)
v_add_f32 v67, v57, v65
v_cvt_pk_bf16_f32 v70, v66, v67
v_mfma_f32_16x16x32_bf16 v[136:139], a[176:179], a[84:87], v[136:139]
s_waitcnt lgkmcnt(3)
v_lshlrev_b32 v64, 16, v37
v_and_b32 v65, s39, v37
v_mfma_f32_16x16x32_bf16 v[84:87], a[164:167], a[92:95], v[84:87]
s_waitcnt lgkmcnt(0)
v_sub_f32 v66, v58, v64
v_sub_f32 v67, v59, v65
v_mfma_f32_16x16x32_bf16 v[84:87], a[180:183], a[96:99], v[84:87]
v_cvt_pk_bf16_f32 v71, v66, v67
ds_read_b64_tr_b16 a[168:169], v233 offset:2048
v_mfma_f32_16x16x32_bf16 v[92:95], a[164:167], a[96:99], v[92:95]
ds_write2st64_b32 v235, v69, v71 offset0:136 offset1:137
v_mfma_f32_16x16x32_bf16 v[92:95], a[180:183], a[100:103], v[92:95]
v_add_f32 v66, v58, v64
v_add_f32 v67, v59, v65
v_mfma_f32_16x16x32_bf16 v[100:103], a[164:167], a[100:103], v[100:103]
s_waitcnt vmcnt(15)
ds_read_b64_tr_b16 a[170:171], v233 offset:3072
ds_read_b64_tr_b16 a[184:185], v233 offset:6144
ds_read_b64_tr_b16 a[186:187], v233 offset:7168
v_mfma_f32_16x16x32_bf16 v[100:103], a[180:183], a[104:107], v[100:103]
buffer_load_dwordx4 a[228:231], v9, s[16:19], s35 offen offset:1024 sc1
v_mfma_f32_16x16x32_bf16 v[108:111], a[164:167], a[104:107], v[108:111]
v_cvt_pk_bf16_f32 v72, v66, v67
ds_read_b64_tr_b16 a[172:173], v233 offset:2056
v_mfma_f32_16x16x32_bf16 v[108:111], a[180:183], a[108:111], v[108:111]
ds_write2st64_b32 v235, v70, v72 offset0:200 offset1:201
v_mfma_f32_16x16x32_bf16 v[116:119], a[164:167], a[108:111], v[116:119]
v_lshlrev_b32 v64, 16, v38
v_and_b32 v65, s39, v38
v_mfma_f32_16x16x32_bf16 v[116:119], a[180:183], a[112:115], v[116:119]
v_sub_f32 v66, v60, v64
v_sub_f32 v67, v61, v65
v_mfma_f32_16x16x32_bf16 v[124:127], a[164:167], a[112:115], v[124:127]
v_cvt_pk_bf16_f32 v73, v66, v67
v_add_f32 v66, v60, v64
v_mfma_f32_16x16x32_bf16 v[124:127], a[180:183], a[116:119], v[124:127]
v_add_f32 v67, v61, v65
v_cvt_pk_bf16_f32 v74, v66, v67
v_mfma_f32_16x16x32_bf16 v[132:135], a[164:167], a[116:119], v[132:135]
v_lshlrev_b32 v64, 16, v39
v_and_b32 v65, s39, v39
v_mfma_f32_16x16x32_bf16 v[132:135], a[180:183], a[80:83], v[132:135]
buffer_load_dwordx4 a[244:247], v9, s[16:19], s69 offen offset:1024 sc1
v_mfma_f32_16x16x32_bf16 v[140:143], a[164:167], a[80:83], v[140:143]
v_sub_f32 v66, v62, v64
v_sub_f32 v67, v63, v65
v_mfma_f32_16x16x32_bf16 v[140:143], a[180:183], a[84:87], v[140:143]
s_waitcnt lgkmcnt(4)
v_cvt_pk_bf16_f32 v75, v66, v67
ds_read_b64_tr_b16 a[174:175], v233 offset:3080
v_mfma_f32_16x16x32_bf16 a[0:3], a[168:171], a[92:95], a[0:3]
s_waitcnt lgkmcnt(3)
ds_write2st64_b32 v235, v73, v75 offset0:138 offset1:139
v_mfma_f32_16x16x32_bf16 a[0:3], a[184:187], a[96:99], a[0:3]
v_add_f32 v66, v62, v64
v_add_f32 v67, v63, v65
v_mfma_f32_16x16x32_bf16 a[8:11], a[168:171], a[96:99], a[8:11]
v_cvt_pk_bf16_f32 v68, v66, v67
ds_read_b64_tr_b16 a[188:189], v233 offset:6152
v_mfma_f32_16x16x32_bf16 a[8:11], a[184:187], a[100:103], a[8:11]
ds_read_b64_tr_b16 a[190:191], v233 offset:7176
v_mfma_f32_16x16x32_bf16 a[16:19], a[168:171], a[100:103], a[16:19]
ds_write2st64_b32 v235, v74, v68 offset0:202 offset1:203
v_mfma_f32_16x16x32_bf16 a[16:19], a[184:187], a[104:107], a[16:19]
buffer_load_dwordx4 a[232:235], v9, s[16:19], s35 offen offset:2048 sc1
v_mfma_f32_16x16x32_bf16 a[24:27], a[168:171], a[104:107], a[24:27]
buffer_load_dwordx4 v[36:39], v2, s[8:11], 0 offen offset:1152
v_mfma_f32_16x16x32_bf16 a[24:27], a[184:187], a[108:111], a[24:27]
v_lshlrev_b32 v48, 16, v40
v_and_b32 v49, s39, v40
v_mfma_f32_16x16x32_bf16 a[32:35], a[168:171], a[108:111], a[32:35]
v_lshlrev_b32 v50, 16, v41
v_and_b32 v51, s39, v41
v_mfma_f32_16x16x32_bf16 a[32:35], a[184:187], a[112:115], a[32:35]
v_lshlrev_b32 v52, 16, v42
v_and_b32 v53, s39, v42
v_mfma_f32_16x16x32_bf16 v[144:147], a[168:171], a[112:115], v[144:147]
v_lshlrev_b32 v54, 16, v43
v_and_b32 v55, s39, v43
buffer_load_dwordx4 v[40:43], v11, s[8:11], 0 offen offset:128
v_lshlrev_b32 v64, 16, v44
v_and_b32 v65, s39, v44
v_sub_f32 v66, v48, v64
v_sub_f32 v67, v49, v65
v_cvt_pk_bf16_f32 v69, v66, v67
v_add_f32 v66, v48, v64
v_add_f32 v67, v49, v65
v_cvt_pk_bf16_f32 v70, v66, v67
v_lshlrev_b32 v64, 16, v45
v_and_b32 v65, s39, v45
v_sub_f32 v66, v50, v64
v_sub_f32 v67, v51, v65
v_cvt_pk_bf16_f32 v71, v66, v67
ds_write2st64_b32 v235, v69, v71 offset0:140 offset1:141
v_add_f32 v66, v50, v64
v_add_f32 v67, v51, v65
v_cvt_pk_bf16_f32 v72, v66, v67
ds_write2st64_b32 v235, v70, v72 offset0:204 offset1:205
v_lshlrev_b32 v64, 16, v46
v_and_b32 v65, s39, v46
v_sub_f32 v66, v52, v64
v_sub_f32 v67, v53, v65
v_cvt_pk_bf16_f32 v73, v66, v67
v_add_f32 v66, v52, v64
v_add_f32 v67, v53, v65
v_cvt_pk_bf16_f32 v74, v66, v67
v_lshlrev_b32 v64, 16, v47
v_and_b32 v65, s39, v47
v_sub_f32 v66, v54, v64
v_sub_f32 v67, v55, v65
v_cvt_pk_bf16_f32 v75, v66, v67
ds_write2st64_b32 v235, v73, v75 offset0:142 offset1:143
v_add_f32 v66, v54, v64
v_add_f32 v67, v55, v65
v_cvt_pk_bf16_f32 v68, v66, v67
ds_write2st64_b32 v235, v74, v68 offset0:206 offset1:207
buffer_load_dwordx4 v[44:47], v2, s[8:11], 0 offen offset:3200
v_mfma_f32_16x16x32_bf16 v[144:147], a[184:187], a[116:119], v[144:147]
buffer_load_dwordx4 a[248:251], v9, s[16:19], s69 offen offset:2048 sc1
v_mfma_f32_16x16x32_bf16 v[152:155], a[168:171], a[116:119], v[152:155]
v_mfma_f32_16x16x32_bf16 v[152:155], a[184:187], a[80:83], v[152:155]
v_mfma_f32_16x16x32_bf16 v[160:163], a[168:171], a[80:83], v[160:163]
s_waitcnt lgkmcnt(0)
s_barrier
v_mfma_f32_16x16x32_bf16 v[160:163], a[184:187], a[84:87], v[160:163]
ds_read_b128 a[88:91], v3 offset:32768
v_lshlrev_b32 v48, 16, v12
v_mfma_f32_16x16x32_bf16 a[4:7], a[172:175], a[92:95], a[4:7]
ds_read_b128 a[92:95], v3 offset:33792
v_and_b32 v49, s39, v12
v_mfma_f32_16x16x32_bf16 a[4:7], a[188:191], a[96:99], a[4:7]
buffer_load_dwordx4 a[236:239], v9, s[16:19], s35 offen offset:3072 sc1
v_mfma_f32_16x16x32_bf16 a[12:15], a[172:175], a[96:99], a[12:15]
ds_read_b128 a[96:99], v3 offset:34816
v_lshlrev_b32 v50, 16, v13
v_mfma_f32_16x16x32_bf16 a[12:15], a[188:191], a[100:103], a[12:15]
v_and_b32 v51, s39, v13
v_lshlrev_b32 v52, 16, v14
v_mfma_f32_16x16x32_bf16 a[20:23], a[172:175], a[100:103], a[20:23]
ds_read_b128 a[100:103], v3 offset:35840
v_and_b32 v53, s39, v14
v_mfma_f32_16x16x32_bf16 a[20:23], a[188:191], a[104:107], a[20:23]
v_lshlrev_b32 v54, 16, v15
v_and_b32 v55, s39, v15
v_mfma_f32_16x16x32_bf16 a[28:31], a[172:175], a[104:107], a[28:31]
ds_read_b128 a[104:107], v5 offset:32768
v_mfma_f32_16x16x32_bf16 a[28:31], a[188:191], a[108:111], a[28:31]
buffer_load_dwordx4 a[252:255], v9, s[16:19], s69 offen offset:3072 sc1
v_mfma_f32_16x16x32_bf16 a[36:39], a[172:175], a[108:111], a[36:39]
ds_read_b128 a[108:111], v5 offset:33792
v_mfma_f32_16x16x32_bf16 a[36:39], a[188:191], a[112:115], a[36:39]
v_mfma_f32_16x16x32_bf16 v[148:151], a[172:175], a[112:115], v[148:151]
ds_read_b128 a[112:115], v5 offset:34816
v_mfma_f32_16x16x32_bf16 v[148:151], a[188:191], a[116:119], v[148:151]
buffer_load_dwordx4 v[12:15], v1, s[8:11], 0 offen offset:256
v_mfma_f32_16x16x32_bf16 v[156:159], a[172:175], a[116:119], v[156:159]
s_waitcnt vmcnt(24)
ds_read_b128 a[116:119], v5 offset:35840
v_lshlrev_b32 v56, 16, v16
v_mfma_f32_16x16x32_bf16 v[156:159], a[188:191], a[80:83], v[156:159]
v_and_b32 v57, s39, v16
v_lshlrev_b32 v58, 16, v17
v_mfma_f32_16x16x32_bf16 v[164:167], a[172:175], a[80:83], v[164:167]
s_mov_b32 s35, 16384
ds_read_b128 a[80:83], v7 offset:32768
s_mov_b32 s69, 20480
v_mfma_f32_16x16x32_bf16 v[164:167], a[188:191], a[84:87], v[164:167]
s_waitcnt vmcnt(23) lgkmcnt(8)
buffer_load_dwordx4 a[128:131], v9, s[16:19], s35 offen offset:0 sc1
v_mfma_f32_16x16x32_bf16 v[168:171], a[192:195], a[88:91], v[80:83]
s_waitcnt vmcnt(23) lgkmcnt(7)
v_and_b32 v59, s39, v17
v_lshlrev_b32 v60, 16, v18
v_mfma_f32_16x16x32_bf16 v[168:171], a[208:211], a[92:95], v[168:171]
v_and_b32 v61, s39, v18
v_lshlrev_b32 v62, 16, v19
v_mfma_f32_16x16x32_bf16 v[176:179], a[192:195], a[92:95], v[88:91]
s_waitcnt lgkmcnt(6)
v_and_b32 v63, s39, v19
v_mfma_f32_16x16x32_bf16 v[176:179], a[208:211], a[96:99], v[176:179]
buffer_load_dwordx4 v[16:19], v1, s[8:11], 0 offen offset:2304
v_mfma_f32_16x16x32_bf16 v[184:187], a[192:195], a[96:99], v[96:99]
s_waitcnt vmcnt(22) lgkmcnt(5)
s_mov_b32 m0, s6
v_lshlrev_b32 v64, 16, v20
v_mfma_f32_16x16x32_bf16 v[184:187], a[208:211], a[100:103], v[184:187]
v_and_b32 v65, s39, v20
v_sub_f32 v66, v56, v64
v_mfma_f32_16x16x32_bf16 v[192:195], a[192:195], a[100:103], v[104:107]
s_waitcnt lgkmcnt(4)
v_sub_f32 v67, v57, v65
v_cvt_pk_bf16_f32 v69, v66, v67
v_mfma_f32_16x16x32_bf16 v[192:195], a[208:211], a[104:107], v[192:195]
buffer_load_dwordx4 a[144:147], v9, s[16:19], s69 offen offset:0 sc1
v_mfma_f32_16x16x32_bf16 v[200:203], a[192:195], a[104:107], v[112:115]
s_waitcnt lgkmcnt(3)
ds_write_addtid_b32 v69 offset:0
v_mfma_f32_16x16x32_bf16 v[200:203], a[208:211], a[108:111], v[200:203]
v_add_f32 v66, v56, v64
v_add_f32 v67, v57, v65
v_mfma_f32_16x16x32_bf16 v[208:211], a[192:195], a[108:111], v[120:123]
s_waitcnt lgkmcnt(3)
v_cvt_pk_bf16_f32 v70, v66, v67
v_mfma_f32_16x16x32_bf16 v[208:211], a[208:211], a[112:115], v[208:211]
ds_write_addtid_b32 v70 offset:16384
v_mfma_f32_16x16x32_bf16 v[216:219], a[192:195], a[112:115], v[128:131]
s_waitcnt lgkmcnt(3)
v_lshlrev_b32 v64, 16, v21
v_and_b32 v65, s39, v21
v_mfma_f32_16x16x32_bf16 v[216:219], a[208:211], a[116:119], v[216:219]
v_sub_f32 v66, v58, v64
v_sub_f32 v67, v59, v65
v_mfma_f32_16x16x32_bf16 v[224:227], a[192:195], a[116:119], v[136:139]
s_waitcnt lgkmcnt(2)
buffer_load_dwordx4 a[132:135], v9, s[16:19], s35 offen offset:1024 sc1
v_mfma_f32_16x16x32_bf16 v[224:227], a[208:211], a[80:83], v[224:227]
v_cvt_pk_bf16_f32 v71, v66, v67
v_mfma_f32_16x16x32_bf16 v[172:175], a[196:199], a[88:91], v[84:87]
s_waitcnt vmcnt(23)
ds_write_addtid_b32 v71 offset:256
v_mfma_f32_16x16x32_bf16 v[172:175], a[212:215], a[92:95], v[172:175]
v_add_f32 v66, v58, v64
v_add_f32 v67, v59, v65
v_mfma_f32_16x16x32_bf16 v[180:183], a[196:199], a[92:95], v[92:95]
v_cvt_pk_bf16_f32 v72, v66, v67
v_mfma_f32_16x16x32_bf16 v[180:183], a[212:215], a[96:99], v[180:183]
ds_write_addtid_b32 v72 offset:16640
v_mfma_f32_16x16x32_bf16 v[188:191], a[196:199], a[96:99], v[100:103]
v_lshlrev_b32 v64, 16, v22
v_and_b32 v65, s39, v22
v_mfma_f32_16x16x32_bf16 v[188:191], a[212:215], a[100:103], v[188:191]
v_sub_f32 v66, v60, v64
v_sub_f32 v67, v61, v65
v_mfma_f32_16x16x32_bf16 v[196:199], a[196:199], a[100:103], v[108:111]
buffer_load_dwordx4 a[148:151], v9, s[16:19], s69 offen offset:1024 sc1
v_mfma_f32_16x16x32_bf16 v[196:199], a[212:215], a[104:107], v[196:199]
v_cvt_pk_bf16_f32 v73, v66, v67
v_mfma_f32_16x16x32_bf16 v[204:207], a[196:199], a[104:107], v[116:119]
ds_write_addtid_b32 v73 offset:512
v_mfma_f32_16x16x32_bf16 v[204:207], a[212:215], a[108:111], v[204:207]
v_add_f32 v66, v60, v64
v_add_f32 v67, v61, v65
v_mfma_f32_16x16x32_bf16 v[212:215], a[196:199], a[108:111], v[124:127]
v_cvt_pk_bf16_f32 v74, v66, v67
v_mfma_f32_16x16x32_bf16 v[212:215], a[212:215], a[112:115], v[212:215]
ds_write_addtid_b32 v74 offset:16896
v_mfma_f32_16x16x32_bf16 v[220:223], a[196:199], a[112:115], v[132:135]
v_lshlrev_b32 v64, 16, v23
v_and_b32 v65, s39, v23
v_mfma_f32_16x16x32_bf16 v[220:223], a[212:215], a[116:119], v[220:223]
v_sub_f32 v66, v62, v64
v_sub_f32 v67, v63, v65
v_mfma_f32_16x16x32_bf16 v[228:231], a[196:199], a[116:119], v[140:143]
buffer_load_dwordx4 a[136:139], v9, s[16:19], s35 offen offset:2048 sc1
v_mfma_f32_16x16x32_bf16 v[228:231], a[212:215], a[80:83], v[228:231]
s_waitcnt vmcnt(23)
v_cvt_pk_bf16_f32 v75, v66, v67
v_mfma_f32_16x16x32_bf16 a[40:43], a[200:203], a[88:91], a[0:3]
s_waitcnt vmcnt(22)
ds_write_addtid_b32 v75 offset:768
v_mfma_f32_16x16x32_bf16 a[40:43], a[216:219], a[92:95], a[40:43]
v_add_f32 v66, v62, v64
v_add_f32 v67, v63, v65
v_mfma_f32_16x16x32_bf16 a[48:51], a[200:203], a[92:95], a[8:11]
v_cvt_pk_bf16_f32 v68, v66, v67
v_mfma_f32_16x16x32_bf16 a[48:51], a[216:219], a[96:99], a[48:51]
ds_write_addtid_b32 v68 offset:17152
v_mfma_f32_16x16x32_bf16 a[56:59], a[200:203], a[96:99], a[16:19]
buffer_load_dwordx4 v[20:23], v1, s[8:11], 0 offen offset:1280
v_mfma_f32_16x16x32_bf16 a[56:59], a[216:219], a[100:103], a[56:59]
s_mov_b32 m0, s7
v_sub_f32 v66, v48, v56
v_sub_f32 v67, v49, v57
v_mfma_f32_16x16x32_bf16 a[64:67], a[200:203], a[100:103], a[24:27]
v_cvt_pk_bf16_f32 v69, v66, v67
v_mfma_f32_16x16x32_bf16 a[64:67], a[216:219], a[104:107], a[64:67]
ds_write_addtid_b32 v69 offset:28676
v_mfma_f32_16x16x32_bf16 a[72:75], a[200:203], a[104:107], a[32:35]
buffer_load_dwordx4 a[152:155], v9, s[16:19], s69 offen offset:2048 sc1
v_mfma_f32_16x16x32_bf16 a[72:75], a[216:219], a[108:111], a[72:75]
v_sub_f32 v66, v50, v58
v_sub_f32 v67, v51, v59
v_mfma_f32_16x16x32_bf16 v[232:235], a[200:203], a[108:111], v[144:147]
v_cvt_pk_bf16_f32 v70, v66, v67
v_mfma_f32_16x16x32_bf16 v[232:235], a[216:219], a[112:115], v[232:235]
ds_write_addtid_b32 v70 offset:28932
v_mfma_f32_16x16x32_bf16 v[240:243], a[200:203], a[112:115], v[152:155]
v_mfma_f32_16x16x32_bf16 v[240:243], a[216:219], a[116:119], v[240:243]
v_sub_f32 v66, v52, v60
v_sub_f32 v67, v53, v61
v_mfma_f32_16x16x32_bf16 v[248:251], a[200:203], a[116:119], v[160:163]
buffer_load_dwordx4 a[140:143], v9, s[16:19], s35 offen offset:3072 sc1
v_mfma_f32_16x16x32_bf16 v[248:251], a[216:219], a[80:83], v[248:251]
s_waitcnt vmcnt(24)
ds_read_b128 a[84:87], v3 offset:49152
v_cvt_pk_bf16_f32 v71, v66, v67
v_mfma_f32_16x16x32_bf16 a[44:47], a[204:207], a[88:91], a[4:7]
s_waitcnt vmcnt(23)
ds_read_b128 a[88:91], v3 offset:50176
v_mfma_f32_16x16x32_bf16 a[44:47], a[220:223], a[92:95], a[44:47]
ds_write_addtid_b32 v71 offset:29188
v_mfma_f32_16x16x32_bf16 a[52:55], a[204:207], a[92:95], a[12:15]
ds_read_b128 a[92:95], v3 offset:51200
v_sub_f32 v66, v54, v62
v_mfma_f32_16x16x32_bf16 a[52:55], a[220:223], a[96:99], a[52:55]
v_sub_f32 v67, v55, v63
v_cvt_pk_bf16_f32 v72, v66, v67
v_mfma_f32_16x16x32_bf16 a[60:63], a[204:207], a[96:99], a[20:23]
ds_read_b128 a[96:99], v3 offset:52224
v_mfma_f32_16x16x32_bf16 a[60:63], a[220:223], a[100:103], a[60:63]
ds_write_addtid_b32 v72 offset:29444
v_mfma_f32_16x16x32_bf16 a[68:71], a[204:207], a[100:103], a[28:31]
ds_read_b128 a[100:103], v5 offset:49152
v_lshlrev_b32 v48, 16, v24
v_mfma_f32_16x16x32_bf16 a[68:71], a[220:223], a[104:107], a[68:71]
buffer_load_dwordx4 a[156:159], v9, s[16:19], s69 offen offset:3072 sc1
v_mfma_f32_16x16x32_bf16 a[76:79], a[204:207], a[104:107], a[36:39]
ds_read_b128 a[104:107], v5 offset:50176
v_and_b32 v49, s39, v24
v_mfma_f32_16x16x32_bf16 a[76:79], a[220:223], a[108:111], a[76:79]
v_lshlrev_b32 v50, 16, v25
v_and_b32 v51, s39, v25
v_mfma_f32_16x16x32_bf16 v[236:239], a[204:207], a[108:111], v[148:151]
ds_read_b128 a[108:111], v5 offset:51200
v_lshlrev_b32 v52, 16, v26
v_mfma_f32_16x16x32_bf16 v[236:239], a[220:223], a[112:115], v[236:239]
v_and_b32 v53, s39, v26
v_lshlrev_b32 v54, 16, v27
v_mfma_f32_16x16x32_bf16 v[244:247], a[204:207], a[112:115], v[156:159]
ds_read_b128 a[112:115], v5 offset:52224
v_and_b32 v55, s39, v27
v_mfma_f32_16x16x32_bf16 v[244:247], a[220:223], a[116:119], v[244:247]
buffer_load_dwordx4 v[24:27], v2, s[8:11], 0 offen offset:256
v_mfma_f32_16x16x32_bf16 v[252:255], a[204:207], a[116:119], v[164:167]
s_mov_b32 s35, 24576
ds_read_b128 a[116:119], v7 offset:49152
s_mov_b32 s69, 28672
v_mfma_f32_16x16x32_bf16 v[252:255], a[220:223], a[80:83], v[252:255]
s_waitcnt vmcnt(23) lgkmcnt(10)
s_mov_b32 m0, s6
v_lshlrev_b32 v64, 16, v28
v_mfma_f32_16x16x32_bf16 v[80:83], a[224:227], a[84:87], v[80:83]
s_waitcnt vmcnt(21) lgkmcnt(9)
v_and_b32 v65, s39, v28
v_sub_f32 v66, v48, v64
v_mfma_f32_16x16x32_bf16 v[80:83], a[240:243], a[88:91], v[80:83]
buffer_load_dwordx4 a[160:163], v9, s[16:19], s35 offen offset:0 sc1
v_mfma_f32_16x16x32_bf16 v[88:91], a[224:227], a[88:91], v[88:91]
s_waitcnt lgkmcnt(7)
v_sub_f32 v67, v49, v65
v_cvt_pk_bf16_f32 v73, v66, v67
v_mfma_f32_16x16x32_bf16 v[88:91], a[240:243], a[92:95], v[88:91]
ds_write_addtid_b32 v73 offset:1024
v_mfma_f32_16x16x32_bf16 v[96:99], a[224:227], a[92:95], v[96:99]
s_waitcnt lgkmcnt(7)
v_add_f32 v66, v48, v64
v_add_f32 v67, v49, v65
v_mfma_f32_16x16x32_bf16 v[96:99], a[240:243], a[96:99], v[96:99]
v_cvt_pk_bf16_f32 v74, v66, v67
v_mfma_f32_16x16x32_bf16 v[104:107], a[224:227], a[96:99], v[104:107]
s_waitcnt lgkmcnt(5)
buffer_load_dwordx4 a[176:179], v9, s[16:19], s69 offen offset:0 sc1
v_mfma_f32_16x16x32_bf16 v[104:107], a[240:243], a[100:103], v[104:107]
ds_write_addtid_b32 v74 offset:17408
v_mfma_f32_16x16x32_bf16 v[112:115], a[224:227], a[100:103], v[112:115]
s_waitcnt lgkmcnt(5)
v_lshlrev_b32 v64, 16, v29
v_and_b32 v65, s39, v29
v_mfma_f32_16x16x32_bf16 v[112:115], a[240:243], a[104:107], v[112:115]
v_sub_f32 v66, v50, v64
v_sub_f32 v67, v51, v65
v_mfma_f32_16x16x32_bf16 v[120:123], a[224:227], a[104:107], v[120:123]
s_waitcnt lgkmcnt(4)
v_cvt_pk_bf16_f32 v75, v66, v67
v_mfma_f32_16x16x32_bf16 v[120:123], a[240:243], a[108:111], v[120:123]
ds_write_addtid_b32 v75 offset:1280
v_mfma_f32_16x16x32_bf16 v[128:131], a[224:227], a[108:111], v[128:131]
s_waitcnt lgkmcnt(4)
v_add_f32 v66, v50, v64
v_add_f32 v67, v51, v65
v_mfma_f32_16x16x32_bf16 v[128:131], a[240:243], a[112:115], v[128:131]
v_cvt_pk_bf16_f32 v68, v66, v67
v_mfma_f32_16x16x32_bf16 v[136:139], a[224:227], a[112:115], v[136:139]
s_waitcnt lgkmcnt(3)
buffer_load_dwordx4 a[164:167], v9, s[16:19], s35 offen offset:1024 sc1
v_mfma_f32_16x16x32_bf16 v[136:139], a[240:243], a[116:119], v[136:139]
s_waitcnt vmcnt(23)
ds_write_addtid_b32 v68 offset:17664
v_mfma_f32_16x16x32_bf16 v[84:87], a[228:231], a[84:87], v[84:87]
s_waitcnt vmcnt(22)
v_lshlrev_b32 v64, 16, v30
v_and_b32 v65, s39, v30
v_mfma_f32_16x16x32_bf16 v[84:87], a[244:247], a[88:91], v[84:87]
v_sub_f32 v66, v52, v64
v_sub_f32 v67, v53, v65
v_mfma_f32_16x16x32_bf16 v[92:95], a[228:231], a[88:91], v[92:95]
v_cvt_pk_bf16_f32 v69, v66, v67
v_mfma_f32_16x16x32_bf16 v[92:95], a[244:247], a[92:95], v[92:95]
ds_write_addtid_b32 v69 offset:1536
v_mfma_f32_16x16x32_bf16 v[100:103], a[228:231], a[92:95], v[100:103]
v_add_f32 v66, v52, v64
v_add_f32 v67, v53, v65
v_mfma_f32_16x16x32_bf16 v[100:103], a[244:247], a[96:99], v[100:103]
v_cvt_pk_bf16_f32 v70, v66, v67
v_mfma_f32_16x16x32_bf16 v[108:111], a[228:231], a[96:99], v[108:111]
buffer_load_dwordx4 a[180:183], v9, s[16:19], s69 offen offset:1024 sc1
v_mfma_f32_16x16x32_bf16 v[108:111], a[244:247], a[100:103], v[108:111]
ds_write_addtid_b32 v70 offset:17920
v_mfma_f32_16x16x32_bf16 v[116:119], a[228:231], a[100:103], v[116:119]
v_lshlrev_b32 v64, 16, v31
v_and_b32 v65, s39, v31
v_mfma_f32_16x16x32_bf16 v[116:119], a[244:247], a[104:107], v[116:119]
v_sub_f32 v66, v54, v64
v_sub_f32 v67, v55, v65
v_mfma_f32_16x16x32_bf16 v[124:127], a[228:231], a[104:107], v[124:127]
v_cvt_pk_bf16_f32 v71, v66, v67
v_mfma_f32_16x16x32_bf16 v[124:127], a[244:247], a[108:111], v[124:127]
ds_write_addtid_b32 v71 offset:1792
v_mfma_f32_16x16x32_bf16 v[132:135], a[228:231], a[108:111], v[132:135]
v_mfma_f32_16x16x32_bf16 v[132:135], a[244:247], a[112:115], v[132:135]
v_add_f32 v66, v54, v64
v_add_f32 v67, v55, v65
v_mfma_f32_16x16x32_bf16 v[140:143], a[228:231], a[112:115], v[140:143]
buffer_load_dwordx4 a[168:171], v9, s[16:19], s35 offen offset:2048 sc1
v_mfma_f32_16x16x32_bf16 v[140:143], a[244:247], a[116:119], v[140:143]
s_waitcnt vmcnt(23)
v_cvt_pk_bf16_f32 v72, v66, v67
v_mfma_f32_16x16x32_bf16 a[0:3], a[232:235], a[84:87], a[0:3]
s_waitcnt vmcnt(19)
ds_write_addtid_b32 v72 offset:18176
v_mfma_f32_16x16x32_bf16 a[0:3], a[248:251], a[88:91], a[0:3]
v_mfma_f32_16x16x32_bf16 a[8:11], a[232:235], a[88:91], a[8:11]
buffer_load_dwordx4 v[28:31], v1, s[8:11], 0 offen offset:3328
v_mfma_f32_16x16x32_bf16 a[8:11], a[248:251], a[92:95], a[8:11]
s_mov_b32 m0, s7
v_sub_f32 v66, v56, v48
v_sub_f32 v67, v57, v49
v_mfma_f32_16x16x32_bf16 a[16:19], a[232:235], a[92:95], a[16:19]
v_cvt_pk_bf16_f32 v73, v66, v67
v_mfma_f32_16x16x32_bf16 a[16:19], a[248:251], a[96:99], a[16:19]
ds_write_addtid_b32 v73 offset:29700
v_mfma_f32_16x16x32_bf16 a[24:27], a[232:235], a[96:99], a[24:27]
buffer_load_dwordx4 a[184:187], v9, s[16:19], s69 offen offset:2048 sc1
v_mfma_f32_16x16x32_bf16 a[24:27], a[248:251], a[100:103], a[24:27]
v_sub_f32 v66, v58, v50
v_sub_f32 v67, v59, v51
v_mfma_f32_16x16x32_bf16 a[32:35], a[232:235], a[100:103], a[32:35]
v_cvt_pk_bf16_f32 v74, v66, v67
v_mfma_f32_16x16x32_bf16 a[32:35], a[248:251], a[104:107], a[32:35]
ds_write_addtid_b32 v74 offset:29956
v_mfma_f32_16x16x32_bf16 v[144:147], a[232:235], a[104:107], v[144:147]
v_sub_f32 v66, v60, v52
v_sub_f32 v67, v61, v53
v_mfma_f32_16x16x32_bf16 v[144:147], a[248:251], a[108:111], v[144:147]
v_cvt_pk_bf16_f32 v75, v66, v67
v_mfma_f32_16x16x32_bf16 v[152:155], a[232:235], a[108:111], v[152:155]
ds_write_addtid_b32 v75 offset:30212
v_mfma_f32_16x16x32_bf16 v[152:155], a[248:251], a[112:115], v[152:155]
v_sub_f32 v66, v62, v54
v_sub_f32 v67, v63, v55
v_mfma_f32_16x16x32_bf16 v[160:163], a[232:235], a[112:115], v[160:163]
buffer_load_dwordx4 a[172:175], v9, s[16:19], s35 offen offset:3072 sc1
v_mfma_f32_16x16x32_bf16 v[160:163], a[248:251], a[116:119], v[160:163]
s_waitcnt vmcnt(21)
ds_read_b128 a[80:83], v4 offset:32768
v_cvt_pk_bf16_f32 v68, v66, v67
v_mfma_f32_16x16x32_bf16 a[4:7], a[236:239], a[84:87], a[4:7]
s_waitcnt vmcnt(20)
ds_read_b128 a[84:87], v4 offset:33792
v_mfma_f32_16x16x32_bf16 a[4:7], a[252:255], a[88:91], a[4:7]
ds_write_addtid_b32 v68 offset:30468
v_mfma_f32_16x16x32_bf16 a[12:15], a[236:239], a[88:91], a[12:15]
ds_read_b128 a[88:91], v4 offset:34816
v_lshlrev_b32 v56, 16, v32
v_mfma_f32_16x16x32_bf16 a[12:15], a[252:255], a[92:95], a[12:15]
v_and_b32 v57, s39, v32
v_lshlrev_b32 v58, 16, v33
v_mfma_f32_16x16x32_bf16 a[20:23], a[236:239], a[92:95], a[20:23]
ds_read_b128 a[92:95], v4 offset:35840
v_and_b32 v59, s39, v33
v_mfma_f32_16x16x32_bf16 a[20:23], a[252:255], a[96:99], a[20:23]
v_lshlrev_b32 v60, 16, v34
v_and_b32 v61, s39, v34
v_mfma_f32_16x16x32_bf16 a[28:31], a[236:239], a[96:99], a[28:31]
ds_read_b128 a[96:99], v6 offset:32768
v_lshlrev_b32 v62, 16, v35
v_mfma_f32_16x16x32_bf16 a[28:31], a[252:255], a[100:103], a[28:31]
buffer_load_dwordx4 a[188:191], v9, s[16:19], s69 offen offset:3072 sc1
v_mfma_f32_16x16x32_bf16 a[36:39], a[236:239], a[100:103], a[36:39]
ds_read_b128 a[100:103], v6 offset:33792
v_and_b32 v63, s39, v35
v_mfma_f32_16x16x32_bf16 a[36:39], a[252:255], a[104:107], a[36:39]
v_mfma_f32_16x16x32_bf16 v[148:151], a[236:239], a[104:107], v[148:151]
ds_read_b128 a[104:107], v6 offset:34816
v_mfma_f32_16x16x32_bf16 v[148:151], a[252:255], a[108:111], v[148:151]
buffer_load_dwordx4 v[32:35], v2, s[8:11], 0 offen offset:2304
v_mfma_f32_16x16x32_bf16 v[156:159], a[236:239], a[108:111], v[156:159]
s_mov_b32 m0, s6
ds_read_b128 a[108:111], v6 offset:35840
v_lshlrev_b32 v64, 16, v36
v_mfma_f32_16x16x32_bf16 v[156:159], a[252:255], a[112:115], v[156:159]
v_and_b32 v65, s39, v36
v_sub_f32 v66, v56, v64
v_mfma_f32_16x16x32_bf16 v[164:167], a[236:239], a[112:115], v[164:167]
s_mov_b32 s35, 32768
ds_read_b128 a[112:115], v8 offset:32768
s_mov_b32 s69, 36864
v_mfma_f32_16x16x32_bf16 v[164:167], a[252:255], a[116:119], v[164:167]
s_waitcnt vmcnt(20) lgkmcnt(9)
buffer_load_dwordx4 a[192:195], v9, s[16:19], s35 offen offset:0 sc1
v_mfma_f32_16x16x32_bf16 v[168:171], a[128:131], a[80:83], v[168:171]
s_waitcnt vmcnt(19) lgkmcnt(8)
v_sub_f32 v67, v57, v65
v_cvt_pk_bf16_f32 v69, v66, v67
v_mfma_f32_16x16x32_bf16 v[168:171], a[144:147], a[84:87], v[168:171]
ds_write_addtid_b32 v69 offset:2048
v_mfma_f32_16x16x32_bf16 v[176:179], a[128:131], a[84:87], v[176:179]
s_waitcnt lgkmcnt(7)
v_add_f32 v66, v56, v64
v_add_f32 v67, v57, v65
v_mfma_f32_16x16x32_bf16 v[176:179], a[144:147], a[88:91], v[176:179]
v_cvt_pk_bf16_f32 v70, v66, v67
v_mfma_f32_16x16x32_bf16 v[184:187], a[128:131], a[88:91], v[184:187]
s_waitcnt lgkmcnt(6)
ds_write_addtid_b32 v70 offset:18432
v_mfma_f32_16x16x32_bf16 v[184:187], a[144:147], a[92:95], v[184:187]
v_lshlrev_b32 v64, 16, v37
v_and_b32 v65, s39, v37
v_mfma_f32_16x16x32_bf16 v[192:195], a[128:131], a[92:95], v[192:195]
s_waitcnt lgkmcnt(6)
buffer_load_dwordx4 a[208:211], v9, s[16:19], s69 offen offset:0 sc1
v_mfma_f32_16x16x32_bf16 v[192:195], a[144:147], a[96:99], v[192:195]
v_sub_f32 v66, v58, v64
v_sub_f32 v67, v59, v65
v_mfma_f32_16x16x32_bf16 v[200:203], a[128:131], a[96:99], v[200:203]
s_waitcnt lgkmcnt(5)
v_cvt_pk_bf16_f32 v71, v66, v67
v_mfma_f32_16x16x32_bf16 v[200:203], a[144:147], a[100:103], v[200:203]
ds_write_addtid_b32 v71 offset:2304
v_mfma_f32_16x16x32_bf16 v[208:211], a[128:131], a[100:103], v[208:211]
s_waitcnt lgkmcnt(5)
v_add_f32 v66, v58, v64
v_add_f32 v67, v59, v65
v_mfma_f32_16x16x32_bf16 v[208:211], a[144:147], a[104:107], v[208:211]
v_cvt_pk_bf16_f32 v72, v66, v67
v_mfma_f32_16x16x32_bf16 v[216:219], a[128:131], a[104:107], v[216:219]
s_waitcnt lgkmcnt(4)
ds_write_addtid_b32 v72 offset:18688
v_mfma_f32_16x16x32_bf16 v[216:219], a[144:147], a[108:111], v[216:219]
v_lshlrev_b32 v64, 16, v38
v_and_b32 v65, s39, v38
v_mfma_f32_16x16x32_bf16 v[224:227], a[128:131], a[108:111], v[224:227]
s_waitcnt lgkmcnt(4)
buffer_load_dwordx4 a[196:199], v9, s[16:19], s35 offen offset:1024 sc1
v_mfma_f32_16x16x32_bf16 v[224:227], a[144:147], a[112:115], v[224:227]
s_waitcnt vmcnt(20)
v_sub_f32 v66, v60, v64
v_sub_f32 v67, v61, v65
v_mfma_f32_16x16x32_bf16 v[172:175], a[132:135], a[80:83], v[172:175]
s_waitcnt vmcnt(19)
v_cvt_pk_bf16_f32 v73, v66, v67
v_mfma_f32_16x16x32_bf16 v[172:175], a[148:151], a[84:87], v[172:175]
ds_write_addtid_b32 v73 offset:2560
v_mfma_f32_16x16x32_bf16 v[180:183], a[132:135], a[84:87], v[180:183]
v_add_f32 v66, v60, v64
v_add_f32 v67, v61, v65
v_mfma_f32_16x16x32_bf16 v[180:183], a[148:151], a[88:91], v[180:183]
v_cvt_pk_bf16_f32 v74, v66, v67
v_mfma_f32_16x16x32_bf16 v[188:191], a[132:135], a[88:91], v[188:191]
ds_write_addtid_b32 v74 offset:18944
v_mfma_f32_16x16x32_bf16 v[188:191], a[148:151], a[92:95], v[188:191]
v_lshlrev_b32 v64, 16, v39
v_and_b32 v65, s39, v39
v_mfma_f32_16x16x32_bf16 v[196:199], a[132:135], a[92:95], v[196:199]
buffer_load_dwordx4 a[212:215], v9, s[16:19], s69 offen offset:1024 sc1
v_mfma_f32_16x16x32_bf16 v[196:199], a[148:151], a[96:99], v[196:199]
v_sub_f32 v66, v62, v64
v_sub_f32 v67, v63, v65
v_mfma_f32_16x16x32_bf16 v[204:207], a[132:135], a[96:99], v[204:207]
v_cvt_pk_bf16_f32 v75, v66, v67
v_mfma_f32_16x16x32_bf16 v[204:207], a[148:151], a[100:103], v[204:207]
ds_write_addtid_b32 v75 offset:2816
v_mfma_f32_16x16x32_bf16 v[212:215], a[132:135], a[100:103], v[212:215]
v_add_f32 v66, v62, v64
v_add_f32 v67, v63, v65
v_mfma_f32_16x16x32_bf16 v[212:215], a[148:151], a[104:107], v[212:215]
v_cvt_pk_bf16_f32 v68, v66, v67
v_mfma_f32_16x16x32_bf16 v[220:223], a[132:135], a[104:107], v[220:223]
ds_write_addtid_b32 v68 offset:19200
v_mfma_f32_16x16x32_bf16 v[220:223], a[148:151], a[108:111], v[220:223]
v_mfma_f32_16x16x32_bf16 v[228:231], a[132:135], a[108:111], v[228:231]
buffer_load_dwordx4 a[200:203], v9, s[16:19], s35 offen offset:2048 sc1
v_mfma_f32_16x16x32_bf16 v[228:231], a[148:151], a[112:115], v[228:231]
s_waitcnt vmcnt(20)
v_mfma_f32_16x16x32_bf16 a[40:43], a[136:139], a[80:83], a[40:43]
s_waitcnt vmcnt(18)
v_mfma_f32_16x16x32_bf16 a[40:43], a[152:155], a[84:87], a[40:43]
v_mfma_f32_16x16x32_bf16 a[48:51], a[136:139], a[84:87], a[48:51]
buffer_load_dwordx4 v[36:39], v2, s[8:11], 0 offen offset:1280
v_mfma_f32_16x16x32_bf16 a[48:51], a[152:155], a[88:91], a[48:51]
s_mov_b32 m0, s7
v_sub_f32 v66, v48, v56
v_sub_f32 v67, v49, v57
v_mfma_f32_16x16x32_bf16 a[56:59], a[136:139], a[88:91], a[56:59]
v_cvt_pk_bf16_f32 v69, v66, v67
v_mfma_f32_16x16x32_bf16 a[56:59], a[152:155], a[92:95], a[56:59]
ds_write_addtid_b32 v69 offset:30724
v_mfma_f32_16x16x32_bf16 a[64:67], a[136:139], a[92:95], a[64:67]
buffer_load_dwordx4 a[216:219], v9, s[16:19], s69 offen offset:2048 sc1
v_mfma_f32_16x16x32_bf16 a[64:67], a[152:155], a[96:99], a[64:67]
v_sub_f32 v66, v50, v58
v_sub_f32 v67, v51, v59
v_mfma_f32_16x16x32_bf16 a[72:75], a[136:139], a[96:99], a[72:75]
v_cvt_pk_bf16_f32 v70, v66, v67
v_mfma_f32_16x16x32_bf16 a[72:75], a[152:155], a[100:103], a[72:75]
ds_write_addtid_b32 v70 offset:30980
v_mfma_f32_16x16x32_bf16 v[232:235], a[136:139], a[100:103], v[232:235]
v_sub_f32 v66, v52, v60
v_sub_f32 v67, v53, v61
v_mfma_f32_16x16x32_bf16 v[232:235], a[152:155], a[104:107], v[232:235]
v_cvt_pk_bf16_f32 v71, v66, v67
v_mfma_f32_16x16x32_bf16 v[240:243], a[136:139], a[104:107], v[240:243]
ds_write_addtid_b32 v71 offset:31236
v_mfma_f32_16x16x32_bf16 v[240:243], a[152:155], a[108:111], v[240:243]
v_sub_f32 v66, v54, v62
v_sub_f32 v67, v55, v63
v_mfma_f32_16x16x32_bf16 v[248:251], a[136:139], a[108:111], v[248:251]
buffer_load_dwordx4 a[204:207], v9, s[16:19], s35 offen offset:3072 sc1
v_mfma_f32_16x16x32_bf16 v[248:251], a[152:155], a[112:115], v[248:251]
s_waitcnt vmcnt(20)
ds_read_b128 a[116:119], v4 offset:49152
v_cvt_pk_bf16_f32 v72, v66, v67
v_mfma_f32_16x16x32_bf16 a[44:47], a[140:143], a[80:83], a[44:47]
s_waitcnt vmcnt(19)
ds_read_b128 a[80:83], v4 offset:50176
v_mfma_f32_16x16x32_bf16 a[44:47], a[156:159], a[84:87], a[44:47]
ds_write_addtid_b32 v72 offset:31492
v_mfma_f32_16x16x32_bf16 a[52:55], a[140:143], a[84:87], a[52:55]
ds_read_b128 a[84:87], v4 offset:51200
v_lshlrev_b32 v48, 16, v40
v_mfma_f32_16x16x32_bf16 a[52:55], a[156:159], a[88:91], a[52:55]
v_and_b32 v49, s39, v40
v_lshlrev_b32 v50, 16, v41
v_mfma_f32_16x16x32_bf16 a[60:63], a[140:143], a[88:91], a[60:63]
ds_read_b128 a[88:91], v4 offset:52224
v_and_b32 v51, s39, v41
v_mfma_f32_16x16x32_bf16 a[60:63], a[156:159], a[92:95], a[60:63]
v_lshlrev_b32 v52, 16, v42
v_and_b32 v53, s39, v42
v_mfma_f32_16x16x32_bf16 a[68:71], a[140:143], a[92:95], a[68:71]
ds_read_b128 a[92:95], v6 offset:49152
v_lshlrev_b32 v54, 16, v43
v_mfma_f32_16x16x32_bf16 a[68:71], a[156:159], a[96:99], a[68:71]
buffer_load_dwordx4 a[220:223], v9, s[16:19], s69 offen offset:3072 sc1
v_mfma_f32_16x16x32_bf16 a[76:79], a[140:143], a[96:99], a[76:79]
ds_read_b128 a[96:99], v6 offset:50176
v_and_b32 v55, s39, v43
v_mfma_f32_16x16x32_bf16 a[76:79], a[156:159], a[100:103], a[76:79]
v_mfma_f32_16x16x32_bf16 v[236:239], a[140:143], a[100:103], v[236:239]
ds_read_b128 a[100:103], v6 offset:51200
v_mfma_f32_16x16x32_bf16 v[236:239], a[156:159], a[104:107], v[236:239]
buffer_load_dwordx4 v[40:43], v11, s[8:11], 0 offen offset:256
v_mfma_f32_16x16x32_bf16 v[244:247], a[140:143], a[104:107], v[244:247]
s_mov_b32 m0, s6
ds_read_b128 a[104:107], v6 offset:52224
v_lshlrev_b32 v64, 16, v44
v_mfma_f32_16x16x32_bf16 v[244:247], a[156:159], a[108:111], v[244:247]
v_and_b32 v65, s39, v44
v_sub_f32 v66, v48, v64
v_mfma_f32_16x16x32_bf16 v[252:255], a[140:143], a[108:111], v[252:255]
s_mov_b32 s35, 40960
ds_read_b128 a[108:111], v8 offset:49152
s_mov_b32 s69, 45056
v_mfma_f32_16x16x32_bf16 v[252:255], a[156:159], a[112:115], v[252:255]
s_waitcnt vmcnt(19) lgkmcnt(9)
buffer_load_dwordx4 a[224:227], v9, s[16:19], s35 offen offset:0 sc1
v_mfma_f32_16x16x32_bf16 v[80:83], a[160:163], a[116:119], v[80:83]
s_waitcnt vmcnt(19) lgkmcnt(8)
v_sub_f32 v67, v49, v65
v_cvt_pk_bf16_f32 v73, v66, v67
v_mfma_f32_16x16x32_bf16 v[80:83], a[176:179], a[80:83], v[80:83]
ds_write_addtid_b32 v73 offset:3072
v_mfma_f32_16x16x32_bf16 v[88:91], a[160:163], a[80:83], v[88:91]
s_waitcnt lgkmcnt(7)
v_add_f32 v66, v48, v64
v_add_f32 v67, v49, v65
v_mfma_f32_16x16x32_bf16 v[88:91], a[176:179], a[84:87], v[88:91]
s_mov_b32 s37, 0x2000
v_cvt_pk_bf16_f32 v74, v66, v67
v_mfma_f32_16x16x32_bf16 v[96:99], a[160:163], a[84:87], v[96:99]
s_waitcnt lgkmcnt(6)
ds_write_addtid_b32 v74 offset:19456
v_mfma_f32_16x16x32_bf16 v[96:99], a[176:179], a[88:91], v[96:99]
v_lshlrev_b32 v64, 16, v45
v_and_b32 v65, s39, v45
v_mfma_f32_16x16x32_bf16 v[104:107], a[160:163], a[88:91], v[104:107]
s_waitcnt lgkmcnt(6)
buffer_load_dwordx4 a[240:243], v9, s[16:19], s69 offen offset:0 sc1
v_mfma_f32_16x16x32_bf16 v[104:107], a[176:179], a[92:95], v[104:107]
v_sub_f32 v66, v50, v64
v_sub_f32 v67, v51, v65
v_mfma_f32_16x16x32_bf16 v[112:115], a[160:163], a[92:95], v[112:115]
s_waitcnt lgkmcnt(5)
v_cvt_pk_bf16_f32 v75, v66, v67
v_mfma_f32_16x16x32_bf16 v[112:115], a[176:179], a[96:99], v[112:115]
ds_write_addtid_b32 v75 offset:3328
v_mfma_f32_16x16x32_bf16 v[120:123], a[160:163], a[96:99], v[120:123]
s_waitcnt lgkmcnt(5)
v_add_f32 v66, v50, v64
v_add_f32 v67, v51, v65
v_mfma_f32_16x16x32_bf16 v[120:123], a[176:179], a[100:103], v[120:123]
s_mov_b32 s38, 0x3000
v_cvt_pk_bf16_f32 v68, v66, v67
v_mfma_f32_16x16x32_bf16 v[128:131], a[160:163], a[100:103], v[128:131]
s_waitcnt lgkmcnt(4)
ds_write_addtid_b32 v68 offset:19712
v_mfma_f32_16x16x32_bf16 v[128:131], a[176:179], a[104:107], v[128:131]
v_lshlrev_b32 v64, 16, v46
v_and_b32 v65, s39, v46
v_mfma_f32_16x16x32_bf16 v[136:139], a[160:163], a[104:107], v[136:139]
s_waitcnt lgkmcnt(4)
v_sub_f32 v66, v52, v64
v_sub_f32 v67, v53, v65
v_mfma_f32_16x16x32_bf16 v[136:139], a[176:179], a[108:111], v[136:139]
s_waitcnt vmcnt(19)
buffer_load_dwordx4 a[228:231], v9, s[16:19], s35 offen offset:1024 sc1
v_mfma_f32_16x16x32_bf16 v[84:87], a[164:167], a[116:119], v[84:87]
s_waitcnt vmcnt(19)
v_cvt_pk_bf16_f32 v69, v66, v67
v_mfma_f32_16x16x32_bf16 v[84:87], a[180:183], a[80:83], v[84:87]
ds_write_addtid_b32 v69 offset:3584
v_mfma_f32_16x16x32_bf16 v[92:95], a[164:167], a[80:83], v[92:95]
v_add_f32 v66, v52, v64
v_add_f32 v67, v53, v65
v_mfma_f32_16x16x32_bf16 v[92:95], a[180:183], a[84:87], v[92:95]
s_mov_b32 s50, 0x7fffffff
v_cvt_pk_bf16_f32 v70, v66, v67
v_mfma_f32_16x16x32_bf16 v[100:103], a[164:167], a[84:87], v[100:103]
ds_write_addtid_b32 v70 offset:19968
v_mfma_f32_16x16x32_bf16 v[100:103], a[180:183], a[88:91], v[100:103]
v_lshlrev_b32 v64, 16, v47
v_and_b32 v65, s39, v47
v_mfma_f32_16x16x32_bf16 v[108:111], a[164:167], a[88:91], v[108:111]
v_sub_f32 v66, v54, v64
v_sub_f32 v67, v55, v65
v_mfma_f32_16x16x32_bf16 v[108:111], a[180:183], a[92:95], v[108:111]
v_cvt_pk_bf16_f32 v71, v66, v67
v_mfma_f32_16x16x32_bf16 v[116:119], a[164:167], a[92:95], v[116:119]
ds_write_addtid_b32 v71 offset:3840
v_mfma_f32_16x16x32_bf16 v[116:119], a[180:183], a[96:99], v[116:119]
buffer_load_dwordx4 a[244:247], v9, s[16:19], s69 offen offset:1024 sc1
v_mfma_f32_16x16x32_bf16 v[124:127], a[164:167], a[96:99], v[124:127]
v_add_f32 v66, v54, v64
v_add_f32 v67, v55, v65
v_mfma_f32_16x16x32_bf16 v[124:127], a[180:183], a[100:103], v[124:127]
s_mov_b32 s42, 0x3fb8aa3b
v_cvt_pk_bf16_f32 v72, v66, v67
v_mfma_f32_16x16x32_bf16 v[132:135], a[164:167], a[100:103], v[132:135]
ds_write_addtid_b32 v72 offset:20224
v_mfma_f32_16x16x32_bf16 v[132:135], a[180:183], a[104:107], v[132:135]
buffer_load_dwordx4 v[44:47], v2, s[8:11], 0 offen offset:3328
v_mfma_f32_16x16x32_bf16 v[140:143], a[164:167], a[104:107], v[140:143]
s_mov_b32 m0, s7
v_sub_f32 v66, v56, v48
v_sub_f32 v67, v57, v49
v_mfma_f32_16x16x32_bf16 v[140:143], a[180:183], a[108:111], v[140:143]
s_waitcnt vmcnt(20)
v_cvt_pk_bf16_f32 v73, v66, v67
v_mfma_f32_16x16x32_bf16 a[0:3], a[168:171], a[116:119], a[0:3]
s_waitcnt vmcnt(18)
ds_write_addtid_b32 v73 offset:31748
v_mfma_f32_16x16x32_bf16 a[0:3], a[184:187], a[80:83], a[0:3]
v_sub_f32 v66, v58, v50
v_sub_f32 v67, v59, v51
v_mfma_f32_16x16x32_bf16 a[8:11], a[168:171], a[80:83], a[8:11]
v_cvt_pk_bf16_f32 v74, v66, v67
v_mfma_f32_16x16x32_bf16 a[8:11], a[184:187], a[84:87], a[8:11]
s_mov_b32 s43, 0x3fb8aa3b
ds_write_addtid_b32 v74 offset:32004
v_mfma_f32_16x16x32_bf16 a[16:19], a[168:171], a[84:87], a[16:19]
buffer_load_dwordx4 a[232:235], v9, s[16:19], s35 offen offset:2048 sc1
v_mfma_f32_16x16x32_bf16 a[16:19], a[184:187], a[88:91], a[16:19]
v_sub_f32 v66, v60, v52
v_sub_f32 v67, v61, v53
v_mfma_f32_16x16x32_bf16 a[24:27], a[168:171], a[88:91], a[24:27]
v_cvt_pk_bf16_f32 v75, v66, v67
v_mfma_f32_16x16x32_bf16 a[24:27], a[184:187], a[92:95], a[24:27]
ds_write_addtid_b32 v75 offset:32260
v_mfma_f32_16x16x32_bf16 a[32:35], a[168:171], a[92:95], a[32:35]
v_sub_f32 v66, v62, v54
v_sub_f32 v67, v63, v55
v_mfma_f32_16x16x32_bf16 a[32:35], a[184:187], a[96:99], a[32:35]
v_cvt_pk_bf16_f32 v68, v66, v67
v_mfma_f32_16x16x32_bf16 v[144:147], a[168:171], a[96:99], v[144:147]
ds_write_addtid_b32 v68 offset:32516
v_mfma_f32_16x16x32_bf16 v[144:147], a[184:187], a[100:103], v[144:147]
s_mov_b32 s44, 0xbf38aa3b
buffer_load_dwordx4 a[248:251], v9, s[16:19], s69 offen offset:2048 sc1
v_mfma_f32_16x16x32_bf16 v[152:155], a[168:171], a[100:103], v[152:155]
v_mfma_f32_16x16x32_bf16 v[152:155], a[184:187], a[104:107], v[152:155]
v_mfma_f32_16x16x32_bf16 v[160:163], a[168:171], a[104:107], v[160:163]
s_waitcnt lgkmcnt(0)
s_barrier
v_mfma_f32_16x16x32_bf16 v[160:163], a[184:187], a[108:111], v[160:163]
s_waitcnt vmcnt(19)
ds_read_b128 a[112:115], v3 offset:0
v_lshlrev_b32 v48, 16, v12
v_mfma_f32_16x16x32_bf16 a[4:7], a[172:175], a[116:119], a[4:7]
s_waitcnt vmcnt(18)
ds_read_b128 a[116:119], v3 offset:1024
v_and_b32 v49, s39, v12
v_mfma_f32_16x16x32_bf16 a[4:7], a[188:191], a[80:83], a[4:7]
buffer_load_dwordx4 a[236:239], v9, s[16:19], s35 offen offset:3072 sc1
v_mfma_f32_16x16x32_bf16 a[12:15], a[172:175], a[80:83], a[12:15]
ds_read_b128 a[80:83], v3 offset:2048
v_lshlrev_b32 v50, 16, v13
v_mfma_f32_16x16x32_bf16 a[12:15], a[188:191], a[84:87], a[12:15]
s_mov_b32 s45, 0xbf38aa3b
v_and_b32 v51, s39, v13
v_lshlrev_b32 v52, 16, v14
v_mfma_f32_16x16x32_bf16 a[20:23], a[172:175], a[84:87], a[20:23]
ds_read_b128 a[84:87], v3 offset:3072
v_and_b32 v53, s39, v14
v_mfma_f32_16x16x32_bf16 a[20:23], a[188:191], a[88:91], a[20:23]
v_lshlrev_b32 v54, 16, v15
v_and_b32 v55, s39, v15
v_mfma_f32_16x16x32_bf16 a[28:31], a[172:175], a[88:91], a[28:31]
ds_read_b128 a[88:91], v5 offset:0
v_mfma_f32_16x16x32_bf16 a[28:31], a[188:191], a[92:95], a[28:31]
buffer_load_dwordx4 a[252:255], v9, s[16:19], s69 offen offset:3072 sc1
v_mfma_f32_16x16x32_bf16 a[36:39], a[172:175], a[92:95], a[36:39]
s_mov_b32 s60, L_sd2-L_pc
ds_read_b128 a[92:95], v5 offset:1024
v_mfma_f32_16x16x32_bf16 a[36:39], a[188:191], a[96:99], a[36:39]
buffer_load_dword a124, v10, s[64:67], s60 offen
v_mfma_f32_16x16x32_bf16 v[148:151], a[172:175], a[96:99], v[148:151]
ds_read_b128 a[96:99], v5 offset:2048
v_mfma_f32_16x16x32_bf16 v[148:151], a[188:191], a[100:103], v[148:151]
s_mov_b32 s46, 0x4038aa3b
v_mfma_f32_16x16x32_bf16 v[156:159], a[172:175], a[100:103], v[156:159]
ds_read_b128 a[100:103], v5 offset:3072
v_mfma_f32_16x16x32_bf16 v[156:159], a[188:191], a[104:107], v[156:159]
buffer_load_dwordx4 v[12:15], v1, s[8:11], 0 offen offset:384
v_mfma_f32_16x16x32_bf16 v[164:167], a[172:175], a[104:107], v[164:167]
s_mov_b32 s35, 49152
ds_read_b128 a[104:107], v7 offset:0
s_mov_b32 s69, 53248
v_mfma_f32_16x16x32_bf16 v[164:167], a[188:191], a[108:111], v[164:167]
s_waitcnt vmcnt(20) lgkmcnt(8)
v_lshlrev_b32 v56, 16, v16
v_and_b32 v57, s39, v16
v_mfma_f32_16x16x32_bf16 v[168:171], a[192:195], a[112:115], v[168:171]
s_waitcnt vmcnt(19) lgkmcnt(7)
v_lshlrev_b32 v58, 16, v17
v_and_b32 v59, s39, v17
v_mfma_f32_16x16x32_bf16 v[168:171], a[208:211], a[116:119], v[168:171]
buffer_load_dwordx4 a[128:131], v9, s[16:19], s35 offen offset:0 sc1
v_mfma_f32_16x16x32_bf16 v[176:179], a[192:195], a[116:119], v[176:179]
s_waitcnt lgkmcnt(6)
v_lshlrev_b32 v60, 16, v18
v_and_b32 v61, s39, v18
v_mfma_f32_16x16x32_bf16 v[176:179], a[208:211], a[80:83], v[176:179]
s_mov_b32 s47, 0x4038aa3b
v_lshlrev_b32 v62, 16, v19
v_and_b32 v63, s39, v19
v_mfma_f32_16x16x32_bf16 v[184:187], a[192:195], a[80:83], v[184:187]
s_waitcnt lgkmcnt(5)
v_mfma_f32_16x16x32_bf16 v[184:187], a[208:211], a[84:87], v[184:187]
buffer_load_dwordx4 v[16:19], v1, s[8:11], 0 offen offset:2432
v_mfma_f32_16x16x32_bf16 v[192:195], a[192:195], a[84:87], v[192:195]
s_waitcnt lgkmcnt(4)
s_mov_b32 m0, s6
v_lshlrev_b32 v64, 16, v20
v_mfma_f32_16x16x32_bf16 v[192:195], a[208:211], a[88:91], v[192:195]
v_and_b32 v65, s39, v20
v_sub_f32 v66, v56, v64
v_mfma_f32_16x16x32_bf16 v[200:203], a[192:195], a[88:91], v[200:203]
s_waitcnt lgkmcnt(3)
v_sub_f32 v67, v57, v65
v_cvt_pk_bf16_f32 v69, v66, v67
v_mfma_f32_16x16x32_bf16 v[200:203], a[208:211], a[92:95], v[200:203]
buffer_load_dwordx4 a[144:147], v9, s[16:19], s69 offen offset:0 sc1
v_mfma_f32_16x16x32_bf16 v[208:211], a[192:195], a[92:95], v[208:211]
s_waitcnt lgkmcnt(2)
ds_write_addtid_b32 v69 offset:32768
v_mfma_f32_16x16x32_bf16 v[208:211], a[208:211], a[96:99], v[208:211]
s_mov_b32 s48, 0xbfb8aa3b
v_add_f32 v66, v56, v64
v_add_f32 v67, v57, v65
v_mfma_f32_16x16x32_bf16 v[216:219], a[192:195], a[96:99], v[216:219]
s_waitcnt lgkmcnt(2)
v_cvt_pk_bf16_f32 v70, v66, v67
v_mfma_f32_16x16x32_bf16 v[216:219], a[208:211], a[100:103], v[216:219]
ds_write_addtid_b32 v70 offset:49152
v_mfma_f32_16x16x32_bf16 v[224:227], a[192:195], a[100:103], v[224:227]
s_waitcnt lgkmcnt(2)
buffer_load_dwordx4 a[132:135], v9, s[16:19], s35 offen offset:1024 sc1
v_mfma_f32_16x16x32_bf16 v[224:227], a[208:211], a[104:107], v[224:227]
s_waitcnt vmcnt(22)
v_lshlrev_b32 v64, 16, v21
v_and_b32 v65, s39, v21
v_mfma_f32_16x16x32_bf16 v[172:175], a[196:199], a[112:115], v[172:175]
s_waitcnt vmcnt(21)
v_sub_f32 v66, v58, v64
v_sub_f32 v67, v59, v65
v_mfma_f32_16x16x32_bf16 v[172:175], a[212:215], a[116:119], v[172:175]
v_cvt_pk_bf16_f32 v71, v66, v67
v_mfma_f32_16x16x32_bf16 v[180:183], a[196:199], a[116:119], v[180:183]
ds_write_addtid_b32 v71 offset:33024
v_mfma_f32_16x16x32_bf16 v[180:183], a[212:215], a[80:83], v[180:183]
s_mov_b32 s49, 0xbfb8aa3b
v_add_f32 v66, v58, v64
v_add_f32 v67, v59, v65
v_mfma_f32_16x16x32_bf16 v[188:191], a[196:199], a[80:83], v[188:191]
v_cvt_pk_bf16_f32 v72, v66, v67
v_mfma_f32_16x16x32_bf16 v[188:191], a[212:215], a[84:87], v[188:191]
ds_write_addtid_b32 v72 offset:49408
v_mfma_f32_16x16x32_bf16 v[196:199], a[196:199], a[84:87], v[196:199]
buffer_load_dwordx4 a[148:151], v9, s[16:19], s69 offen offset:1024 sc1
v_mfma_f32_16x16x32_bf16 v[196:199], a[212:215], a[88:91], v[196:199]
v_lshlrev_b32 v64, 16, v22
v_and_b32 v65, s39, v22
v_mfma_f32_16x16x32_bf16 v[204:207], a[196:199], a[88:91], v[204:207]
v_sub_f32 v66, v60, v64
v_sub_f32 v67, v61, v65
v_mfma_f32_16x16x32_bf16 v[204:207], a[212:215], a[92:95], v[204:207]
v_cvt_pk_bf16_f32 v73, v66, v67
v_mfma_f32_16x16x32_bf16 v[212:215], a[196:199], a[92:95], v[212:215]
ds_write_addtid_b32 v73 offset:33280
v_mfma_f32_16x16x32_bf16 v[212:215], a[212:215], a[96:99], v[212:215]
v_add_f32 v66, v60, v64
v_add_f32 v67, v61, v65
v_mfma_f32_16x16x32_bf16 v[220:223], a[196:199], a[96:99], v[220:223]
v_cvt_pk_bf16_f32 v74, v66, v67
v_mfma_f32_16x16x32_bf16 v[220:223], a[212:215], a[100:103], v[220:223]
ds_write_addtid_b32 v74 offset:49664
v_mfma_f32_16x16x32_bf16 v[228:231], a[196:199], a[100:103], v[228:231]
buffer_load_dwordx4 a[136:139], v9, s[16:19], s35 offen offset:2048 sc1
v_mfma_f32_16x16x32_bf16 v[228:231], a[212:215], a[104:107], v[228:231]
s_waitcnt vmcnt(22)
v_lshlrev_b32 v64, 16, v23
v_and_b32 v65, s39, v23
v_mfma_f32_16x16x32_bf16 a[40:43], a[200:203], a[112:115], a[40:43]
s_waitcnt vmcnt(20)
v_sub_f32 v66, v62, v64
v_sub_f32 v67, v63, v65
v_mfma_f32_16x16x32_bf16 a[40:43], a[216:219], a[116:119], a[40:43]
v_cvt_pk_bf16_f32 v75, v66, v67
v_mfma_f32_16x16x32_bf16 a[48:51], a[200:203], a[116:119], a[48:51]
ds_write_addtid_b32 v75 offset:33536
v_mfma_f32_16x16x32_bf16 a[48:51], a[216:219], a[80:83], a[48:51]
v_add_f32 v66, v62, v64
v_add_f32 v67, v63, v65
v_mfma_f32_16x16x32_bf16 a[56:59], a[200:203], a[80:83], a[56:59]
v_cvt_pk_bf16_f32 v68, v66, v67
v_mfma_f32_16x16x32_bf16 a[56:59], a[216:219], a[84:87], a[56:59]
ds_write_addtid_b32 v68 offset:49920
v_mfma_f32_16x16x32_bf16 a[64:67], a[200:203], a[84:87], a[64:67]
buffer_load_dwordx4 a[152:155], v9, s[16:19], s69 offen offset:2048 sc1
v_mfma_f32_16x16x32_bf16 a[64:67], a[216:219], a[88:91], a[64:67]
v_mfma_f32_16x16x32_bf16 a[72:75], a[200:203], a[88:91], a[72:75]
v_mfma_f32_16x16x32_bf16 a[72:75], a[216:219], a[92:95], a[72:75]
v_mfma_f32_16x16x32_bf16 v[232:235], a[200:203], a[92:95], v[232:235]
buffer_load_dwordx4 v[20:23], v1, s[8:11], 0 offen offset:1408
v_mfma_f32_16x16x32_bf16 v[232:235], a[216:219], a[96:99], v[232:235]
s_mov_b32 m0, s7
v_sub_f32 v66, v48, v56
v_sub_f32 v67, v49, v57
v_mfma_f32_16x16x32_bf16 v[240:243], a[200:203], a[96:99], v[240:243]
v_cvt_pk_bf16_f32 v69, v66, v67
v_mfma_f32_16x16x32_bf16 v[240:243], a[216:219], a[100:103], v[240:243]
ds_write_addtid_b32 v69 offset:45060
v_mfma_f32_16x16x32_bf16 v[248:251], a[200:203], a[100:103], v[248:251]
buffer_load_dwordx4 a[140:143], v9, s[16:19], s35 offen offset:3072 sc1
v_mfma_f32_16x16x32_bf16 v[248:251], a[216:219], a[104:107], v[248:251]
s_waitcnt vmcnt(22)
ds_read_b128 a[108:111], v3 offset:16384
v_sub_f32 v66, v50, v58
v_mfma_f32_16x16x32_bf16 a[44:47], a[204:207], a[112:115], a[44:47]
s_waitcnt vmcnt(21)
ds_read_b128 a[112:115], v3 offset:17408
v_sub_f32 v67, v51, v59
v_mfma_f32_16x16x32_bf16 a[44:47], a[220:223], a[116:119], a[44:47]
v_cvt_pk_bf16_f32 v70, v66, v67
v_mfma_f32_16x16x32_bf16 a[52:55], a[204:207], a[116:119], a[52:55]
ds_read_b128 a[116:119], v3 offset:18432
v_mfma_f32_16x16x32_bf16 a[52:55], a[220:223], a[80:83], a[52:55]
ds_write_addtid_b32 v70 offset:45316
v_mfma_f32_16x16x32_bf16 a[60:63], a[204:207], a[80:83], a[60:63]
ds_read_b128 a[80:83], v3 offset:19456
v_sub_f32 v66, v52, v60
v_mfma_f32_16x16x32_bf16 a[60:63], a[220:223], a[84:87], a[60:63]
v_sub_f32 v67, v53, v61
v_cvt_pk_bf16_f32 v71, v66, v67
v_mfma_f32_16x16x32_bf16 a[68:71], a[204:207], a[84:87], a[68:71]
ds_read_b128 a[84:87], v5 offset:16384
v_mfma_f32_16x16x32_bf16 a[68:71], a[220:223], a[88:91], a[68:71]
buffer_load_dwordx4 a[156:159], v9, s[16:19], s69 offen offset:3072 sc1
v_mfma_f32_16x16x32_bf16 a[76:79], a[204:207], a[88:91], a[76:79]
ds_read_b128 a[88:91], v5 offset:17408
v_mfma_f32_16x16x32_bf16 a[76:79], a[220:223], a[92:95], a[76:79]
ds_write_addtid_b32 v71 offset:45572
v_mfma_f32_16x16x32_bf16 v[236:239], a[204:207], a[92:95], v[236:239]
ds_read_b128 a[92:95], v5 offset:18432
v_sub_f32 v66, v54, v62
v_mfma_f32_16x16x32_bf16 v[236:239], a[220:223], a[96:99], v[236:239]
v_sub_f32 v67, v55, v63
v_cvt_pk_bf16_f32 v72, v66, v67
v_mfma_f32_16x16x32_bf16 v[244:247], a[204:207], a[96:99], v[244:247]
ds_read_b128 a[96:99], v5 offset:19456
v_mfma_f32_16x16x32_bf16 v[244:247], a[220:223], a[100:103], v[244:247]
ds_write_addtid_b32 v72 offset:45828
v_mfma_f32_16x16x32_bf16 v[252:255], a[204:207], a[100:103], v[252:255]
s_mov_b32 s35, 57344
ds_read_b128 a[100:103], v7 offset:16384
s_mov_b32 s69, 61440
v_mfma_f32_16x16x32_bf16 v[252:255], a[220:223], a[104:107], v[252:255]
s_waitcnt vmcnt(20) lgkmcnt(11)
buffer_load_dwordx4 a[160:163], v9, s[16:19], s35 offen offset:0 sc1
v_mfma_f32_16x16x32_bf16 v[80:83], a[224:227], a[108:111], v[80:83]
s_waitcnt vmcnt(20) lgkmcnt(10)
v_lshlrev_b32 v48, 16, v24
v_and_b32 v49, s39, v24
v_mfma_f32_16x16x32_bf16 v[80:83], a[240:243], a[112:115], v[80:83]
v_lshlrev_b32 v50, 16, v25
v_and_b32 v51, s39, v25
v_mfma_f32_16x16x32_bf16 v[88:91], a[224:227], a[112:115], v[88:91]
s_waitcnt lgkmcnt(9)
v_lshlrev_b32 v52, 16, v26
v_and_b32 v53, s39, v26
v_mfma_f32_16x16x32_bf16 v[88:91], a[240:243], a[116:119], v[88:91]
v_lshlrev_b32 v54, 16, v27
v_and_b32 v55, s39, v27
v_mfma_f32_16x16x32_bf16 v[96:99], a[224:227], a[116:119], v[96:99]
s_waitcnt lgkmcnt(7)
buffer_load_dwordx4 v[24:27], v2, s[8:11], 0 offen offset:384
v_mfma_f32_16x16x32_bf16 v[96:99], a[240:243], a[80:83], v[96:99]
s_mov_b32 m0, s6
v_lshlrev_b32 v64, 16, v28
v_and_b32 v65, s39, v28
v_mfma_f32_16x16x32_bf16 v[104:107], a[224:227], a[80:83], v[104:107]
s_waitcnt lgkmcnt(6)
v_sub_f32 v66, v48, v64
v_sub_f32 v67, v49, v65
v_mfma_f32_16x16x32_bf16 v[104:107], a[240:243], a[84:87], v[104:107]
v_cvt_pk_bf16_f32 v73, v66, v67
v_mfma_f32_16x16x32_bf16 v[112:115], a[224:227], a[84:87], v[112:115]
s_waitcnt lgkmcnt(5)
buffer_load_dwordx4 a[176:179], v9, s[16:19], s69 offen offset:0 sc1
v_mfma_f32_16x16x32_bf16 v[112:115], a[240:243], a[88:91], v[112:115]
ds_write_addtid_b32 v73 offset:33792
v_mfma_f32_16x16x32_bf16 v[120:123], a[224:227], a[88:91], v[120:123]
s_waitcnt lgkmcnt(4)
v_add_f32 v66, v48, v64
v_add_f32 v67, v49, v65
v_mfma_f32_16x16x32_bf16 v[120:123], a[240:243], a[92:95], v[120:123]
v_cvt_pk_bf16_f32 v74, v66, v67
v_mfma_f32_16x16x32_bf16 v[128:131], a[224:227], a[92:95], v[128:131]
s_waitcnt lgkmcnt(3)
ds_write_addtid_b32 v74 offset:50176
v_mfma_f32_16x16x32_bf16 v[128:131], a[240:243], a[96:99], v[128:131]
v_lshlrev_b32 v64, 16, v29
v_and_b32 v65, s39, v29
v_mfma_f32_16x16x32_bf16 v[136:139], a[224:227], a[96:99], v[136:139]
s_waitcnt lgkmcnt(2)
buffer_load_dwordx4 a[164:167], v9, s[16:19], s35 offen offset:1024 sc1
v_mfma_f32_16x16x32_bf16 v[136:139], a[240:243], a[100:103], v[136:139]
s_waitcnt vmcnt(22)
v_sub_f32 v66, v50, v64
v_sub_f32 v67, v51, v65
v_mfma_f32_16x16x32_bf16 v[84:87], a[228:231], a[108:111], v[84:87]
s_waitcnt vmcnt(21)
v_cvt_pk_bf16_f32 v75, v66, v67
v_mfma_f32_16x16x32_bf16 v[84:87], a[244:247], a[112:115], v[84:87]
ds_write_addtid_b32 v75 offset:34048
v_mfma_f32_16x16x32_bf16 v[92:95], a[228:231], a[112:115], v[92:95]
v_add_f32 v66, v50, v64
v_add_f32 v67, v51, v65
v_mfma_f32_16x16x32_bf16 v[92:95], a[244:247], a[116:119], v[92:95]
v_cvt_pk_bf16_f32 v68, v66, v67
v_mfma_f32_16x16x32_bf16 v[100:103], a[228:231], a[116:119], v[100:103]
ds_write_addtid_b32 v68 offset:50432
v_mfma_f32_16x16x32_bf16 v[100:103], a[244:247], a[80:83], v[100:103]
v_lshlrev_b32 v64, 16, v30
v_and_b32 v65, s39, v30
v_mfma_f32_16x16x32_bf16 v[108:111], a[228:231], a[80:83], v[108:111]
buffer_load_dwordx4 a[180:183], v9, s[16:19], s69 offen offset:1024 sc1
v_mfma_f32_16x16x32_bf16 v[108:111], a[244:247], a[84:87], v[108:111]
v_sub_f32 v66, v52, v64
v_sub_f32 v67, v53, v65
v_mfma_f32_16x16x32_bf16 v[116:119], a[228:231], a[84:87], v[116:119]
v_cvt_pk_bf16_f32 v69, v66, v67
v_mfma_f32_16x16x32_bf16 v[116:119], a[244:247], a[88:91], v[116:119]
ds_write_addtid_b32 v69 offset:34304
v_mfma_f32_16x16x32_bf16 v[124:127], a[228:231], a[88:91], v[124:127]
v_add_f32 v66, v52, v64
v_add_f32 v67, v53, v65
v_mfma_f32_16x16x32_bf16 v[124:127], a[244:247], a[92:95], v[124:127]
v_cvt_pk_bf16_f32 v70, v66, v67
v_mfma_f32_16x16x32_bf16 v[132:135], a[228:231], a[92:95], v[132:135]
ds_write_addtid_b32 v70 offset:50688
v_mfma_f32_16x16x32_bf16 v[132:135], a[244:247], a[96:99], v[132:135]
v_lshlrev_b32 v64, 16, v31
v_and_b32 v65, s39, v31
v_mfma_f32_16x16x32_bf16 v[140:143], a[228:231], a[96:99], v[140:143]
buffer_load_dwordx4 a[168:171], v9, s[16:19], s35 offen offset:2048 sc1
v_mfma_f32_16x16x32_bf16 v[140:143], a[244:247], a[100:103], v[140:143]
s_waitcnt vmcnt(21)
v_sub_f32 v66, v54, v64
v_sub_f32 v67, v55, v65
v_mfma_f32_16x16x32_bf16 a[0:3], a[232:235], a[108:111], a[0:3]
s_waitcnt vmcnt(20)
v_cvt_pk_bf16_f32 v71, v66, v67
v_mfma_f32_16x16x32_bf16 a[0:3], a[248:251], a[112:115], a[0:3]
ds_write_addtid_b32 v71 offset:34560
v_mfma_f32_16x16x32_bf16 a[8:11], a[232:235], a[112:115], a[8:11]
v_add_f32 v66, v54, v64
v_add_f32 v67, v55, v65
v_mfma_f32_16x16x32_bf16 a[8:11], a[248:251], a[116:119], a[8:11]
v_cvt_pk_bf16_f32 v72, v66, v67
v_mfma_f32_16x16x32_bf16 a[16:19], a[232:235], a[116:119], a[16:19]
ds_write_addtid_b32 v72 offset:50944
v_mfma_f32_16x16x32_bf16 a[16:19], a[248:251], a[80:83], a[16:19]
buffer_load_dwordx4 v[28:31], v1, s[8:11], 0 offen offset:3456
v_mfma_f32_16x16x32_bf16 a[24:27], a[232:235], a[80:83], a[24:27]
s_mov_b32 m0, s7
v_sub_f32 v66, v56, v48
v_sub_f32 v67, v57, v49
v_mfma_f32_16x16x32_bf16 a[24:27], a[248:251], a[84:87], a[24:27]
v_cvt_pk_bf16_f32 v73, v66, v67
v_mfma_f32_16x16x32_bf16 a[32:35], a[232:235], a[84:87], a[32:35]
ds_write_addtid_b32 v73 offset:46084
v_mfma_f32_16x16x32_bf16 a[32:35], a[248:251], a[88:91], a[32:35]
buffer_load_dwordx4 a[184:187], v9, s[16:19], s69 offen offset:2048 sc1
v_mfma_f32_16x16x32_bf16 v[144:147], a[232:235], a[88:91], v[144:147]
v_sub_f32 v66, v58, v50
v_sub_f32 v67, v59, v51
v_mfma_f32_16x16x32_bf16 v[144:147], a[248:251], a[92:95], v[144:147]
v_cvt_pk_bf16_f32 v74, v66, v67
v_mfma_f32_16x16x32_bf16 v[152:155], a[232:235], a[92:95], v[152:155]
ds_write_addtid_b32 v74 offset:46340
v_mfma_f32_16x16x32_bf16 v[152:155], a[248:251], a[96:99], v[152:155]
v_sub_f32 v66, v60, v52
v_sub_f32 v67, v61, v53
v_mfma_f32_16x16x32_bf16 v[160:163], a[232:235], a[96:99], v[160:163]
buffer_load_dwordx4 a[172:175], v9, s[16:19], s35 offen offset:3072 sc1
v_mfma_f32_16x16x32_bf16 v[160:163], a[248:251], a[100:103], v[160:163]
s_waitcnt vmcnt(22)
ds_read_b128 a[104:107], v4 offset:0
v_cvt_pk_bf16_f32 v75, v66, v67
v_mfma_f32_16x16x32_bf16 a[4:7], a[236:239], a[108:111], a[4:7]
s_waitcnt vmcnt(21)
ds_read_b128 a[108:111], v4 offset:1024
v_mfma_f32_16x16x32_bf16 a[4:7], a[252:255], a[112:115], a[4:7]
ds_write_addtid_b32 v75 offset:46596
v_mfma_f32_16x16x32_bf16 a[12:15], a[236:239], a[112:115], a[12:15]
ds_read_b128 a[112:115], v4 offset:2048
v_sub_f32 v66, v62, v54
v_mfma_f32_16x16x32_bf16 a[12:15], a[252:255], a[116:119], a[12:15]
v_sub_f32 v67, v63, v55
v_cvt_pk_bf16_f32 v68, v66, v67
v_mfma_f32_16x16x32_bf16 a[20:23], a[236:239], a[116:119], a[20:23]
ds_read_b128 a[116:119], v4 offset:3072
v_mfma_f32_16x16x32_bf16 a[20:23], a[252:255], a[80:83], a[20:23]
ds_write_addtid_b32 v68 offset:46852
v_mfma_f32_16x16x32_bf16 a[28:31], a[236:239], a[80:83], a[28:31]
ds_read_b128 a[80:83], v6 offset:0
v_lshlrev_b32 v56, 16, v32
v_mfma_f32_16x16x32_bf16 a[28:31], a[252:255], a[84:87], a[28:31]
buffer_load_dwordx4 a[188:191], v9, s[16:19], s69 offen offset:3072 sc1
v_mfma_f32_16x16x32_bf16 a[36:39], a[236:239], a[84:87], a[36:39]
ds_read_b128 a[84:87], v6 offset:1024
v_and_b32 v57, s39, v32
v_mfma_f32_16x16x32_bf16 a[36:39], a[252:255], a[88:91], a[36:39]
v_lshlrev_b32 v58, 16, v33
v_and_b32 v59, s39, v33
v_mfma_f32_16x16x32_bf16 v[148:151], a[236:239], a[88:91], v[148:151]
ds_read_b128 a[88:91], v6 offset:2048
v_lshlrev_b32 v60, 16, v34
v_mfma_f32_16x16x32_bf16 v[148:151], a[252:255], a[92:95], v[148:151]
v_and_b32 v61, s39, v34
v_lshlrev_b32 v62, 16, v35
v_mfma_f32_16x16x32_bf16 v[156:159], a[236:239], a[92:95], v[156:159]
ds_read_b128 a[92:95], v6 offset:3072
v_and_b32 v63, s39, v35
v_mfma_f32_16x16x32_bf16 v[156:159], a[252:255], a[96:99], v[156:159]
buffer_load_dwordx4 v[32:35], v2, s[8:11], 0 offen offset:2432
v_mfma_f32_16x16x32_bf16 v[164:167], a[236:239], a[96:99], v[164:167]
s_mov_b32 s35, 65536
ds_read_b128 a[96:99], v8 offset:0
s_mov_b32 s69, 69632
v_mfma_f32_16x16x32_bf16 v[164:167], a[252:255], a[100:103], v[164:167]
s_waitcnt vmcnt(20) lgkmcnt(10)
s_mov_b32 m0, s6
v_lshlrev_b32 v64, 16, v36
v_mfma_f32_16x16x32_bf16 v[168:171], a[128:131], a[104:107], v[168:171]
s_waitcnt vmcnt(18) lgkmcnt(9)
v_and_b32 v65, s39, v36
v_sub_f32 v66, v56, v64
v_mfma_f32_16x16x32_bf16 v[168:171], a[144:147], a[108:111], v[168:171]
buffer_load_dwordx4 a[192:195], v9, s[16:19], s35 offen offset:0 sc1
v_mfma_f32_16x16x32_bf16 v[176:179], a[128:131], a[108:111], v[176:179]
s_waitcnt lgkmcnt(7)
v_sub_f32 v67, v57, v65
v_cvt_pk_bf16_f32 v69, v66, v67
v_mfma_f32_16x16x32_bf16 v[176:179], a[144:147], a[112:115], v[176:179]
ds_write_addtid_b32 v69 offset:34816
v_mfma_f32_16x16x32_bf16 v[184:187], a[128:131], a[112:115], v[184:187]
s_waitcnt lgkmcnt(7)
v_add_f32 v66, v56, v64
v_add_f32 v67, v57, v65
v_mfma_f32_16x16x32_bf16 v[184:187], a[144:147], a[116:119], v[184:187]
v_cvt_pk_bf16_f32 v70, v66, v67
v_mfma_f32_16x16x32_bf16 v[192:195], a[128:131], a[116:119], v[192:195]
s_waitcnt lgkmcnt(5)
buffer_load_dwordx4 a[208:211], v9, s[16:19], s69 offen offset:0 sc1
v_mfma_f32_16x16x32_bf16 v[192:195], a[144:147], a[80:83], v[192:195]
ds_write_addtid_b32 v70 offset:51200
v_mfma_f32_16x16x32_bf16 v[200:203], a[128:131], a[80:83], v[200:203]
s_waitcnt lgkmcnt(5)
v_lshlrev_b32 v64, 16, v37
v_and_b32 v65, s39, v37
v_mfma_f32_16x16x32_bf16 v[200:203], a[144:147], a[84:87], v[200:203]
v_sub_f32 v66, v58, v64
v_sub_f32 v67, v59, v65
v_mfma_f32_16x16x32_bf16 v[208:211], a[128:131], a[84:87], v[208:211]
s_waitcnt lgkmcnt(4)
v_cvt_pk_bf16_f32 v71, v66, v67
v_mfma_f32_16x16x32_bf16 v[208:211], a[144:147], a[88:91], v[208:211]
ds_write_addtid_b32 v71 offset:35072
v_mfma_f32_16x16x32_bf16 v[216:219], a[128:131], a[88:91], v[216:219]
s_waitcnt lgkmcnt(4)
v_add_f32 v66, v58, v64
v_add_f32 v67, v59, v65
v_mfma_f32_16x16x32_bf16 v[216:219], a[144:147], a[92:95], v[216:219]
v_cvt_pk_bf16_f32 v72, v66, v67
v_mfma_f32_16x16x32_bf16 v[224:227], a[128:131], a[92:95], v[224:227]
s_waitcnt lgkmcnt(3)
buffer_load_dwordx4 a[196:199], v9, s[16:19], s35 offen offset:1024 sc1
v_mfma_f32_16x16x32_bf16 v[224:227], a[144:147], a[96:99], v[224:227]
s_waitcnt vmcnt(20)
ds_write_addtid_b32 v72 offset:51456
v_mfma_f32_16x16x32_bf16 v[172:175], a[132:135], a[104:107], v[172:175]
s_waitcnt vmcnt(19)
v_lshlrev_b32 v64, 16, v38
v_and_b32 v65, s39, v38
v_mfma_f32_16x16x32_bf16 v[172:175], a[148:151], a[108:111], v[172:175]
v_sub_f32 v66, v60, v64
v_sub_f32 v67, v61, v65
v_mfma_f32_16x16x32_bf16 v[180:183], a[132:135], a[108:111], v[180:183]
v_cvt_pk_bf16_f32 v73, v66, v67
v_mfma_f32_16x16x32_bf16 v[180:183], a[148:151], a[112:115], v[180:183]
ds_write_addtid_b32 v73 offset:35328
v_mfma_f32_16x16x32_bf16 v[188:191], a[132:135], a[112:115], v[188:191]
v_add_f32 v66, v60, v64
v_add_f32 v67, v61, v65
v_mfma_f32_16x16x32_bf16 v[188:191], a[148:151], a[116:119], v[188:191]
v_cvt_pk_bf16_f32 v74, v66, v67
v_mfma_f32_16x16x32_bf16 v[196:199], a[132:135], a[116:119], v[196:199]
buffer_load_dwordx4 a[212:215], v9, s[16:19], s69 offen offset:1024 sc1
v_mfma_f32_16x16x32_bf16 v[196:199], a[148:151], a[80:83], v[196:199]
ds_write_addtid_b32 v74 offset:51712
v_mfma_f32_16x16x32_bf16 v[204:207], a[132:135], a[80:83], v[204:207]
v_lshlrev_b32 v64, 16, v39
v_and_b32 v65, s39, v39
v_mfma_f32_16x16x32_bf16 v[204:207], a[148:151], a[84:87], v[204:207]
v_sub_f32 v66, v62, v64
v_sub_f32 v67, v63, v65
v_mfma_f32_16x16x32_bf16 v[212:215], a[132:135], a[84:87], v[212:215]
v_cvt_pk_bf16_f32 v75, v66, v67
v_mfma_f32_16x16x32_bf16 v[212:215], a[148:151], a[88:91], v[212:215]
ds_write_addtid_b32 v75 offset:35584
v_mfma_f32_16x16x32_bf16 v[220:223], a[132:135], a[88:91], v[220:223]
v_add_f32 v66, v62, v64
v_add_f32 v67, v63, v65
v_mfma_f32_16x16x32_bf16 v[220:223], a[148:151], a[92:95], v[220:223]
v_cvt_pk_bf16_f32 v68, v66, v67
v_mfma_f32_16x16x32_bf16 v[228:231], a[132:135], a[92:95], v[228:231]
buffer_load_dwordx4 a[200:203], v9, s[16:19], s35 offen offset:2048 sc1
v_mfma_f32_16x16x32_bf16 v[228:231], a[148:151], a[96:99], v[228:231]
s_waitcnt vmcnt(20)
ds_write_addtid_b32 v68 offset:51968
v_mfma_f32_16x16x32_bf16 a[40:43], a[136:139], a[104:107], a[40:43]
s_waitcnt vmcnt(19)
v_mfma_f32_16x16x32_bf16 a[40:43], a[152:155], a[108:111], a[40:43]
v_mfma_f32_16x16x32_bf16 a[48:51], a[136:139], a[108:111], a[48:51]
buffer_load_dwordx4 v[36:39], v2, s[8:11], 0 offen offset:1408
v_mfma_f32_16x16x32_bf16 a[48:51], a[152:155], a[112:115], a[48:51]
s_mov_b32 m0, s7
v_sub_f32 v66, v48, v56
v_sub_f32 v67, v49, v57
v_mfma_f32_16x16x32_bf16 a[56:59], a[136:139], a[112:115], a[56:59]
v_cvt_pk_bf16_f32 v69, v66, v67
v_mfma_f32_16x16x32_bf16 a[56:59], a[152:155], a[116:119], a[56:59]
ds_write_addtid_b32 v69 offset:47108
v_mfma_f32_16x16x32_bf16 a[64:67], a[136:139], a[116:119], a[64:67]
buffer_load_dwordx4 a[216:219], v9, s[16:19], s69 offen offset:2048 sc1
v_mfma_f32_16x16x32_bf16 a[64:67], a[152:155], a[80:83], a[64:67]
v_sub_f32 v66, v50, v58
v_sub_f32 v67, v51, v59
v_mfma_f32_16x16x32_bf16 a[72:75], a[136:139], a[80:83], a[72:75]
v_cvt_pk_bf16_f32 v70, v66, v67
v_mfma_f32_16x16x32_bf16 a[72:75], a[152:155], a[84:87], a[72:75]
ds_write_addtid_b32 v70 offset:47364
v_mfma_f32_16x16x32_bf16 v[232:235], a[136:139], a[84:87], v[232:235]
v_sub_f32 v66, v52, v60
v_sub_f32 v67, v53, v61
v_mfma_f32_16x16x32_bf16 v[232:235], a[152:155], a[88:91], v[232:235]
v_cvt_pk_bf16_f32 v71, v66, v67
v_mfma_f32_16x16x32_bf16 v[240:243], a[136:139], a[88:91], v[240:243]
ds_write_addtid_b32 v71 offset:47620
v_mfma_f32_16x16x32_bf16 v[240:243], a[152:155], a[92:95], v[240:243]
v_sub_f32 v66, v54, v62
v_sub_f32 v67, v55, v63
v_mfma_f32_16x16x32_bf16 v[248:251], a[136:139], a[92:95], v[248:251]
buffer_load_dwordx4 a[204:207], v9, s[16:19], s35 offen offset:3072 sc1
v_mfma_f32_16x16x32_bf16 v[248:251], a[152:155], a[96:99], v[248:251]
s_waitcnt vmcnt(20)
ds_read_b128 a[100:103], v4 offset:16384
v_cvt_pk_bf16_f32 v72, v66, v67
v_mfma_f32_16x16x32_bf16 a[44:47], a[140:143], a[104:107], a[44:47]
s_waitcnt vmcnt(19)
ds_read_b128 a[104:107], v4 offset:17408
v_mfma_f32_16x16x32_bf16 a[44:47], a[156:159], a[108:111], a[44:47]
ds_write_addtid_b32 v72 offset:47876
v_mfma_f32_16x16x32_bf16 a[52:55], a[140:143], a[108:111], a[52:55]
ds_read_b128 a[108:111], v4 offset:18432
v_lshlrev_b32 v48, 16, v40
v_mfma_f32_16x16x32_bf16 a[52:55], a[156:159], a[112:115], a[52:55]
v_and_b32 v49, s39, v40
v_lshlrev_b32 v50, 16, v41
v_mfma_f32_16x16x32_bf16 a[60:63], a[140:143], a[112:115], a[60:63]
ds_read_b128 a[112:115], v4 offset:19456
v_and_b32 v51, s39, v41
v_mfma_f32_16x16x32_bf16 a[60:63], a[156:159], a[116:119], a[60:63]
v_lshlrev_b32 v52, 16, v42
v_and_b32 v53, s39, v42
v_mfma_f32_16x16x32_bf16 a[68:71], a[140:143], a[116:119], a[68:71]
ds_read_b128 a[116:119], v6 offset:16384
v_lshlrev_b32 v54, 16, v43
v_mfma_f32_16x16x32_bf16 a[68:71], a[156:159], a[80:83], a[68:71]
buffer_load_dwordx4 a[220:223], v9, s[16:19], s69 offen offset:3072 sc1
v_mfma_f32_16x16x32_bf16 a[76:79], a[140:143], a[80:83], a[76:79]
ds_read_b128 a[80:83], v6 offset:17408
v_and_b32 v55, s39, v43
v_mfma_f32_16x16x32_bf16 a[76:79], a[156:159], a[84:87], a[76:79]
v_mfma_f32_16x16x32_bf16 v[236:239], a[140:143], a[84:87], v[236:239]
ds_read_b128 a[84:87], v6 offset:18432
v_mfma_f32_16x16x32_bf16 v[236:239], a[156:159], a[88:91], v[236:239]
buffer_load_dwordx4 v[40:43], v11, s[8:11], 0 offen offset:384
v_mfma_f32_16x16x32_bf16 v[244:247], a[140:143], a[88:91], v[244:247]
s_mov_b32 m0, s6
ds_read_b128 a[88:91], v6 offset:19456
v_lshlrev_b32 v64, 16, v44
v_mfma_f32_16x16x32_bf16 v[244:247], a[156:159], a[92:95], v[244:247]
v_and_b32 v65, s39, v44
v_sub_f32 v66, v48, v64
v_mfma_f32_16x16x32_bf16 v[252:255], a[140:143], a[92:95], v[252:255]
s_mov_b32 s35, 73728
ds_read_b128 a[92:95], v8 offset:16384
s_mov_b32 s69, 77824
v_mfma_f32_16x16x32_bf16 v[252:255], a[156:159], a[96:99], v[252:255]
s_waitcnt vmcnt(20) lgkmcnt(9)
buffer_load_dwordx4 a[224:227], v9, s[16:19], s35 offen offset:0 sc1
v_mfma_f32_16x16x32_bf16 v[80:83], a[160:163], a[100:103], v[80:83]
s_waitcnt vmcnt(19) lgkmcnt(8)
v_sub_f32 v67, v49, v65
v_cvt_pk_bf16_f32 v73, v66, v67
v_mfma_f32_16x16x32_bf16 v[80:83], a[176:179], a[104:107], v[80:83]
ds_write_addtid_b32 v73 offset:35840
v_mfma_f32_16x16x32_bf16 v[88:91], a[160:163], a[104:107], v[88:91]
s_waitcnt lgkmcnt(7)
v_add_f32 v66, v48, v64
v_add_f32 v67, v49, v65
v_mfma_f32_16x16x32_bf16 v[88:91], a[176:179], a[108:111], v[88:91]
v_cvt_pk_bf16_f32 v74, v66, v67
v_mfma_f32_16x16x32_bf16 v[96:99], a[160:163], a[108:111], v[96:99]
s_waitcnt lgkmcnt(6)
ds_write_addtid_b32 v74 offset:52224
v_mfma_f32_16x16x32_bf16 v[96:99], a[176:179], a[112:115], v[96:99]
v_lshlrev_b32 v64, 16, v45
v_and_b32 v65, s39, v45
v_mfma_f32_16x16x32_bf16 v[104:107], a[160:163], a[112:115], v[104:107]
s_waitcnt lgkmcnt(6)
buffer_load_dwordx4 a[240:243], v9, s[16:19], s69 offen offset:0 sc1
v_mfma_f32_16x16x32_bf16 v[104:107], a[176:179], a[116:119], v[104:107]
v_sub_f32 v66, v50, v64
v_sub_f32 v67, v51, v65
v_mfma_f32_16x16x32_bf16 v[112:115], a[160:163], a[116:119], v[112:115]
s_waitcnt lgkmcnt(5)
v_cvt_pk_bf16_f32 v75, v66, v67
v_mfma_f32_16x16x32_bf16 v[112:115], a[176:179], a[80:83], v[112:115]
ds_write_addtid_b32 v75 offset:36096
v_mfma_f32_16x16x32_bf16 v[120:123], a[160:163], a[80:83], v[120:123]
s_waitcnt lgkmcnt(5)
v_add_f32 v66, v50, v64
v_add_f32 v67, v51, v65
v_mfma_f32_16x16x32_bf16 v[120:123], a[176:179], a[84:87], v[120:123]
v_cvt_pk_bf16_f32 v68, v66, v67
v_mfma_f32_16x16x32_bf16 v[128:131], a[160:163], a[84:87], v[128:131]
s_waitcnt lgkmcnt(4)
ds_write_addtid_b32 v68 offset:52480
v_mfma_f32_16x16x32_bf16 v[128:131], a[176:179], a[88:91], v[128:131]
v_lshlrev_b32 v64, 16, v46
v_and_b32 v65, s39, v46
v_mfma_f32_16x16x32_bf16 v[136:139], a[160:163], a[88:91], v[136:139]
s_waitcnt lgkmcnt(4)
v_sub_f32 v66, v52, v64
v_sub_f32 v67, v53, v65
v_mfma_f32_16x16x32_bf16 v[136:139], a[176:179], a[92:95], v[136:139]
s_waitcnt vmcnt(19)
buffer_load_dwordx4 a[228:231], v9, s[16:19], s35 offen offset:1024 sc1
v_mfma_f32_16x16x32_bf16 v[84:87], a[164:167], a[100:103], v[84:87]
s_waitcnt vmcnt(19)
v_cvt_pk_bf16_f32 v69, v66, v67
v_mfma_f32_16x16x32_bf16 v[84:87], a[180:183], a[104:107], v[84:87]
ds_write_addtid_b32 v69 offset:36352
v_mfma_f32_16x16x32_bf16 v[92:95], a[164:167], a[104:107], v[92:95]
v_add_f32 v66, v52, v64
v_add_f32 v67, v53, v65
v_mfma_f32_16x16x32_bf16 v[92:95], a[180:183], a[108:111], v[92:95]
v_cvt_pk_bf16_f32 v70, v66, v67
v_mfma_f32_16x16x32_bf16 v[100:103], a[164:167], a[108:111], v[100:103]
ds_write_addtid_b32 v70 offset:52736
v_mfma_f32_16x16x32_bf16 v[100:103], a[180:183], a[112:115], v[100:103]
v_lshlrev_b32 v64, 16, v47
v_and_b32 v65, s39, v47
v_mfma_f32_16x16x32_bf16 v[108:111], a[164:167], a[112:115], v[108:111]
v_sub_f32 v66, v54, v64
v_sub_f32 v67, v55, v65
v_mfma_f32_16x16x32_bf16 v[108:111], a[180:183], a[116:119], v[108:111]
v_cvt_pk_bf16_f32 v71, v66, v67
v_mfma_f32_16x16x32_bf16 v[116:119], a[164:167], a[116:119], v[116:119]
ds_write_addtid_b32 v71 offset:36608
v_mfma_f32_16x16x32_bf16 v[116:119], a[180:183], a[80:83], v[116:119]
buffer_load_dwordx4 a[244:247], v9, s[16:19], s69 offen offset:1024 sc1
v_mfma_f32_16x16x32_bf16 v[124:127], a[164:167], a[80:83], v[124:127]
v_add_f32 v66, v54, v64
v_add_f32 v67, v55, v65
v_mfma_f32_16x16x32_bf16 v[124:127], a[180:183], a[84:87], v[124:127]
v_cvt_pk_bf16_f32 v72, v66, v67
v_mfma_f32_16x16x32_bf16 v[132:135], a[164:167], a[84:87], v[132:135]
ds_write_addtid_b32 v72 offset:52992
v_mfma_f32_16x16x32_bf16 v[132:135], a[180:183], a[88:91], v[132:135]
buffer_load_dwordx4 v[44:47], v2, s[8:11], 0 offen offset:3456
v_mfma_f32_16x16x32_bf16 v[140:143], a[164:167], a[88:91], v[140:143]
s_mov_b32 m0, s7
v_sub_f32 v66, v56, v48
v_sub_f32 v67, v57, v49
v_mfma_f32_16x16x32_bf16 v[140:143], a[180:183], a[92:95], v[140:143]
s_waitcnt vmcnt(20)
v_cvt_pk_bf16_f32 v73, v66, v67
v_mfma_f32_16x16x32_bf16 a[0:3], a[168:171], a[100:103], a[0:3]
s_waitcnt vmcnt(18)
ds_write_addtid_b32 v73 offset:48132
v_mfma_f32_16x16x32_bf16 a[0:3], a[184:187], a[104:107], a[0:3]
v_sub_f32 v66, v58, v50
v_sub_f32 v67, v59, v51
v_mfma_f32_16x16x32_bf16 a[8:11], a[168:171], a[104:107], a[8:11]
v_cvt_pk_bf16_f32 v74, v66, v67
v_mfma_f32_16x16x32_bf16 a[8:11], a[184:187], a[108:111], a[8:11]
ds_write_addtid_b32 v74 offset:48388
v_mfma_f32_16x16x32_bf16 a[16:19], a[168:171], a[108:111], a[16:19]
buffer_load_dwordx4 a[232:235], v9, s[16:19], s35 offen offset:2048 sc1
v_mfma_f32_16x16x32_bf16 a[16:19], a[184:187], a[112:115], a[16:19]
v_sub_f32 v66, v60, v52
v_sub_f32 v67, v61, v53
v_mfma_f32_16x16x32_bf16 a[24:27], a[168:171], a[112:115], a[24:27]
v_cvt_pk_bf16_f32 v75, v66, v67
v_mfma_f32_16x16x32_bf16 a[24:27], a[184:187], a[116:119], a[24:27]
ds_write_addtid_b32 v75 offset:48644
v_mfma_f32_16x16x32_bf16 a[32:35], a[168:171], a[116:119], a[32:35]
v_sub_f32 v66, v62, v54
v_sub_f32 v67, v63, v55
v_mfma_f32_16x16x32_bf16 a[32:35], a[184:187], a[80:83], a[32:35]
v_cvt_pk_bf16_f32 v68, v66, v67
v_mfma_f32_16x16x32_bf16 v[144:147], a[168:171], a[80:83], v[144:147]
ds_write_addtid_b32 v68 offset:48900
v_mfma_f32_16x16x32_bf16 v[144:147], a[184:187], a[84:87], v[144:147]
buffer_load_dwordx4 a[248:251], v9, s[16:19], s69 offen offset:2048 sc1
v_mfma_f32_16x16x32_bf16 v[152:155], a[168:171], a[84:87], v[152:155]
v_mfma_f32_16x16x32_bf16 v[152:155], a[184:187], a[88:91], v[152:155]
v_mfma_f32_16x16x32_bf16 v[160:163], a[168:171], a[88:91], v[160:163]
s_waitcnt lgkmcnt(0)
s_barrier
v_mfma_f32_16x16x32_bf16 v[160:163], a[184:187], a[92:95], v[160:163]
s_waitcnt vmcnt(19)
ds_read_b128 a[96:99], v3 offset:32768
v_lshlrev_b32 v48, 16, v12
v_mfma_f32_16x16x32_bf16 a[4:7], a[172:175], a[100:103], a[4:7]
s_waitcnt vmcnt(18)
ds_read_b128 a[100:103], v3 offset:33792
v_and_b32 v49, s39, v12
v_mfma_f32_16x16x32_bf16 a[4:7], a[188:191], a[104:107], a[4:7]
buffer_load_dwordx4 a[236:239], v9, s[16:19], s35 offen offset:3072 sc1
v_mfma_f32_16x16x32_bf16 a[12:15], a[172:175], a[104:107], a[12:15]
ds_read_b128 a[104:107], v3 offset:34816
v_lshlrev_b32 v50, 16, v13
v_mfma_f32_16x16x32_bf16 a[12:15], a[188:191], a[108:111], a[12:15]
v_and_b32 v51, s39, v13
v_lshlrev_b32 v52, 16, v14
v_mfma_f32_16x16x32_bf16 a[20:23], a[172:175], a[108:111], a[20:23]
ds_read_b128 a[108:111], v3 offset:35840
v_and_b32 v53, s39, v14
v_mfma_f32_16x16x32_bf16 a[20:23], a[188:191], a[112:115], a[20:23]
v_lshlrev_b32 v54, 16, v15
v_and_b32 v55, s39, v15
v_mfma_f32_16x16x32_bf16 a[28:31], a[172:175], a[112:115], a[28:31]
ds_read_b128 a[112:115], v5 offset:32768
v_mfma_f32_16x16x32_bf16 a[28:31], a[188:191], a[116:119], a[28:31]
buffer_load_dwordx4 a[252:255], v9, s[16:19], s69 offen offset:3072 sc1
v_mfma_f32_16x16x32_bf16 a[36:39], a[172:175], a[116:119], a[36:39]
ds_read_b128 a[116:119], v5 offset:33792
v_mfma_f32_16x16x32_bf16 a[36:39], a[188:191], a[80:83], a[36:39]
v_mfma_f32_16x16x32_bf16 v[148:151], a[172:175], a[80:83], v[148:151]
ds_read_b128 a[80:83], v5 offset:34816
v_mfma_f32_16x16x32_bf16 v[148:151], a[188:191], a[84:87], v[148:151]
buffer_load_dwordx4 v[12:15], v1, s[8:11], 0 offen offset:0
v_mfma_f32_16x16x32_bf16 v[156:159], a[172:175], a[84:87], v[156:159]
ds_read_b128 a[84:87], v5 offset:35840
v_lshlrev_b32 v56, 16, v16
v_mfma_f32_16x16x32_bf16 v[156:159], a[188:191], a[88:91], v[156:159]
v_and_b32 v57, s39, v16
v_lshlrev_b32 v58, 16, v17
v_mfma_f32_16x16x32_bf16 v[164:167], a[172:175], a[88:91], v[164:167]
s_mov_b32 s35, 81920
ds_read_b128 a[88:91], v7 offset:32768
s_mov_b32 s69, 86016
v_mfma_f32_16x16x32_bf16 v[164:167], a[188:191], a[92:95], v[164:167]
s_waitcnt vmcnt(19) lgkmcnt(8)
buffer_load_dwordx4 a[128:131], v9, s[16:19], s35 offen offset:0 sc1
v_mfma_f32_16x16x32_bf16 v[168:171], a[192:195], a[96:99], v[168:171]
L_sd2:
v_and_b32 v59, s39, v17
v_lshlrev_b32 v60, 16, v18
s_waitcnt vmcnt(19) lgkmcnt(7)
v_mfma_f32_16x16x32_bf16 v[168:171], a[208:211], a[100:103], v[168:171]
v_and_b32 v61, s39, v18
v_lshlrev_b32 v62, 16, v19
v_mfma_f32_16x16x32_bf16 v[176:179], a[192:195], a[100:103], v[176:179]
s_waitcnt lgkmcnt(6)
v_and_b32 v63, s39, v19
v_mfma_f32_16x16x32_bf16 v[176:179], a[208:211], a[104:107], v[176:179]
buffer_load_dwordx4 v[16:19], v1, s[8:11], 0 offen offset:2048
v_mfma_f32_16x16x32_bf16 v[184:187], a[192:195], a[104:107], v[184:187]
s_waitcnt lgkmcnt(5)
s_mov_b32 m0, s6
v_lshlrev_b32 v64, 16, v20
v_mfma_f32_16x16x32_bf16 v[184:187], a[208:211], a[108:111], v[184:187]
v_and_b32 v65, s39, v20
v_sub_f32 v66, v56, v64
v_mfma_f32_16x16x32_bf16 v[192:195], a[192:195], a[108:111], v[192:195]
s_waitcnt lgkmcnt(4)
v_sub_f32 v67, v57, v65
v_cvt_pk_bf16_f32 v69, v66, v67
v_mfma_f32_16x16x32_bf16 v[192:195], a[208:211], a[112:115], v[192:195]
buffer_load_dwordx4 a[144:147], v9, s[16:19], s69 offen offset:0 sc1
v_mfma_f32_16x16x32_bf16 v[200:203], a[192:195], a[112:115], v[200:203]
s_waitcnt lgkmcnt(3)
ds_write_addtid_b32 v69 offset:0
v_mfma_f32_16x16x32_bf16 v[200:203], a[208:211], a[116:119], v[200:203]
v_add_f32 v66, v56, v64
v_add_f32 v67, v57, v65
v_mfma_f32_16x16x32_bf16 v[208:211], a[192:195], a[116:119], v[208:211]
s_waitcnt lgkmcnt(3)
v_cvt_pk_bf16_f32 v70, v66, v67
v_mfma_f32_16x16x32_bf16 v[208:211], a[208:211], a[80:83], v[208:211]
ds_write_addtid_b32 v70 offset:16384
v_mfma_f32_16x16x32_bf16 v[216:219], a[192:195], a[80:83], v[216:219]
s_waitcnt lgkmcnt(3)
v_lshlrev_b32 v64, 16, v21
v_and_b32 v65, s39, v21
v_mfma_f32_16x16x32_bf16 v[216:219], a[208:211], a[84:87], v[216:219]
v_sub_f32 v66, v58, v64
v_sub_f32 v67, v59, v65
v_mfma_f32_16x16x32_bf16 v[224:227], a[192:195], a[84:87], v[224:227]
s_waitcnt lgkmcnt(2)
buffer_load_dwordx4 a[132:135], v9, s[16:19], s35 offen offset:1024 sc1
v_mfma_f32_16x16x32_bf16 v[224:227], a[208:211], a[88:91], v[224:227]
s_waitcnt vmcnt(21)
v_cvt_pk_bf16_f32 v71, v66, v67
v_mfma_f32_16x16x32_bf16 v[172:175], a[196:199], a[96:99], v[172:175]
s_waitcnt vmcnt(20)
ds_write_addtid_b32 v71 offset:256
v_mfma_f32_16x16x32_bf16 v[172:175], a[212:215], a[100:103], v[172:175]
v_add_f32 v66, v58, v64
v_add_f32 v67, v59, v65
v_mfma_f32_16x16x32_bf16 v[180:183], a[196:199], a[100:103], v[180:183]
v_cvt_pk_bf16_f32 v72, v66, v67
v_mfma_f32_16x16x32_bf16 v[180:183], a[212:215], a[104:107], v[180:183]
ds_write_addtid_b32 v72 offset:16640
v_mfma_f32_16x16x32_bf16 v[188:191], a[196:199], a[104:107], v[188:191]
v_lshlrev_b32 v64, 16, v22
v_and_b32 v65, s39, v22
v_mfma_f32_16x16x32_bf16 v[188:191], a[212:215], a[108:111], v[188:191]
v_sub_f32 v66, v60, v64
v_sub_f32 v67, v61, v65
v_mfma_f32_16x16x32_bf16 v[196:199], a[196:199], a[108:111], v[196:199]
buffer_load_dwordx4 a[148:151], v9, s[16:19], s69 offen offset:1024 sc1
v_mfma_f32_16x16x32_bf16 v[196:199], a[212:215], a[112:115], v[196:199]
v_cvt_pk_bf16_f32 v73, v66, v67
v_mfma_f32_16x16x32_bf16 v[204:207], a[196:199], a[112:115], v[204:207]
ds_write_addtid_b32 v73 offset:512
v_mfma_f32_16x16x32_bf16 v[204:207], a[212:215], a[116:119], v[204:207]
v_add_f32 v66, v60, v64
v_add_f32 v67, v61, v65
v_mfma_f32_16x16x32_bf16 v[212:215], a[196:199], a[116:119], v[212:215]
v_cvt_pk_bf16_f32 v74, v66, v67
v_mfma_f32_16x16x32_bf16 v[212:215], a[212:215], a[80:83], v[212:215]
ds_write_addtid_b32 v74 offset:16896
v_mfma_f32_16x16x32_bf16 v[220:223], a[196:199], a[80:83], v[220:223]
v_lshlrev_b32 v64, 16, v23
v_and_b32 v65, s39, v23
v_mfma_f32_16x16x32_bf16 v[220:223], a[212:215], a[84:87], v[220:223]
v_sub_f32 v66, v62, v64
v_sub_f32 v67, v63, v65
v_mfma_f32_16x16x32_bf16 v[228:231], a[196:199], a[84:87], v[228:231]
buffer_load_dwordx4 a[136:139], v9, s[16:19], s35 offen offset:2048 sc1
v_mfma_f32_16x16x32_bf16 v[228:231], a[212:215], a[88:91], v[228:231]
s_waitcnt vmcnt(21)
v_cvt_pk_bf16_f32 v75, v66, v67
v_mfma_f32_16x16x32_bf16 a[40:43], a[200:203], a[96:99], a[40:43]
s_waitcnt vmcnt(19)
ds_write_addtid_b32 v75 offset:768
v_mfma_f32_16x16x32_bf16 a[40:43], a[216:219], a[100:103], a[40:43]
v_add_f32 v66, v62, v64
v_add_f32 v67, v63, v65
v_mfma_f32_16x16x32_bf16 a[48:51], a[200:203], a[100:103], a[48:51]
v_cvt_pk_bf16_f32 v68, v66, v67
v_mfma_f32_16x16x32_bf16 a[48:51], a[216:219], a[104:107], a[48:51]
ds_write_addtid_b32 v68 offset:17152
v_mfma_f32_16x16x32_bf16 a[56:59], a[200:203], a[104:107], a[56:59]
v_mfma_f32_16x16x32_bf16 a[56:59], a[216:219], a[108:111], a[56:59]
buffer_load_dwordx4 v[20:23], v2, s[8:11], 0 offen offset:0
v_mfma_f32_16x16x32_bf16 a[64:67], a[200:203], a[108:111], a[64:67]
s_mov_b32 m0, s7
v_sub_f32 v66, v48, v56
v_sub_f32 v67, v49, v57
v_mfma_f32_16x16x32_bf16 a[64:67], a[216:219], a[112:115], a[64:67]
v_mfma_f32_16x16x32_bf16 a[72:75], a[200:203], a[112:115], a[72:75]
v_cvt_pk_bf16_f32 v69, v66, v67
v_mfma_f32_16x16x32_bf16 a[72:75], a[216:219], a[116:119], a[72:75]
buffer_load_dwordx4 a[152:155], v9, s[16:19], s69 offen offset:2048 sc1
v_mfma_f32_16x16x32_bf16 v[232:235], a[200:203], a[116:119], v[232:235]
ds_write_addtid_b32 v69 offset:61444
v_mfma_f32_16x16x32_bf16 v[232:235], a[216:219], a[80:83], v[232:235]
v_sub_f32 v66, v50, v58
v_sub_f32 v67, v51, v59
v_mfma_f32_16x16x32_bf16 v[240:243], a[200:203], a[80:83], v[240:243]
v_cvt_pk_bf16_f32 v70, v66, v67
v_mfma_f32_16x16x32_bf16 v[240:243], a[216:219], a[84:87], v[240:243]
ds_write_addtid_b32 v70 offset:61700
v_mfma_f32_16x16x32_bf16 v[248:251], a[200:203], a[84:87], v[248:251]
buffer_load_dwordx4 a[140:143], v9, s[16:19], s35 offen offset:3072 sc1
v_mfma_f32_16x16x32_bf16 v[248:251], a[216:219], a[88:91], v[248:251]
s_waitcnt vmcnt(21)
ds_read_b128 a[92:95], v3 offset:49152
v_sub_f32 v66, v52, v60
v_mfma_f32_16x16x32_bf16 a[44:47], a[204:207], a[96:99], a[44:47]
s_waitcnt vmcnt(20)
ds_read_b128 a[96:99], v3 offset:50176
v_sub_f32 v67, v53, v61
v_mfma_f32_16x16x32_bf16 a[44:47], a[220:223], a[100:103], a[44:47]
v_cvt_pk_bf16_f32 v71, v66, v67
v_mfma_f32_16x16x32_bf16 a[52:55], a[204:207], a[100:103], a[52:55]
ds_read_b128 a[100:103], v3 offset:51200
v_mfma_f32_16x16x32_bf16 a[52:55], a[220:223], a[104:107], a[52:55]
ds_write_addtid_b32 v71 offset:61956
v_mfma_f32_16x16x32_bf16 a[60:63], a[204:207], a[104:107], a[60:63]
ds_read_b128 a[104:107], v3 offset:52224
v_sub_f32 v66, v54, v62
v_mfma_f32_16x16x32_bf16 a[60:63], a[220:223], a[108:111], a[60:63]
v_sub_f32 v67, v55, v63
v_cvt_pk_bf16_f32 v72, v66, v67
v_mfma_f32_16x16x32_bf16 a[68:71], a[204:207], a[108:111], a[68:71]
ds_read_b128 a[108:111], v5 offset:49152
v_mfma_f32_16x16x32_bf16 a[68:71], a[220:223], a[112:115], a[68:71]
buffer_load_dwordx4 a[156:159], v9, s[16:19], s69 offen offset:3072 sc1
v_mfma_f32_16x16x32_bf16 a[76:79], a[204:207], a[112:115], a[76:79]
ds_read_b128 a[112:115], v5 offset:50176
v_mfma_f32_16x16x32_bf16 a[76:79], a[220:223], a[116:119], a[76:79]
ds_write_addtid_b32 v72 offset:62212
v_mfma_f32_16x16x32_bf16 v[236:239], a[204:207], a[116:119], v[236:239]
ds_read_b128 a[116:119], v5 offset:51200
v_lshlrev_b32 v48, 16, v24
v_mfma_f32_16x16x32_bf16 v[236:239], a[220:223], a[80:83], v[236:239]
v_and_b32 v49, s39, v24
v_lshlrev_b32 v50, 16, v25
v_mfma_f32_16x16x32_bf16 v[244:247], a[204:207], a[80:83], v[244:247]
ds_read_b128 a[80:83], v5 offset:52224
v_and_b32 v51, s39, v25
v_mfma_f32_16x16x32_bf16 v[244:247], a[220:223], a[84:87], v[244:247]
v_lshlrev_b32 v52, 16, v26
v_and_b32 v53, s39, v26
v_mfma_f32_16x16x32_bf16 v[252:255], a[204:207], a[84:87], v[252:255]
s_mov_b32 s35, 90112
ds_read_b128 a[84:87], v7 offset:49152
s_mov_b32 s69, 94208
v_mfma_f32_16x16x32_bf16 v[252:255], a[220:223], a[88:91], v[252:255]
s_waitcnt vmcnt(19) lgkmcnt(10)
buffer_load_dwordx4 a[160:163], v9, s[16:19], s35 offen offset:0 sc1
v_mfma_f32_16x16x32_bf16 v[80:83], a[224:227], a[92:95], v[80:83]
s_waitcnt vmcnt(19) lgkmcnt(9)
v_lshlrev_b32 v54, 16, v27
v_and_b32 v55, s39, v27
v_mfma_f32_16x16x32_bf16 v[80:83], a[240:243], a[96:99], v[80:83]
v_mfma_f32_16x16x32_bf16 v[88:91], a[224:227], a[96:99], v[88:91]
s_waitcnt lgkmcnt(8)
v_mfma_f32_16x16x32_bf16 v[88:91], a[240:243], a[100:103], v[88:91]
buffer_load_dwordx4 v[24:27], v2, s[8:11], 0 offen offset:2048
v_mfma_f32_16x16x32_bf16 v[96:99], a[224:227], a[100:103], v[96:99]
s_waitcnt lgkmcnt(6)
s_mov_b32 m0, s6
v_lshlrev_b32 v64, 16, v28
v_mfma_f32_16x16x32_bf16 v[96:99], a[240:243], a[104:107], v[96:99]
v_and_b32 v65, s39, v28
v_sub_f32 v66, v48, v64
v_mfma_f32_16x16x32_bf16 v[104:107], a[224:227], a[104:107], v[104:107]
s_waitcnt lgkmcnt(5)
v_sub_f32 v67, v49, v65
v_cvt_pk_bf16_f32 v73, v66, v67
v_mfma_f32_16x16x32_bf16 v[104:107], a[240:243], a[108:111], v[104:107]
buffer_load_dwordx4 a[176:179], v9, s[16:19], s69 offen offset:0 sc1
v_mfma_f32_16x16x32_bf16 v[112:115], a[224:227], a[108:111], v[112:115]
s_waitcnt lgkmcnt(4)
ds_write_addtid_b32 v73 offset:1024
v_mfma_f32_16x16x32_bf16 v[112:115], a[240:243], a[112:115], v[112:115]
v_add_f32 v66, v48, v64
v_add_f32 v67, v49, v65
v_mfma_f32_16x16x32_bf16 v[120:123], a[224:227], a[112:115], v[120:123]
s_waitcnt lgkmcnt(3)
v_cvt_pk_bf16_f32 v74, v66, v67
v_mfma_f32_16x16x32_bf16 v[120:123], a[240:243], a[116:119], v[120:123]
ds_write_addtid_b32 v74 offset:17408
v_mfma_f32_16x16x32_bf16 v[128:131], a[224:227], a[116:119], v[128:131]
s_waitcnt lgkmcnt(3)
v_lshlrev_b32 v64, 16, v29
v_and_b32 v65, s39, v29
v_mfma_f32_16x16x32_bf16 v[128:131], a[240:243], a[80:83], v[128:131]
v_sub_f32 v66, v50, v64
v_sub_f32 v67, v51, v65
v_mfma_f32_16x16x32_bf16 v[136:139], a[224:227], a[80:83], v[136:139]
s_waitcnt lgkmcnt(2)
buffer_load_dwordx4 a[164:167], v9, s[16:19], s35 offen offset:1024 sc1
v_mfma_f32_16x16x32_bf16 v[136:139], a[240:243], a[84:87], v[136:139]
s_waitcnt vmcnt(21)
v_cvt_pk_bf16_f32 v75, v66, v67
v_mfma_f32_16x16x32_bf16 v[84:87], a[228:231], a[92:95], v[84:87]
s_waitcnt vmcnt(20)
ds_write_addtid_b32 v75 offset:1280
v_mfma_f32_16x16x32_bf16 v[84:87], a[244:247], a[96:99], v[84:87]
v_add_f32 v66, v50, v64
v_add_f32 v67, v51, v65
v_mfma_f32_16x16x32_bf16 v[92:95], a[228:231], a[96:99], v[92:95]
v_cvt_pk_bf16_f32 v68, v66, v67
v_mfma_f32_16x16x32_bf16 v[92:95], a[244:247], a[100:103], v[92:95]
ds_write_addtid_b32 v68 offset:17664
v_mfma_f32_16x16x32_bf16 v[100:103], a[228:231], a[100:103], v[100:103]
v_lshlrev_b32 v64, 16, v30
v_and_b32 v65, s39, v30
v_mfma_f32_16x16x32_bf16 v[100:103], a[244:247], a[104:107], v[100:103]
v_sub_f32 v66, v52, v64
v_sub_f32 v67, v53, v65
v_mfma_f32_16x16x32_bf16 v[108:111], a[228:231], a[104:107], v[108:111]
buffer_load_dwordx4 a[180:183], v9, s[16:19], s69 offen offset:1024 sc1
v_mfma_f32_16x16x32_bf16 v[108:111], a[244:247], a[108:111], v[108:111]
v_cvt_pk_bf16_f32 v69, v66, v67
v_mfma_f32_16x16x32_bf16 v[116:119], a[228:231], a[108:111], v[116:119]
ds_write_addtid_b32 v69 offset:1536
v_mfma_f32_16x16x32_bf16 v[116:119], a[244:247], a[112:115], v[116:119]
v_add_f32 v66, v52, v64
v_add_f32 v67, v53, v65
v_mfma_f32_16x16x32_bf16 v[124:127], a[228:231], a[112:115], v[124:127]
v_cvt_pk_bf16_f32 v70, v66, v67
v_mfma_f32_16x16x32_bf16 v[124:127], a[244:247], a[116:119], v[124:127]
ds_write_addtid_b32 v70 offset:17920
v_mfma_f32_16x16x32_bf16 v[132:135], a[228:231], a[116:119], v[132:135]
v_lshlrev_b32 v64, 16, v31
v_and_b32 v65, s39, v31
v_mfma_f32_16x16x32_bf16 v[132:135], a[244:247], a[80:83], v[132:135]
v_sub_f32 v66, v54, v64
v_sub_f32 v67, v55, v65
v_mfma_f32_16x16x32_bf16 v[140:143], a[228:231], a[80:83], v[140:143]
buffer_load_dwordx4 a[168:171], v9, s[16:19], s35 offen offset:2048 sc1
v_mfma_f32_16x16x32_bf16 v[140:143], a[244:247], a[84:87], v[140:143]
s_waitcnt vmcnt(20)
v_cvt_pk_bf16_f32 v71, v66, v67
v_mfma_f32_16x16x32_bf16 a[0:3], a[232:235], a[92:95], a[0:3]
s_waitcnt vmcnt(19)
ds_write_addtid_b32 v71 offset:1792
v_mfma_f32_16x16x32_bf16 a[0:3], a[248:251], a[96:99], a[0:3]
v_add_f32 v66, v54, v64
v_add_f32 v67, v55, v65
v_mfma_f32_16x16x32_bf16 a[8:11], a[232:235], a[96:99], a[8:11]
v_cvt_pk_bf16_f32 v72, v66, v67
v_mfma_f32_16x16x32_bf16 a[8:11], a[248:251], a[100:103], a[8:11]
ds_write_addtid_b32 v72 offset:18176
v_mfma_f32_16x16x32_bf16 a[16:19], a[232:235], a[100:103], a[16:19]
buffer_load_dwordx4 v[28:31], v11, s[8:11], 0 offen offset:0
v_mfma_f32_16x16x32_bf16 a[16:19], a[248:251], a[104:107], a[16:19]
s_mov_b32 m0, s7
v_sub_f32 v66, v56, v48
v_sub_f32 v67, v57, v49
v_mfma_f32_16x16x32_bf16 a[24:27], a[232:235], a[104:107], a[24:27]
v_cvt_pk_bf16_f32 v73, v66, v67
v_mfma_f32_16x16x32_bf16 a[24:27], a[248:251], a[108:111], a[24:27]
ds_write_addtid_b32 v73 offset:62468
v_mfma_f32_16x16x32_bf16 a[32:35], a[232:235], a[108:111], a[32:35]
buffer_load_dwordx4 a[184:187], v9, s[16:19], s69 offen offset:2048 sc1
v_mfma_f32_16x16x32_bf16 a[32:35], a[248:251], a[112:115], a[32:35]
v_sub_f32 v66, v58, v50
v_sub_f32 v67, v59, v51
v_mfma_f32_16x16x32_bf16 v[144:147], a[232:235], a[112:115], v[144:147]
v_cvt_pk_bf16_f32 v74, v66, v67
v_mfma_f32_16x16x32_bf16 v[144:147], a[248:251], a[116:119], v[144:147]
ds_write_addtid_b32 v74 offset:62724
v_mfma_f32_16x16x32_bf16 v[152:155], a[232:235], a[116:119], v[152:155]
v_mfma_f32_16x16x32_bf16 v[152:155], a[248:251], a[80:83], v[152:155]
v_sub_f32 v66, v60, v52
v_sub_f32 v67, v61, v53
v_mfma_f32_16x16x32_bf16 v[160:163], a[232:235], a[80:83], v[160:163]
buffer_load_dwordx4 a[172:175], v9, s[16:19], s35 offen offset:3072 sc1
v_mfma_f32_16x16x32_bf16 v[160:163], a[248:251], a[84:87], v[160:163]
s_waitcnt vmcnt(21)
ds_read_b128 a[88:91], v4 offset:32768
v_cvt_pk_bf16_f32 v75, v66, v67
v_mfma_f32_16x16x32_bf16 a[4:7], a[236:239], a[92:95], a[4:7]
s_waitcnt vmcnt(20)
ds_read_b128 a[92:95], v4 offset:33792
v_mfma_f32_16x16x32_bf16 a[4:7], a[252:255], a[96:99], a[4:7]
ds_write_addtid_b32 v75 offset:62980
v_mfma_f32_16x16x32_bf16 a[12:15], a[236:239], a[96:99], a[12:15]
ds_read_b128 a[96:99], v4 offset:34816
v_sub_f32 v66, v62, v54
v_mfma_f32_16x16x32_bf16 a[12:15], a[252:255], a[100:103], a[12:15]
buffer_load_dwordx4 a[188:191], v9, s[16:19], s69 offen offset:3072 sc1
v_mfma_f32_16x16x32_bf16 a[20:23], a[236:239], a[100:103], a[20:23]
ds_read_b128 a[100:103], v4 offset:35840
v_sub_f32 v67, v63, v55
v_mfma_f32_16x16x32_bf16 a[20:23], a[252:255], a[104:107], a[20:23]
v_cvt_pk_bf16_f32 v68, v66, v67
v_mfma_f32_16x16x32_bf16 a[28:31], a[236:239], a[104:107], a[28:31]
ds_read_b128 a[104:107], v6 offset:32768
v_mfma_f32_16x16x32_bf16 a[28:31], a[252:255], a[108:111], a[28:31]
ds_write_addtid_b32 v68 offset:63236
v_mfma_f32_16x16x32_bf16 a[36:39], a[236:239], a[108:111], a[36:39]
ds_read_b128 a[108:111], v6 offset:33792
v_lshlrev_b32 v56, 16, v32
v_mfma_f32_16x16x32_bf16 a[36:39], a[252:255], a[112:115], a[36:39]
s_mov_b32 s35, 98304
s_mov_b32 s69, 102400
v_and_b32 v57, s39, v32
v_mfma_f32_16x16x32_bf16 v[148:151], a[236:239], a[112:115], v[148:151]
ds_read_b128 a[112:115], v6 offset:34816
v_lshlrev_b32 v58, 16, v33
v_mfma_f32_16x16x32_bf16 v[148:151], a[252:255], a[116:119], v[148:151]
buffer_load_dwordx4 a[192:195], v9, s[16:19], s35 offen offset:0 sc1
v_mfma_f32_16x16x32_bf16 v[156:159], a[236:239], a[116:119], v[156:159]
ds_read_b128 a[116:119], v6 offset:35840
v_and_b32 v59, s39, v33
v_mfma_f32_16x16x32_bf16 v[156:159], a[252:255], a[80:83], v[156:159]
v_lshlrev_b32 v60, 16, v34
v_and_b32 v61, s39, v34
v_mfma_f32_16x16x32_bf16 v[164:167], a[236:239], a[80:83], v[164:167]
ds_read_b128 a[80:83], v8 offset:32768
v_lshlrev_b32 v62, 16, v35
v_mfma_f32_16x16x32_bf16 v[164:167], a[252:255], a[84:87], v[164:167]
s_waitcnt vmcnt(20) lgkmcnt(10)
buffer_load_dwordx4 a[208:211], v9, s[16:19], s69 offen offset:0 sc1
v_mfma_f32_16x16x32_bf16 v[168:171], a[128:131], a[88:91], v[168:171]
s_waitcnt vmcnt(19) lgkmcnt(9)
v_and_b32 v63, s39, v35
s_mov_b32 m0, s6
v_mfma_f32_16x16x32_bf16 v[168:171], a[144:147], a[92:95], v[168:171]
v_lshlrev_b32 v64, 16, v36
v_and_b32 v65, s39, v36
v_mfma_f32_16x16x32_bf16 v[176:179], a[128:131], a[92:95], v[176:179]
s_waitcnt lgkmcnt(7)
v_sub_f32 v66, v56, v64
v_sub_f32 v67, v57, v65
v_mfma_f32_16x16x32_bf16 v[176:179], a[144:147], a[96:99], v[176:179]
buffer_load_dwordx4 a[196:199], v9, s[16:19], s35 offen offset:1024 sc1
v_mfma_f32_16x16x32_bf16 v[184:187], a[128:131], a[96:99], v[184:187]
s_waitcnt lgkmcnt(6)
v_cvt_pk_bf16_f32 v69, v66, v67
v_mfma_f32_16x16x32_bf16 v[184:187], a[144:147], a[100:103], v[184:187]
ds_write_addtid_b32 v69 offset:2048
v_mfma_f32_16x16x32_bf16 v[192:195], a[128:131], a[100:103], v[192:195]
s_waitcnt lgkmcnt(6)
v_add_f32 v66, v56, v64
v_add_f32 v67, v57, v65
v_mfma_f32_16x16x32_bf16 v[192:195], a[144:147], a[104:107], v[192:195]
v_cvt_pk_bf16_f32 v70, v66, v67
v_mfma_f32_16x16x32_bf16 v[200:203], a[128:131], a[104:107], v[200:203]
s_waitcnt lgkmcnt(4)
buffer_load_dwordx4 a[212:215], v9, s[16:19], s69 offen offset:1024 sc1
v_mfma_f32_16x16x32_bf16 v[200:203], a[144:147], a[108:111], v[200:203]
ds_write_addtid_b32 v70 offset:18432
v_mfma_f32_16x16x32_bf16 v[208:211], a[128:131], a[108:111], v[208:211]
s_waitcnt lgkmcnt(4)
v_lshlrev_b32 v64, 16, v37
v_and_b32 v65, s39, v37
v_mfma_f32_16x16x32_bf16 v[208:211], a[144:147], a[112:115], v[208:211]
v_sub_f32 v66, v58, v64
v_sub_f32 v67, v59, v65
v_mfma_f32_16x16x32_bf16 v[216:219], a[128:131], a[112:115], v[216:219]
s_waitcnt lgkmcnt(3)
v_cvt_pk_bf16_f32 v71, v66, v67
v_mfma_f32_16x16x32_bf16 v[216:219], a[144:147], a[116:119], v[216:219]
buffer_load_dwordx4 a[200:203], v9, s[16:19], s35 offen offset:2048 sc1
v_mfma_f32_16x16x32_bf16 v[224:227], a[128:131], a[116:119], v[224:227]
s_waitcnt lgkmcnt(2)
ds_write_addtid_b32 v71 offset:2304
v_mfma_f32_16x16x32_bf16 v[224:227], a[144:147], a[80:83], v[224:227]
s_waitcnt vmcnt(21)
v_add_f32 v66, v58, v64
v_add_f32 v67, v59, v65
v_mfma_f32_16x16x32_bf16 v[172:175], a[132:135], a[88:91], v[172:175]
s_waitcnt vmcnt(20)
v_cvt_pk_bf16_f32 v72, v66, v67
v_mfma_f32_16x16x32_bf16 v[172:175], a[148:151], a[92:95], v[172:175]
ds_write_addtid_b32 v72 offset:18688
v_mfma_f32_16x16x32_bf16 v[180:183], a[132:135], a[92:95], v[180:183]
buffer_load_dwordx4 a[216:219], v9, s[16:19], s69 offen offset:2048 sc1
v_mfma_f32_16x16x32_bf16 v[180:183], a[148:151], a[96:99], v[180:183]
v_lshlrev_b32 v64, 16, v38
v_and_b32 v65, s39, v38
v_mfma_f32_16x16x32_bf16 v[188:191], a[132:135], a[96:99], v[188:191]
v_sub_f32 v66, v60, v64
v_sub_f32 v67, v61, v65
v_mfma_f32_16x16x32_bf16 v[188:191], a[148:151], a[100:103], v[188:191]
v_cvt_pk_bf16_f32 v73, v66, v67
v_mfma_f32_16x16x32_bf16 v[196:199], a[132:135], a[100:103], v[196:199]
ds_write_addtid_b32 v73 offset:2560
v_mfma_f32_16x16x32_bf16 v[196:199], a[148:151], a[104:107], v[196:199]
buffer_load_dwordx4 a[204:207], v9, s[16:19], s35 offen offset:3072 sc1
v_mfma_f32_16x16x32_bf16 v[204:207], a[132:135], a[104:107], v[204:207]
v_add_f32 v66, v60, v64
v_add_f32 v67, v61, v65
v_mfma_f32_16x16x32_bf16 v[204:207], a[148:151], a[108:111], v[204:207]
v_cvt_pk_bf16_f32 v74, v66, v67
v_mfma_f32_16x16x32_bf16 v[212:215], a[132:135], a[108:111], v[212:215]
ds_write_addtid_b32 v74 offset:18944
v_mfma_f32_16x16x32_bf16 v[212:215], a[148:151], a[112:115], v[212:215]
v_lshlrev_b32 v64, 16, v39
v_and_b32 v65, s39, v39
v_mfma_f32_16x16x32_bf16 v[220:223], a[132:135], a[112:115], v[220:223]
buffer_load_dwordx4 a[220:223], v9, s[16:19], s69 offen offset:3072 sc1
v_mfma_f32_16x16x32_bf16 v[220:223], a[148:151], a[116:119], v[220:223]
v_sub_f32 v66, v62, v64
v_sub_f32 v67, v63, v65
v_mfma_f32_16x16x32_bf16 v[228:231], a[132:135], a[116:119], v[228:231]
v_cvt_pk_bf16_f32 v75, v66, v67
v_mfma_f32_16x16x32_bf16 v[228:231], a[148:151], a[80:83], v[228:231]
s_waitcnt vmcnt(22)
ds_write_addtid_b32 v75 offset:2816
v_mfma_f32_16x16x32_bf16 a[40:43], a[136:139], a[88:91], a[40:43]
s_waitcnt vmcnt(20)
v_add_f32 v66, v62, v64
v_add_f32 v67, v63, v65
v_mfma_f32_16x16x32_bf16 a[40:43], a[152:155], a[92:95], a[40:43]
s_mov_b32 s35, 106496
s_mov_b32 s69, 110592
v_cvt_pk_bf16_f32 v68, v66, v67
v_mfma_f32_16x16x32_bf16 a[48:51], a[136:139], a[92:95], a[48:51]
buffer_load_dwordx4 a[224:227], v9, s[16:19], s35 offen offset:0 sc1
v_mfma_f32_16x16x32_bf16 a[48:51], a[152:155], a[96:99], a[48:51]
ds_write_addtid_b32 v68 offset:19200
v_mfma_f32_16x16x32_bf16 a[56:59], a[136:139], a[96:99], a[56:59]
s_mov_b32 m0, s7
v_sub_f32 v66, v48, v56
v_sub_f32 v67, v49, v57
v_mfma_f32_16x16x32_bf16 a[56:59], a[152:155], a[100:103], a[56:59]
v_cvt_pk_bf16_f32 v69, v66, v67
v_mfma_f32_16x16x32_bf16 a[64:67], a[136:139], a[100:103], a[64:67]
buffer_load_dwordx4 a[240:243], v9, s[16:19], s69 offen offset:0 sc1
v_mfma_f32_16x16x32_bf16 a[64:67], a[152:155], a[104:107], a[64:67]
ds_write_addtid_b32 v69 offset:63492
v_mfma_f32_16x16x32_bf16 a[72:75], a[136:139], a[104:107], a[72:75]
v_sub_f32 v66, v50, v58
v_sub_f32 v67, v51, v59
v_mfma_f32_16x16x32_bf16 a[72:75], a[152:155], a[108:111], a[72:75]
v_cvt_pk_bf16_f32 v70, v66, v67
v_mfma_f32_16x16x32_bf16 v[232:235], a[136:139], a[108:111], v[232:235]
ds_write_addtid_b32 v70 offset:63748
v_mfma_f32_16x16x32_bf16 v[232:235], a[152:155], a[112:115], v[232:235]
buffer_load_dwordx4 a[228:231], v9, s[16:19], s35 offen offset:1024 sc1
v_mfma_f32_16x16x32_bf16 v[240:243], a[136:139], a[112:115], v[240:243]
v_sub_f32 v66, v52, v60
v_sub_f32 v67, v53, v61
v_mfma_f32_16x16x32_bf16 v[240:243], a[152:155], a[116:119], v[240:243]
v_cvt_pk_bf16_f32 v71, v66, v67
v_mfma_f32_16x16x32_bf16 v[248:251], a[136:139], a[116:119], v[248:251]
ds_write_addtid_b32 v71 offset:64004
v_mfma_f32_16x16x32_bf16 v[248:251], a[152:155], a[80:83], v[248:251]
s_waitcnt vmcnt(22)
ds_read_b128 a[84:87], v4 offset:49152
v_sub_f32 v66, v54, v62
v_mfma_f32_16x16x32_bf16 a[44:47], a[140:143], a[88:91], a[44:47]
s_waitcnt vmcnt(21)
ds_read_b128 a[88:91], v4 offset:50176
v_sub_f32 v67, v55, v63
v_mfma_f32_16x16x32_bf16 a[44:47], a[156:159], a[92:95], a[44:47]
buffer_load_dwordx4 a[244:247], v9, s[16:19], s69 offen offset:1024 sc1
v_mfma_f32_16x16x32_bf16 a[52:55], a[140:143], a[92:95], a[52:55]
ds_read_b128 a[92:95], v4 offset:51200
v_cvt_pk_bf16_f32 v72, v66, v67
v_mfma_f32_16x16x32_bf16 a[52:55], a[156:159], a[96:99], a[52:55]
ds_write_addtid_b32 v72 offset:64260
v_mfma_f32_16x16x32_bf16 a[60:63], a[140:143], a[96:99], a[60:63]
ds_read_b128 a[96:99], v4 offset:52224
v_lshlrev_b32 v48, 16, v40
v_mfma_f32_16x16x32_bf16 a[60:63], a[156:159], a[100:103], a[60:63]
buffer_load_dwordx4 a[232:235], v9, s[16:19], s35 offen offset:2048 sc1
v_mfma_f32_16x16x32_bf16 a[68:71], a[140:143], a[100:103], a[68:71]
ds_read_b128 a[100:103], v6 offset:49152
v_and_b32 v49, s39, v40
v_mfma_f32_16x16x32_bf16 a[68:71], a[156:159], a[104:107], a[68:71]
v_lshlrev_b32 v50, 16, v41
v_and_b32 v51, s39, v41
v_mfma_f32_16x16x32_bf16 a[76:79], a[140:143], a[104:107], a[76:79]
ds_read_b128 a[104:107], v6 offset:50176
v_lshlrev_b32 v52, 16, v42
v_mfma_f32_16x16x32_bf16 a[76:79], a[156:159], a[108:111], a[76:79]
v_and_b32 v53, s39, v42
v_lshlrev_b32 v54, 16, v43
v_mfma_f32_16x16x32_bf16 v[236:239], a[140:143], a[108:111], v[236:239]
ds_read_b128 a[108:111], v6 offset:51200
v_and_b32 v55, s39, v43
v_mfma_f32_16x16x32_bf16 v[236:239], a[156:159], a[112:115], v[236:239]
s_mov_b32 m0, s6
buffer_load_dwordx4 a[248:251], v9, s[16:19], s69 offen offset:2048 sc1
v_mfma_f32_16x16x32_bf16 v[244:247], a[140:143], a[112:115], v[244:247]
ds_read_b128 a[112:115], v6 offset:52224
v_lshlrev_b32 v64, 16, v44
v_mfma_f32_16x16x32_bf16 v[244:247], a[156:159], a[116:119], v[244:247]
v_and_b32 v65, s39, v44
v_sub_f32 v66, v48, v64
v_mfma_f32_16x16x32_bf16 v[252:255], a[140:143], a[116:119], v[252:255]
ds_read_b128 a[116:119], v8 offset:49152
v_sub_f32 v67, v49, v65
v_mfma_f32_16x16x32_bf16 v[252:255], a[156:159], a[80:83], v[252:255]
s_waitcnt vmcnt(23) lgkmcnt(9)
buffer_load_dwordx4 a[236:239], v9, s[16:19], s35 offen offset:3072 sc1
v_mfma_f32_16x16x32_bf16 v[80:83], a[160:163], a[84:87], v[80:83]
s_waitcnt vmcnt(22) lgkmcnt(8)
v_cvt_pk_bf16_f32 v73, v66, v67
v_mfma_f32_16x16x32_bf16 v[80:83], a[176:179], a[88:91], v[80:83]
ds_write_addtid_b32 v73 offset:3072
v_mfma_f32_16x16x32_bf16 v[88:91], a[160:163], a[88:91], v[88:91]
s_waitcnt lgkmcnt(8)
v_add_f32 v66, v48, v64
v_add_f32 v67, v49, v65
v_mfma_f32_16x16x32_bf16 v[88:91], a[176:179], a[92:95], v[88:91]
v_cvt_pk_bf16_f32 v74, v66, v67
v_mfma_f32_16x16x32_bf16 v[96:99], a[160:163], a[92:95], v[96:99]
s_waitcnt lgkmcnt(6)
buffer_load_dwordx4 a[252:255], v9, s[16:19], s69 offen offset:3072 sc1
v_mfma_f32_16x16x32_bf16 v[96:99], a[176:179], a[96:99], v[96:99]
ds_write_addtid_b32 v74 offset:19456
v_mfma_f32_16x16x32_bf16 v[104:107], a[160:163], a[96:99], v[104:107]
s_waitcnt lgkmcnt(6)
v_lshlrev_b32 v64, 16, v45
v_and_b32 v65, s39, v45
v_mfma_f32_16x16x32_bf16 v[104:107], a[176:179], a[100:103], v[104:107]
v_sub_f32 v66, v50, v64
v_sub_f32 v67, v51, v65
v_mfma_f32_16x16x32_bf16 v[112:115], a[160:163], a[100:103], v[112:115]
s_waitcnt lgkmcnt(5)
v_cvt_pk_bf16_f32 v75, v66, v67
v_mfma_f32_16x16x32_bf16 v[112:115], a[176:179], a[104:107], v[112:115]
s_mov_b32 s35, 114688
s_mov_b32 s69, 118784
v_mfma_f32_16x16x32_bf16 v[120:123], a[160:163], a[104:107], v[120:123]
s_waitcnt lgkmcnt(4)
buffer_load_dwordx4 a[128:131], v9, s[16:19], s35 offen offset:0 sc1
v_mfma_f32_16x16x32_bf16 v[120:123], a[176:179], a[108:111], v[120:123]
ds_write_addtid_b32 v75 offset:3328
v_mfma_f32_16x16x32_bf16 v[128:131], a[160:163], a[108:111], v[128:131]
s_waitcnt lgkmcnt(4)
v_add_f32 v66, v50, v64
v_add_f32 v67, v51, v65
v_mfma_f32_16x16x32_bf16 v[128:131], a[176:179], a[112:115], v[128:131]
v_cvt_pk_bf16_f32 v68, v66, v67
v_mfma_f32_16x16x32_bf16 v[136:139], a[160:163], a[112:115], v[136:139]
s_waitcnt lgkmcnt(3)
buffer_load_dwordx4 a[144:147], v9, s[16:19], s69 offen offset:0 sc1
v_mfma_f32_16x16x32_bf16 v[136:139], a[176:179], a[116:119], v[136:139]
s_waitcnt vmcnt(24)
ds_write_addtid_b32 v68 offset:19712
v_mfma_f32_16x16x32_bf16 v[84:87], a[164:167], a[84:87], v[84:87]
s_waitcnt vmcnt(23)
v_lshlrev_b32 v64, 16, v46
v_and_b32 v65, s39, v46
v_mfma_f32_16x16x32_bf16 v[84:87], a[180:183], a[88:91], v[84:87]
v_sub_f32 v66, v52, v64
v_sub_f32 v67, v53, v65
v_mfma_f32_16x16x32_bf16 v[92:95], a[164:167], a[88:91], v[92:95]
v_cvt_pk_bf16_f32 v69, v66, v67
v_mfma_f32_16x16x32_bf16 v[92:95], a[180:183], a[92:95], v[92:95]
buffer_load_dwordx4 a[132:135], v9, s[16:19], s35 offen offset:1024 sc1
v_mfma_f32_16x16x32_bf16 v[100:103], a[164:167], a[92:95], v[100:103]
ds_write_addtid_b32 v69 offset:3584
v_mfma_f32_16x16x32_bf16 v[100:103], a[180:183], a[96:99], v[100:103]
v_add_f32 v66, v52, v64
v_add_f32 v67, v53, v65
v_mfma_f32_16x16x32_bf16 v[108:111], a[164:167], a[96:99], v[108:111]
v_cvt_pk_bf16_f32 v70, v66, v67
v_mfma_f32_16x16x32_bf16 v[108:111], a[180:183], a[100:103], v[108:111]
ds_write_addtid_b32 v70 offset:19968
v_mfma_f32_16x16x32_bf16 v[116:119], a[164:167], a[100:103], v[116:119]
v_lshlrev_b32 v64, 16, v47
v_and_b32 v65, s39, v47
v_mfma_f32_16x16x32_bf16 v[116:119], a[180:183], a[104:107], v[116:119]
v_sub_f32 v66, v54, v64
v_sub_f32 v67, v55, v65
v_mfma_f32_16x16x32_bf16 v[124:127], a[164:167], a[104:107], v[124:127]
buffer_load_dwordx4 a[148:151], v9, s[16:19], s69 offen offset:1024 sc1
v_mfma_f32_16x16x32_bf16 v[124:127], a[180:183], a[108:111], v[124:127]
v_cvt_pk_bf16_f32 v71, v66, v67
v_mfma_f32_16x16x32_bf16 v[132:135], a[164:167], a[108:111], v[132:135]
ds_write_addtid_b32 v71 offset:3840
v_mfma_f32_16x16x32_bf16 v[132:135], a[180:183], a[112:115], v[132:135]
v_add_f32 v66, v54, v64
v_add_f32 v67, v55, v65
v_mfma_f32_16x16x32_bf16 v[140:143], a[164:167], a[112:115], v[140:143]
v_cvt_pk_bf16_f32 v72, v66, v67
v_mfma_f32_16x16x32_bf16 v[140:143], a[180:183], a[116:119], v[140:143]
s_waitcnt vmcnt(24)
ds_write_addtid_b32 v72 offset:20224
v_mfma_f32_16x16x32_bf16 a[0:3], a[168:171], a[84:87], a[0:3]
s_waitcnt vmcnt(22)
s_mov_b32 m0, s7
v_sub_f32 v66, v56, v48
v_sub_f32 v67, v57, v49
v_mfma_f32_16x16x32_bf16 a[0:3], a[184:187], a[88:91], a[0:3]
buffer_load_dwordx4 a[136:139], v9, s[16:19], s35 offen offset:2048 sc1
v_mfma_f32_16x16x32_bf16 a[8:11], a[168:171], a[88:91], a[8:11]
v_cvt_pk_bf16_f32 v73, v66, v67
v_mfma_f32_16x16x32_bf16 a[8:11], a[184:187], a[92:95], a[8:11]
ds_write_addtid_b32 v73 offset:64516
v_mfma_f32_16x16x32_bf16 a[16:19], a[168:171], a[92:95], a[16:19]
v_sub_f32 v66, v58, v50
v_sub_f32 v67, v59, v51
v_mfma_f32_16x16x32_bf16 a[16:19], a[184:187], a[96:99], a[16:19]
v_cvt_pk_bf16_f32 v74, v66, v67
v_mfma_f32_16x16x32_bf16 a[24:27], a[168:171], a[96:99], a[24:27]
buffer_load_dwordx4 a[152:155], v9, s[16:19], s69 offen offset:2048 sc1
v_mfma_f32_16x16x32_bf16 a[24:27], a[184:187], a[100:103], a[24:27]
ds_write_addtid_b32 v74 offset:64772
v_mfma_f32_16x16x32_bf16 a[32:35], a[168:171], a[100:103], a[32:35]
v_sub_f32 v66, v60, v52
v_sub_f32 v67, v61, v53
v_mfma_f32_16x16x32_bf16 a[32:35], a[184:187], a[104:107], a[32:35]
v_cvt_pk_bf16_f32 v75, v66, v67
v_mfma_f32_16x16x32_bf16 v[144:147], a[168:171], a[104:107], v[144:147]
ds_write_addtid_b32 v75 offset:65028
v_sub_f32 v66, v62, v54
v_sub_f32 v67, v63, v55
v_cvt_pk_bf16_f32 v68, v66, v67
ds_write_addtid_b32 v68 offset:65284
v_mfma_f32_16x16x32_bf16 v[144:147], a[184:187], a[108:111], v[144:147]
buffer_load_dwordx4 a[140:143], v9, s[16:19], s35 offen offset:3072 sc1
v_mfma_f32_16x16x32_bf16 v[152:155], a[168:171], a[108:111], v[152:155]
v_mfma_f32_16x16x32_bf16 v[152:155], a[184:187], a[112:115], v[152:155]
v_mfma_f32_16x16x32_bf16 v[160:163], a[168:171], a[112:115], v[160:163]
s_waitcnt lgkmcnt(0)
s_barrier
v_mfma_f32_16x16x32_bf16 v[160:163], a[184:187], a[116:119], v[160:163]
s_waitcnt vmcnt(24)
s_mov_b32 m0, s7
ds_read_b128 a[80:83], v3 offset:0
v_lshlrev_b32 v48, 16, v12
v_mfma_f32_16x16x32_bf16 a[4:7], a[172:175], a[84:87], a[4:7]
s_waitcnt vmcnt(23)
ds_read_b128 a[84:87], v3 offset:1024
buffer_load_dwordx4 a[156:159], v9, s[16:19], s69 offen offset:3072 sc1
v_mfma_f32_16x16x32_bf16 a[4:7], a[188:191], a[88:91], a[4:7]
s_mov_b32 s35, 122880
s_mov_b32 s69, 126976
v_and_b32 v49, s39, v12
v_mfma_f32_16x16x32_bf16 a[12:15], a[172:175], a[88:91], a[12:15]
ds_read_b128 a[88:91], v3 offset:2048
v_lshlrev_b32 v50, 16, v13
v_mfma_f32_16x16x32_bf16 a[12:15], a[188:191], a[92:95], a[12:15]
buffer_load_dwordx4 a[160:163], v9, s[16:19], s35 offen offset:0 sc1
v_mfma_f32_16x16x32_bf16 a[20:23], a[172:175], a[92:95], a[20:23]
v_and_b32 v51, s39, v13
v_lshlrev_b32 v52, 16, v14
v_mfma_f32_16x16x32_bf16 a[20:23], a[188:191], a[96:99], a[20:23]
v_and_b32 v53, s39, v14
v_lshlrev_b32 v54, 16, v15
v_mfma_f32_16x16x32_bf16 a[28:31], a[172:175], a[96:99], a[28:31]
v_and_b32 v55, s39, v15
v_lshlrev_b32 v56, 16, v16
v_mfma_f32_16x16x32_bf16 a[28:31], a[188:191], a[100:103], a[28:31]
buffer_load_dwordx4 a[176:179], v9, s[16:19], s69 offen offset:0 sc1
v_mfma_f32_16x16x32_bf16 a[36:39], a[172:175], a[100:103], a[36:39]
v_and_b32 v57, s39, v16
v_lshlrev_b32 v58, 16, v17
v_mfma_f32_16x16x32_bf16 a[36:39], a[188:191], a[104:107], a[36:39]
v_and_b32 v59, s39, v17
v_lshlrev_b32 v60, 16, v18
v_mfma_f32_16x16x32_bf16 v[148:151], a[172:175], a[104:107], v[148:151]
v_and_b32 v61, s39, v18
v_lshlrev_b32 v62, 16, v19
v_mfma_f32_16x16x32_bf16 v[148:151], a[188:191], a[108:111], v[148:151]
buffer_load_dwordx4 a[164:167], v9, s[16:19], s35 offen offset:1024 sc1
v_mfma_f32_16x16x32_bf16 v[156:159], a[172:175], a[108:111], v[156:159]
v_and_b32 v63, s39, v19
v_sub_f32 v66, v48, v56
v_mfma_f32_16x16x32_bf16 v[156:159], a[188:191], a[112:115], v[156:159]
v_sub_f32 v67, v49, v57
v_cvt_pk_bf16_f32 v69, v66, v67
v_mfma_f32_16x16x32_bf16 v[164:167], a[172:175], a[112:115], v[164:167]
ds_write_addtid_b32 v69 offset:12292
v_mfma_f32_16x16x32_bf16 v[164:167], a[188:191], a[116:119], v[164:167]
s_waitcnt vmcnt(26) lgkmcnt(3)
ds_read_b128 a[92:95], v3 offset:16384
v_sub_f32 v66, v50, v58
v_mfma_f32_16x16x32_bf16 v[168:171], a[192:195], a[80:83], v[168:171]
s_waitcnt vmcnt(25) lgkmcnt(3)
ds_read_b128 a[96:99], v3 offset:17408
v_sub_f32 v67, v51, v59
v_mfma_f32_16x16x32_bf16 v[168:171], a[208:211], a[84:87], v[168:171]
buffer_load_dwordx4 a[180:183], v9, s[16:19], s69 offen offset:1024 sc1
v_mfma_f32_16x16x32_bf16 v[176:179], a[192:195], a[84:87], v[176:179]
s_waitcnt lgkmcnt(3)
ds_read_b128 a[100:103], v3 offset:18432
v_cvt_pk_bf16_f32 v70, v66, v67
v_mfma_f32_16x16x32_bf16 v[176:179], a[208:211], a[88:91], v[176:179]
s_waitcnt vmcnt(25)
ds_write_addtid_b32 v70 offset:12548
v_mfma_f32_16x16x32_bf16 v[172:175], a[196:199], a[80:83], v[172:175]
s_waitcnt vmcnt(24)
v_sub_f32 v66, v52, v60
v_sub_f32 v67, v53, v61
v_mfma_f32_16x16x32_bf16 v[172:175], a[212:215], a[84:87], v[172:175]
buffer_load_dwordx4 a[168:171], v9, s[16:19], s35 offen offset:2048 sc1
v_mfma_f32_16x16x32_bf16 v[180:183], a[196:199], a[84:87], v[180:183]
v_cvt_pk_bf16_f32 v71, v66, v67
v_mfma_f32_16x16x32_bf16 v[180:183], a[212:215], a[88:91], v[180:183]
s_waitcnt vmcnt(24)
ds_write_addtid_b32 v71 offset:12804
v_mfma_f32_16x16x32_bf16 a[40:43], a[200:203], a[80:83], a[40:43]
s_waitcnt vmcnt(23)
v_sub_f32 v66, v54, v62
v_sub_f32 v67, v55, v63
v_mfma_f32_16x16x32_bf16 a[40:43], a[216:219], a[84:87], a[40:43]
v_cvt_pk_bf16_f32 v72, v66, v67
v_mfma_f32_16x16x32_bf16 a[48:51], a[200:203], a[84:87], a[48:51]
buffer_load_dwordx4 a[184:187], v9, s[16:19], s69 offen offset:2048 sc1
v_mfma_f32_16x16x32_bf16 a[48:51], a[216:219], a[88:91], a[48:51]
s_waitcnt vmcnt(23)
ds_write_addtid_b32 v72 offset:13060
v_mfma_f32_16x16x32_bf16 a[44:47], a[204:207], a[80:83], a[44:47]
s_waitcnt vmcnt(22)
v_lshlrev_b32 v48, 16, v20
v_and_b32 v49, s39, v20
v_mfma_f32_16x16x32_bf16 a[44:47], a[220:223], a[84:87], a[44:47]
v_lshlrev_b32 v50, 16, v21
v_and_b32 v51, s39, v21
v_mfma_f32_16x16x32_bf16 a[52:55], a[204:207], a[84:87], a[52:55]
v_lshlrev_b32 v52, 16, v22
v_and_b32 v53, s39, v22
v_mfma_f32_16x16x32_bf16 a[52:55], a[220:223], a[88:91], a[52:55]
s_waitcnt vmcnt(21) lgkmcnt(5)
ds_read_b128 a[104:107], v4 offset:0
v_lshlrev_b32 v54, 16, v23
v_mfma_f32_16x16x32_bf16 v[80:83], a[224:227], a[92:95], v[80:83]
s_waitcnt vmcnt(20) lgkmcnt(5)
ds_read_b128 a[108:111], v4 offset:1024
v_and_b32 v55, s39, v23
v_mfma_f32_16x16x32_bf16 v[80:83], a[240:243], a[96:99], v[80:83]
buffer_load_dwordx4 a[172:175], v9, s[16:19], s35 offen offset:3072 sc1
v_mfma_f32_16x16x32_bf16 v[88:91], a[224:227], a[96:99], v[88:91]
s_waitcnt lgkmcnt(5)
ds_read_b128 a[112:115], v4 offset:2048
v_sub_f32 v66, v56, v48
v_mfma_f32_16x16x32_bf16 v[88:91], a[240:243], a[100:103], v[88:91]
s_waitcnt vmcnt(20)
v_sub_f32 v67, v57, v49
v_cvt_pk_bf16_f32 v73, v66, v67
v_mfma_f32_16x16x32_bf16 v[84:87], a[228:231], a[92:95], v[84:87]
s_waitcnt vmcnt(19)
ds_write_addtid_b32 v73 offset:13316
v_mfma_f32_16x16x32_bf16 v[84:87], a[244:247], a[96:99], v[84:87]
v_sub_f32 v66, v58, v50
v_sub_f32 v67, v59, v51
v_mfma_f32_16x16x32_bf16 v[92:95], a[228:231], a[96:99], v[92:95]
v_cvt_pk_bf16_f32 v74, v66, v67
v_mfma_f32_16x16x32_bf16 v[92:95], a[244:247], a[100:103], v[92:95]
s_waitcnt vmcnt(18)
buffer_load_dwordx4 a[188:191], v9, s[16:19], s69 offen offset:3072 sc1
v_mfma_f32_16x16x32_bf16 a[0:3], a[232:235], a[92:95], a[0:3]
s_waitcnt vmcnt(18)
ds_write_addtid_b32 v74 offset:13572
v_mfma_f32_16x16x32_bf16 a[0:3], a[248:251], a[96:99], a[0:3]
v_sub_f32 v66, v60, v52
v_sub_f32 v67, v61, v53
v_mfma_f32_16x16x32_bf16 a[8:11], a[232:235], a[96:99], a[8:11]
v_cvt_pk_bf16_f32 v75, v66, v67
v_mfma_f32_16x16x32_bf16 a[8:11], a[248:251], a[100:103], a[8:11]
s_waitcnt vmcnt(17)
ds_write_addtid_b32 v75 offset:13828
v_mfma_f32_16x16x32_bf16 a[4:7], a[236:239], a[92:95], a[4:7]
s_waitcnt vmcnt(16)
v_sub_f32 v66, v62, v54
v_sub_f32 v67, v63, v55
v_mfma_f32_16x16x32_bf16 a[4:7], a[252:255], a[96:99], a[4:7]
v_cvt_pk_bf16_f32 v68, v66, v67
v_mfma_f32_16x16x32_bf16 a[12:15], a[236:239], a[96:99], a[12:15]
ds_write_addtid_b32 v68 offset:14084
v_mfma_f32_16x16x32_bf16 a[12:15], a[252:255], a[100:103], a[12:15]
s_waitcnt vmcnt(15) lgkmcnt(6)
ds_read_b128 a[116:119], v4 offset:16384
v_lshlrev_b32 v56, 16, v24
v_mfma_f32_16x16x32_bf16 v[168:171], a[128:131], a[104:107], v[168:171]
s_waitcnt vmcnt(14) lgkmcnt(6)
ds_read_b128 a[80:83], v4 offset:17408
v_and_b32 v57, s39, v24
v_mfma_f32_16x16x32_bf16 v[168:171], a[144:147], a[108:111], v[168:171]
v_lshlrev_b32 v58, 16, v25
v_and_b32 v59, s39, v25
v_mfma_f32_16x16x32_bf16 v[176:179], a[128:131], a[108:111], v[176:179]
s_waitcnt lgkmcnt(6)
ds_read_b128 a[84:87], v4 offset:18432
v_lshlrev_b32 v60, 16, v26
v_mfma_f32_16x16x32_bf16 v[176:179], a[144:147], a[112:115], v[176:179]
s_waitcnt vmcnt(13)
v_and_b32 v61, s39, v26
v_lshlrev_b32 v62, 16, v27
v_mfma_f32_16x16x32_bf16 v[172:175], a[132:135], a[104:107], v[172:175]
s_waitcnt vmcnt(12)
v_and_b32 v63, s39, v27
v_sub_f32 v66, v48, v56
v_mfma_f32_16x16x32_bf16 v[172:175], a[148:151], a[108:111], v[172:175]
v_sub_f32 v67, v49, v57
v_cvt_pk_bf16_f32 v69, v66, v67
v_mfma_f32_16x16x32_bf16 v[180:183], a[132:135], a[108:111], v[180:183]
ds_write_addtid_b32 v69 offset:14340
v_mfma_f32_16x16x32_bf16 v[180:183], a[148:151], a[112:115], v[180:183]
s_waitcnt vmcnt(11)
v_sub_f32 v66, v50, v58
v_sub_f32 v67, v51, v59
v_mfma_f32_16x16x32_bf16 a[40:43], a[136:139], a[104:107], a[40:43]
s_waitcnt vmcnt(10)
v_cvt_pk_bf16_f32 v70, v66, v67
v_mfma_f32_16x16x32_bf16 a[40:43], a[152:155], a[108:111], a[40:43]
ds_write_addtid_b32 v70 offset:14596
v_mfma_f32_16x16x32_bf16 a[48:51], a[136:139], a[108:111], a[48:51]
v_sub_f32 v66, v52, v60
v_sub_f32 v67, v53, v61
v_mfma_f32_16x16x32_bf16 a[48:51], a[152:155], a[112:115], a[48:51]
s_waitcnt vmcnt(9)
v_cvt_pk_bf16_f32 v71, v66, v67
v_mfma_f32_16x16x32_bf16 a[44:47], a[140:143], a[104:107], a[44:47]
s_waitcnt vmcnt(8)
ds_write_addtid_b32 v71 offset:14852
v_mfma_f32_16x16x32_bf16 a[44:47], a[156:159], a[108:111], a[44:47]
v_sub_f32 v66, v54, v62
v_sub_f32 v67, v55, v63
v_mfma_f32_16x16x32_bf16 a[52:55], a[140:143], a[108:111], a[52:55]
v_mfma_f32_16x16x32_bf16 a[52:55], a[156:159], a[112:115], a[52:55]
s_waitcnt vmcnt(7) lgkmcnt(5)
ds_read_b128 a[88:91], v3 offset:2048
v_cvt_pk_bf16_f32 v72, v66, v67
v_mfma_f32_16x16x32_bf16 v[80:83], a[160:163], a[116:119], v[80:83]
s_waitcnt vmcnt(6) lgkmcnt(5)
ds_read_b128 a[92:95], v3 offset:3072
v_mfma_f32_16x16x32_bf16 v[80:83], a[176:179], a[80:83], v[80:83]
ds_write_addtid_b32 v72 offset:15108
v_mfma_f32_16x16x32_bf16 v[88:91], a[160:163], a[80:83], v[88:91]
s_waitcnt lgkmcnt(6)
ds_read_b128 a[96:99], v5 offset:0
v_lshlrev_b32 v48, 16, v28
v_mfma_f32_16x16x32_bf16 v[88:91], a[176:179], a[84:87], v[88:91]
s_waitcnt vmcnt(5)
v_and_b32 v49, s39, v28
v_lshlrev_b32 v50, 16, v29
v_mfma_f32_16x16x32_bf16 v[84:87], a[164:167], a[116:119], v[84:87]
s_waitcnt vmcnt(4)
ds_read_b128 a[100:103], v5 offset:1024
v_and_b32 v51, s39, v29
v_mfma_f32_16x16x32_bf16 v[84:87], a[180:183], a[80:83], v[84:87]
v_lshlrev_b32 v52, 16, v30
v_and_b32 v53, s39, v30
v_mfma_f32_16x16x32_bf16 v[92:95], a[164:167], a[80:83], v[92:95]
ds_read_b128 a[104:107], v5 offset:2048
v_lshlrev_b32 v54, 16, v31
v_mfma_f32_16x16x32_bf16 v[92:95], a[180:183], a[84:87], v[92:95]
s_waitcnt vmcnt(3)
v_and_b32 v55, s39, v31
v_sub_f32 v66, v56, v48
v_mfma_f32_16x16x32_bf16 a[0:3], a[168:171], a[116:119], a[0:3]
s_waitcnt vmcnt(2)
ds_read_b128 a[108:111], v5 offset:3072
v_sub_f32 v67, v57, v49
v_mfma_f32_16x16x32_bf16 a[0:3], a[184:187], a[80:83], a[0:3]
v_cvt_pk_bf16_f32 v73, v66, v67
v_mfma_f32_16x16x32_bf16 a[8:11], a[168:171], a[80:83], a[8:11]
ds_read_b128 a[112:115], v7 offset:0
v_mfma_f32_16x16x32_bf16 a[8:11], a[184:187], a[84:87], a[8:11]
s_waitcnt vmcnt(1)
ds_write_addtid_b32 v73 offset:15364
v_mfma_f32_16x16x32_bf16 a[4:7], a[172:175], a[116:119], a[4:7]
s_waitcnt vmcnt(0)
v_sub_f32 v66, v58, v50
v_sub_f32 v67, v59, v51
v_mfma_f32_16x16x32_bf16 a[4:7], a[188:191], a[80:83], a[4:7]
v_cvt_pk_bf16_f32 v74, v66, v67
v_mfma_f32_16x16x32_bf16 a[12:15], a[172:175], a[80:83], a[12:15]
ds_write_addtid_b32 v74 offset:15620
v_mfma_f32_16x16x32_bf16 a[12:15], a[188:191], a[84:87], a[12:15]
s_waitcnt lgkmcnt(9)
v_sub_f32 v66, v60, v52
v_sub_f32 v67, v61, v53
v_mfma_f32_16x16x32_bf16 v[184:187], a[192:195], a[88:91], v[184:187]
s_waitcnt lgkmcnt(8)
v_cvt_pk_bf16_f32 v75, v66, v67
v_mfma_f32_16x16x32_bf16 v[184:187], a[208:211], a[92:95], v[184:187]
ds_write_addtid_b32 v75 offset:15876
v_mfma_f32_16x16x32_bf16 v[192:195], a[192:195], a[92:95], v[192:195]
s_waitcnt lgkmcnt(7)
v_sub_f32 v66, v62, v54
v_sub_f32 v67, v63, v55
v_mfma_f32_16x16x32_bf16 v[192:195], a[208:211], a[96:99], v[192:195]
v_cvt_pk_bf16_f32 v68, v66, v67
v_mfma_f32_16x16x32_bf16 v[200:203], a[192:195], a[96:99], v[200:203]
s_waitcnt lgkmcnt(6)
ds_write_addtid_b32 v68 offset:16132
v_mfma_f32_16x16x32_bf16 v[200:203], a[208:211], a[100:103], v[200:203]
v_and_b32 v48, 15, v0
v_lshrrev_b32 v49, 4, v0
v_mfma_f32_16x16x32_bf16 v[208:211], a[192:195], a[100:103], v[208:211]
s_waitcnt lgkmcnt(6)
v_lshrrev_b32 v50, 1, v48
v_and_b32 v51, 1, v48
v_mfma_f32_16x16x32_bf16 v[208:211], a[208:211], a[104:107], v[208:211]
v_mfma_f32_16x16x32_bf16 v[216:219], a[192:195], a[104:107], v[216:219]
s_waitcnt lgkmcnt(5)
v_lshl_add_u32 v51, v50, 5, v51
v_add_u32 v51, s30, v51
v_mfma_f32_16x16x32_bf16 v[216:219], a[208:211], a[108:111], v[216:219]
v_lshlrev_b32 v51, 9, v51
v_lshl_add_u32 v51, v49, 4, v51
v_mfma_f32_16x16x32_bf16 v[224:227], a[192:195], a[108:111], v[224:227]
s_waitcnt lgkmcnt(4)
v_mfma_f32_16x16x32_bf16 v[224:227], a[208:211], a[112:115], v[224:227]
v_cmp_eq_u32 vcc, 7, v50
v_add_u32 v1, s51, v51
v_mfma_f32_16x16x32_bf16 v[188:191], a[196:199], a[88:91], v[188:191]
v_mov_b32 v48, 0x80000000
v_cndmask_b32 v2, v1, v48, vcc
v_mfma_f32_16x16x32_bf16 v[188:191], a[212:215], a[92:95], v[188:191]
v_mfma_f32_16x16x32_bf16 v[196:199], a[196:199], a[92:95], v[196:199]
v_mfma_f32_16x16x32_bf16 v[196:199], a[212:215], a[96:99], v[196:199]
v_mfma_f32_16x16x32_bf16 v[204:207], a[196:199], a[96:99], v[204:207]
s_waitcnt lgkmcnt(0)
s_barrier
v_mfma_f32_16x16x32_bf16 v[204:207], a[212:215], a[100:103], v[204:207]
v_accvgpr_read_b32 v12, a40
v_accvgpr_read_b32 v68, a0
v_mfma_f32_16x16x32_bf16 v[212:215], a[196:199], a[100:103], v[212:215]
v_mfma_f32_16x16x32_bf16 v[212:215], a[212:215], a[104:107], v[212:215]
v_add_f32 v168, v80, v168
v_add_f32 v12, v68, v12
v_mfma_f32_16x16x32_bf16 v[220:223], a[196:199], a[104:107], v[220:223]
v_mfma_f32_16x16x32_bf16 v[220:223], a[212:215], a[108:111], v[220:223]
v_mul_f32 v168, s42, v168
v_mul_f32 v12, s44, v12
v_mfma_f32_16x16x32_bf16 v[228:231], a[196:199], a[108:111], v[228:231]
v_mfma_f32_16x16x32_bf16 v[228:231], a[212:215], a[112:115], v[228:231]
v_exp_f32 v44, -|v168|
v_mfma_f32_16x16x32_bf16 a[56:59], a[200:203], a[88:91], a[56:59]
v_mfma_f32_16x16x32_bf16 a[56:59], a[216:219], a[92:95], a[56:59]
v_exp_f32 v52, v12
v_mfma_f32_16x16x32_bf16 a[64:67], a[200:203], a[92:95], a[64:67]
v_mfma_f32_16x16x32_bf16 a[64:67], a[216:219], a[96:99], a[64:67]
v_accvgpr_read_b32 v13, a41
v_accvgpr_read_b32 v69, a1
v_mfma_f32_16x16x32_bf16 a[72:75], a[200:203], a[96:99], a[72:75]
v_add_f32 v169, v81, v169
v_add_f32 v13, v69, v13
v_mfma_f32_16x16x32_bf16 a[72:75], a[216:219], a[100:103], a[72:75]
v_mfma_f32_16x16x32_bf16 v[232:235], a[200:203], a[100:103], v[232:235]
v_mul_f32 v169, s42, v169
v_mul_f32 v13, s44, v13
v_mfma_f32_16x16x32_bf16 v[232:235], a[216:219], a[104:107], v[232:235]
ds_read_b128 a[116:119], v3 offset:18432
v_mfma_f32_16x16x32_bf16 v[240:243], a[200:203], a[104:107], v[240:243]
ds_read_b128 a[80:83], v3 offset:19456
v_mfma_f32_16x16x32_bf16 v[240:243], a[216:219], a[108:111], v[240:243]
v_exp_f32 v45, -|v169|
v_mfma_f32_16x16x32_bf16 v[248:251], a[200:203], a[108:111], v[248:251]
ds_read_b128 a[84:87], v5 offset:16384
v_mfma_f32_16x16x32_bf16 v[248:251], a[216:219], a[112:115], v[248:251]
v_exp_f32 v53, v13
v_mfma_f32_16x16x32_bf16 a[60:63], a[204:207], a[88:91], a[60:63]
ds_read_b128 a[88:91], v5 offset:17408
v_accvgpr_read_b32 v14, a42
v_mfma_f32_16x16x32_bf16 a[60:63], a[220:223], a[92:95], a[60:63]
v_accvgpr_read_b32 v70, a2
v_add_f32 v170, v82, v170
v_mfma_f32_16x16x32_bf16 a[68:71], a[204:207], a[92:95], a[68:71]
ds_read_b128 a[92:95], v5 offset:18432
v_add_f32 v14, v70, v14
v_mfma_f32_16x16x32_bf16 a[68:71], a[220:223], a[96:99], a[68:71]
v_mul_f32 v170, s42, v170
v_mul_f32 v14, s44, v14
v_mfma_f32_16x16x32_bf16 a[76:79], a[204:207], a[96:99], a[76:79]
ds_read_b128 a[96:99], v5 offset:19456
v_mfma_f32_16x16x32_bf16 a[76:79], a[220:223], a[100:103], a[76:79]
v_exp_f32 v46, -|v170|
v_mfma_f32_16x16x32_bf16 v[236:239], a[204:207], a[100:103], v[236:239]
ds_read_b128 a[100:103], v7 offset:16384
v_mfma_f32_16x16x32_bf16 v[236:239], a[220:223], a[104:107], v[236:239]
v_exp_f32 v54, v14
v_mfma_f32_16x16x32_bf16 v[244:247], a[204:207], a[104:107], v[244:247]
v_mfma_f32_16x16x32_bf16 v[244:247], a[220:223], a[108:111], v[244:247]
v_accvgpr_read_b32 v15, a43
v_accvgpr_read_b32 v71, a3
v_mfma_f32_16x16x32_bf16 v[252:255], a[204:207], a[108:111], v[252:255]
v_add_f32 v171, v83, v171
v_add_f32 v15, v71, v15
v_mfma_f32_16x16x32_bf16 v[252:255], a[220:223], a[112:115], v[252:255]
s_waitcnt lgkmcnt(6)
v_mfma_f32_16x16x32_bf16 v[96:99], a[224:227], a[116:119], v[96:99]
s_waitcnt lgkmcnt(5)
v_mul_f32 v171, s42, v171
v_mul_f32 v15, s44, v15
v_mfma_f32_16x16x32_bf16 v[96:99], a[240:243], a[80:83], v[96:99]
s_mov_b32 s35, 131072
s_mov_b32 s69, 135168
v_mfma_f32_16x16x32_bf16 v[104:107], a[224:227], a[80:83], v[104:107]
s_waitcnt lgkmcnt(4)
buffer_load_dwordx4 a[192:195], v9, s[16:19], s35 offen offset:0 sc1
v_mfma_f32_16x16x32_bf16 v[104:107], a[240:243], a[84:87], v[104:107]
v_exp_f32 v47, -|v171|
v_mfma_f32_16x16x32_bf16 v[112:115], a[224:227], a[84:87], v[112:115]
s_waitcnt lgkmcnt(3)
v_exp_f32 v55, v15
v_mfma_f32_16x16x32_bf16 v[112:115], a[240:243], a[88:91], v[112:115]
v_mfma_f32_16x16x32_bf16 v[120:123], a[224:227], a[88:91], v[120:123]
s_waitcnt lgkmcnt(2)
buffer_load_dwordx4 a[208:211], v9, s[16:19], s69 offen offset:0 sc1
v_mfma_f32_16x16x32_bf16 v[120:123], a[240:243], a[92:95], v[120:123]
v_accvgpr_read_b32 v16, a44
v_accvgpr_read_b32 v72, a4
v_mfma_f32_16x16x32_bf16 v[128:131], a[224:227], a[92:95], v[128:131]
s_waitcnt lgkmcnt(1)
s_mov_b32 s60, L_tail-L_pc
v_add_f32 v172, v84, v172
v_mfma_f32_16x16x32_bf16 v[128:131], a[240:243], a[96:99], v[128:131]
buffer_load_dword a125, v10, s[64:67], s60 offen
v_mfma_f32_16x16x32_bf16 v[136:139], a[224:227], a[96:99], v[136:139]
s_waitcnt lgkmcnt(0)
v_add_f32 v16, v72, v16
v_mul_f32 v172, s42, v172
v_mfma_f32_16x16x32_bf16 v[136:139], a[240:243], a[100:103], v[136:139]
v_mul_f32 v16, s44, v16
v_mfma_f32_16x16x32_bf16 v[100:103], a[228:231], a[116:119], v[100:103]
v_exp_f32 v48, -|v172|
v_mfma_f32_16x16x32_bf16 v[100:103], a[244:247], a[80:83], v[100:103]
buffer_load_dwordx4 a[196:199], v9, s[16:19], s35 offen offset:1024 sc1
v_mfma_f32_16x16x32_bf16 v[108:111], a[228:231], a[80:83], v[108:111]
v_exp_f32 v56, v16
v_mfma_f32_16x16x32_bf16 v[108:111], a[244:247], a[84:87], v[108:111]
v_accvgpr_read_b32 v17, a45
v_accvgpr_read_b32 v73, a5
v_mfma_f32_16x16x32_bf16 v[116:119], a[228:231], a[84:87], v[116:119]
v_mfma_f32_16x16x32_bf16 v[116:119], a[244:247], a[88:91], v[116:119]
buffer_load_dwordx4 a[212:215], v9, s[16:19], s69 offen offset:1024 sc1
v_mfma_f32_16x16x32_bf16 v[124:127], a[228:231], a[88:91], v[124:127]
v_add_f32 v173, v85, v173
v_add_f32 v17, v73, v17
v_mfma_f32_16x16x32_bf16 v[124:127], a[244:247], a[92:95], v[124:127]
v_mul_f32 v173, s42, v173
v_mul_f32 v17, s44, v17
v_mfma_f32_16x16x32_bf16 v[132:135], a[228:231], a[92:95], v[132:135]
v_exp_f32 v49, -|v173|
v_mfma_f32_16x16x32_bf16 v[132:135], a[244:247], a[96:99], v[132:135]
buffer_load_dwordx4 a[200:203], v9, s[16:19], s35 offen offset:2048 sc1
v_mfma_f32_16x16x32_bf16 v[140:143], a[228:231], a[96:99], v[140:143]
v_exp_f32 v57, v17
v_mfma_f32_16x16x32_bf16 v[140:143], a[244:247], a[100:103], v[140:143]
v_mfma_f32_16x16x32_bf16 a[16:19], a[232:235], a[116:119], a[16:19]
v_accvgpr_read_b32 v18, a46
v_accvgpr_read_b32 v74, a6
v_mfma_f32_16x16x32_bf16 a[16:19], a[248:251], a[80:83], a[16:19]
v_mfma_f32_16x16x32_bf16 a[24:27], a[232:235], a[80:83], a[24:27]
buffer_load_dwordx4 a[216:219], v9, s[16:19], s69 offen offset:2048 sc1
v_mfma_f32_16x16x32_bf16 a[24:27], a[248:251], a[84:87], a[24:27]
v_add_f32 v174, v86, v174
v_add_f32 v18, v74, v18
v_mfma_f32_16x16x32_bf16 a[32:35], a[232:235], a[84:87], a[32:35]
v_mul_f32 v174, s42, v174
v_mul_f32 v18, s44, v18
v_mfma_f32_16x16x32_bf16 a[32:35], a[248:251], a[88:91], a[32:35]
v_exp_f32 v50, -|v174|
v_mfma_f32_16x16x32_bf16 v[144:147], a[232:235], a[88:91], v[144:147]
v_mfma_f32_16x16x32_bf16 v[144:147], a[248:251], a[92:95], v[144:147]
ds_read_b128 a[104:107], v4 offset:2048
v_mfma_f32_16x16x32_bf16 v[152:155], a[232:235], a[92:95], v[152:155]
ds_read_b128 a[108:111], v4 offset:3072
v_mfma_f32_16x16x32_bf16 v[152:155], a[248:251], a[96:99], v[152:155]
buffer_load_dwordx4 a[204:207], v9, s[16:19], s35 offen offset:3072 sc1
v_mfma_f32_16x16x32_bf16 v[160:163], a[232:235], a[96:99], v[160:163]
ds_read_b128 a[112:115], v6 offset:0
v_mfma_f32_16x16x32_bf16 v[160:163], a[248:251], a[100:103], v[160:163]
v_exp_f32 v58, v18
v_mfma_f32_16x16x32_bf16 a[20:23], a[236:239], a[116:119], a[20:23]
ds_read_b128 a[116:119], v6 offset:1024
v_accvgpr_read_b32 v19, a47
v_mfma_f32_16x16x32_bf16 a[20:23], a[252:255], a[80:83], a[20:23]
buffer_load_dwordx4 a[220:223], v9, s[16:19], s69 offen offset:3072 sc1
v_mfma_f32_16x16x32_bf16 a[28:31], a[236:239], a[80:83], a[28:31]
ds_read_b128 a[80:83], v6 offset:2048
v_accvgpr_read_b32 v75, a7
v_mfma_f32_16x16x32_bf16 a[28:31], a[252:255], a[84:87], a[28:31]
v_add_f32 v175, v87, v175
v_add_f32 v19, v75, v19
v_mfma_f32_16x16x32_bf16 a[36:39], a[236:239], a[84:87], a[36:39]
ds_read_b128 a[84:87], v6 offset:3072
v_mul_f32 v175, s42, v175
v_mfma_f32_16x16x32_bf16 a[36:39], a[252:255], a[88:91], a[36:39]
s_mov_b32 s35, 139264
s_mov_b32 s69, 143360
v_mul_f32 v19, s44, v19
v_mfma_f32_16x16x32_bf16 v[148:151], a[236:239], a[88:91], v[148:151]
ds_read_b128 a[88:91], v8 offset:0
v_mfma_f32_16x16x32_bf16 v[148:151], a[252:255], a[92:95], v[148:151]
buffer_load_dwordx4 a[224:227], v9, s[16:19], s35 offen offset:0 sc1
v_mfma_f32_16x16x32_bf16 v[156:159], a[236:239], a[92:95], v[156:159]
v_exp_f32 v51, -|v175|
v_mfma_f32_16x16x32_bf16 v[156:159], a[252:255], a[96:99], v[156:159]
v_exp_f32 v59, v19
v_mfma_f32_16x16x32_bf16 v[164:167], a[236:239], a[96:99], v[164:167]
v_accvgpr_read_b32 v20, a48
v_accvgpr_read_b32 v60, a8
v_mfma_f32_16x16x32_bf16 v[164:167], a[252:255], a[100:103], v[164:167]
s_waitcnt lgkmcnt(6)
buffer_load_dwordx4 a[240:243], v9, s[16:19], s69 offen offset:0 sc1
v_mfma_f32_16x16x32_bf16 v[184:187], a[128:131], a[104:107], v[184:187]
s_waitcnt lgkmcnt(5)
v_add_f32 v176, v88, v176
v_add_f32 v20, v60, v20
v_mfma_f32_16x16x32_bf16 v[184:187], a[144:147], a[108:111], v[184:187]
v_mul_f32 v176, s42, v176
v_mul_f32 v20, s44, v20
v_mfma_f32_16x16x32_bf16 v[192:195], a[128:131], a[108:111], v[192:195]
s_waitcnt lgkmcnt(4)
v_exp_f32 v36, -|v176|
v_mfma_f32_16x16x32_bf16 v[192:195], a[144:147], a[112:115], v[192:195]
buffer_load_dwordx4 a[228:231], v9, s[16:19], s35 offen offset:1024 sc1
v_mfma_f32_16x16x32_bf16 v[200:203], a[128:131], a[112:115], v[200:203]
s_waitcnt lgkmcnt(3)
v_exp_f32 v28, v20
v_mfma_f32_16x16x32_bf16 v[200:203], a[144:147], a[116:119], v[200:203]
v_accvgpr_read_b32 v21, a49
v_accvgpr_read_b32 v61, a9
v_mfma_f32_16x16x32_bf16 v[208:211], a[128:131], a[116:119], v[208:211]
s_waitcnt lgkmcnt(2)
v_add_f32 v177, v89, v177
v_add_f32 v21, v61, v21
v_mfma_f32_16x16x32_bf16 v[208:211], a[144:147], a[80:83], v[208:211]
v_mul_f32 v177, s42, v177
v_mul_f32 v21, s44, v21
v_mfma_f32_16x16x32_bf16 v[216:219], a[128:131], a[80:83], v[216:219]
s_waitcnt lgkmcnt(1)
buffer_load_dwordx4 a[244:247], v9, s[16:19], s69 offen offset:1024 sc1
v_mfma_f32_16x16x32_bf16 v[216:219], a[144:147], a[84:87], v[216:219]
v_exp_f32 v37, -|v177|
v_mfma_f32_16x16x32_bf16 v[224:227], a[128:131], a[84:87], v[224:227]
s_waitcnt lgkmcnt(0)
v_exp_f32 v29, v21
v_mfma_f32_16x16x32_bf16 v[224:227], a[144:147], a[88:91], v[224:227]
v_mfma_f32_16x16x32_bf16 v[188:191], a[132:135], a[104:107], v[188:191]
v_accvgpr_read_b32 v22, a50
v_accvgpr_read_b32 v62, a10
v_mfma_f32_16x16x32_bf16 v[188:191], a[148:151], a[108:111], v[188:191]
buffer_load_dwordx4 a[232:235], v9, s[16:19], s35 offen offset:2048 sc1
v_mfma_f32_16x16x32_bf16 v[196:199], a[132:135], a[108:111], v[196:199]
v_add_f32 v178, v90, v178
v_add_f32 v22, v62, v22
v_mfma_f32_16x16x32_bf16 v[196:199], a[148:151], a[112:115], v[196:199]
v_mfma_f32_16x16x32_bf16 v[204:207], a[132:135], a[112:115], v[204:207]
v_mul_f32 v178, s42, v178
v_mul_f32 v22, s44, v22
v_mfma_f32_16x16x32_bf16 v[204:207], a[148:151], a[116:119], v[204:207]
v_mfma_f32_16x16x32_bf16 v[212:215], a[132:135], a[116:119], v[212:215]
buffer_load_dwordx4 a[248:251], v9, s[16:19], s69 offen offset:2048 sc1
v_mfma_f32_16x16x32_bf16 v[212:215], a[148:151], a[80:83], v[212:215]
v_exp_f32 v38, -|v178|
v_mfma_f32_16x16x32_bf16 v[220:223], a[132:135], a[80:83], v[220:223]
v_exp_f32 v30, v22
v_mfma_f32_16x16x32_bf16 v[220:223], a[148:151], a[84:87], v[220:223]
v_accvgpr_read_b32 v23, a51
v_accvgpr_read_b32 v63, a11
v_mfma_f32_16x16x32_bf16 v[228:231], a[132:135], a[84:87], v[228:231]
v_mfma_f32_16x16x32_bf16 v[228:231], a[148:151], a[88:91], v[228:231]
buffer_load_dwordx4 a[236:239], v9, s[16:19], s35 offen offset:3072 sc1
v_mfma_f32_16x16x32_bf16 a[56:59], a[136:139], a[104:107], a[56:59]
v_add_f32 v179, v91, v179
v_add_f32 v23, v63, v23
v_mfma_f32_16x16x32_bf16 a[56:59], a[152:155], a[108:111], a[56:59]
v_mul_f32 v179, s42, v179
v_mul_f32 v23, s44, v23
v_mfma_f32_16x16x32_bf16 a[64:67], a[136:139], a[108:111], a[64:67]
v_mfma_f32_16x16x32_bf16 a[64:67], a[152:155], a[112:115], a[64:67]
v_exp_f32 v39, -|v179|
v_mfma_f32_16x16x32_bf16 a[72:75], a[136:139], a[112:115], a[72:75]
buffer_load_dwordx4 a[252:255], v9, s[16:19], s69 offen offset:3072 sc1
v_mfma_f32_16x16x32_bf16 a[72:75], a[152:155], a[116:119], a[72:75]
v_exp_f32 v31, v23
v_mfma_f32_16x16x32_bf16 v[232:235], a[136:139], a[116:119], v[232:235]
v_accvgpr_read_b32 v24, a52
v_accvgpr_read_b32 v64, a12
v_mfma_f32_16x16x32_bf16 v[232:235], a[152:155], a[80:83], v[232:235]
ds_read_b128 a[92:95], v4 offset:18432
v_mfma_f32_16x16x32_bf16 v[240:243], a[136:139], a[80:83], v[240:243]
ds_read_b128 a[96:99], v4 offset:19456
v_add_f32 v180, v92, v180
v_mfma_f32_16x16x32_bf16 v[240:243], a[152:155], a[84:87], v[240:243]
s_mov_b32 s35, 147456
s_mov_b32 s69, 151552
v_add_f32 v24, v64, v24
v_mfma_f32_16x16x32_bf16 v[248:251], a[136:139], a[84:87], v[248:251]
ds_read_b128 a[100:103], v6 offset:16384
v_mul_f32 v180, s42, v180
v_mfma_f32_16x16x32_bf16 v[248:251], a[152:155], a[88:91], v[248:251]
buffer_load_dwordx4 a[128:131], v9, s[16:19], s35 offen offset:0 sc1
v_mfma_f32_16x16x32_bf16 a[60:63], a[140:143], a[104:107], a[60:63]
ds_read_b128 a[104:107], v6 offset:17408
v_mul_f32 v24, s44, v24
v_mfma_f32_16x16x32_bf16 a[60:63], a[156:159], a[108:111], a[60:63]
v_exp_f32 v40, -|v180|
v_mfma_f32_16x16x32_bf16 a[68:71], a[140:143], a[108:111], a[68:71]
ds_read_b128 a[108:111], v6 offset:18432
v_mfma_f32_16x16x32_bf16 a[68:71], a[156:159], a[112:115], a[68:71]
buffer_load_dwordx4 a[144:147], v9, s[16:19], s69 offen offset:0 sc1
v_mfma_f32_16x16x32_bf16 a[76:79], a[140:143], a[112:115], a[76:79]
ds_read_b128 a[112:115], v6 offset:19456
v_mfma_f32_16x16x32_bf16 a[76:79], a[156:159], a[116:119], a[76:79]
v_exp_f32 v32, v24
v_mfma_f32_16x16x32_bf16 v[236:239], a[140:143], a[116:119], v[236:239]
ds_read_b128 a[116:119], v8 offset:16384
v_accvgpr_read_b32 v25, a53
v_mfma_f32_16x16x32_bf16 v[236:239], a[156:159], a[80:83], v[236:239]
buffer_load_dwordx4 a[132:135], v9, s[16:19], s35 offen offset:1024 sc1
v_mfma_f32_16x16x32_bf16 v[244:247], a[140:143], a[80:83], v[244:247]
v_accvgpr_read_b32 v65, a13
v_add_f32 v181, v93, v181
v_mfma_f32_16x16x32_bf16 v[244:247], a[156:159], a[84:87], v[244:247]
v_add_f32 v25, v65, v25
v_mul_f32 v181, s42, v181
v_mfma_f32_16x16x32_bf16 v[252:255], a[140:143], a[84:87], v[252:255]
v_mul_f32 v25, s44, v25
v_add_u32 v3, 0x10000, v3
v_mfma_f32_16x16x32_bf16 v[252:255], a[156:159], a[88:91], v[252:255]
s_waitcnt lgkmcnt(6)
v_exp_f32 v41, -|v181|
v_mfma_f32_16x16x32_bf16 v[96:99], a[160:163], a[92:95], v[96:99]
s_waitcnt lgkmcnt(5)
buffer_load_dwordx4 a[148:151], v9, s[16:19], s69 offen offset:1024 sc1
v_mfma_f32_16x16x32_bf16 v[96:99], a[176:179], a[96:99], v[96:99]
v_exp_f32 v33, v25
v_mfma_f32_16x16x32_bf16 v[104:107], a[160:163], a[96:99], v[104:107]
s_waitcnt lgkmcnt(4)
v_accvgpr_read_b32 v26, a54
v_accvgpr_read_b32 v66, a14
v_mfma_f32_16x16x32_bf16 v[104:107], a[176:179], a[100:103], v[104:107]
v_add_f32 v182, v94, v182
v_add_f32 v26, v66, v26
v_mfma_f32_16x16x32_bf16 v[112:115], a[160:163], a[100:103], v[112:115]
s_waitcnt lgkmcnt(3)
v_mul_f32 v182, s42, v182
v_mul_f32 v26, s44, v26
v_mfma_f32_16x16x32_bf16 v[112:115], a[176:179], a[104:107], v[112:115]
buffer_load_dwordx4 a[136:139], v9, s[16:19], s35 offen offset:2048 sc1
v_mfma_f32_16x16x32_bf16 v[120:123], a[160:163], a[104:107], v[120:123]
s_waitcnt lgkmcnt(2)
v_exp_f32 v42, -|v182|
v_mfma_f32_16x16x32_bf16 v[120:123], a[176:179], a[108:111], v[120:123]
v_add_u32 v4, 0x10000, v4
v_add_u32 v5, 0x10000, v5
v_mfma_f32_16x16x32_bf16 v[128:131], a[160:163], a[108:111], v[128:131]
s_waitcnt lgkmcnt(1)
v_exp_f32 v34, v26
v_mfma_f32_16x16x32_bf16 v[128:131], a[176:179], a[112:115], v[128:131]
v_accvgpr_read_b32 v27, a55
v_accvgpr_read_b32 v67, a15
v_mfma_f32_16x16x32_bf16 v[136:139], a[160:163], a[112:115], v[136:139]
s_waitcnt lgkmcnt(0)
buffer_load_dwordx4 a[152:155], v9, s[16:19], s69 offen offset:2048 sc1
v_mfma_f32_16x16x32_bf16 v[136:139], a[176:179], a[116:119], v[136:139]
v_add_f32 v183, v95, v183
v_add_f32 v27, v67, v27
v_mfma_f32_16x16x32_bf16 v[100:103], a[164:167], a[92:95], v[100:103]
v_mfma_f32_16x16x32_bf16 v[100:103], a[180:183], a[96:99], v[100:103]
v_mul_f32 v183, s42, v183
v_mul_f32 v27, s44, v27
v_mfma_f32_16x16x32_bf16 v[108:111], a[164:167], a[96:99], v[108:111]
v_mfma_f32_16x16x32_bf16 v[108:111], a[180:183], a[100:103], v[108:111]
buffer_load_dwordx4 a[140:143], v9, s[16:19], s35 offen offset:3072 sc1
v_mfma_f32_16x16x32_bf16 v[116:119], a[164:167], a[100:103], v[116:119]
v_exp_f32 v43, -|v183|
v_mfma_f32_16x16x32_bf16 v[116:119], a[180:183], a[104:107], v[116:119]
v_exp_f32 v35, v27
v_mfma_f32_16x16x32_bf16 v[124:127], a[164:167], a[104:107], v[124:127]
v_add_f32 v76, 1.0, v44
v_fma_f32 v52, v76, v52, v76
v_mfma_f32_16x16x32_bf16 v[124:127], a[180:183], a[108:111], v[124:127]
v_add_u32 v6, 0x10000, v6
v_mfma_f32_16x16x32_bf16 v[132:135], a[164:167], a[108:111], v[132:135]
buffer_load_dwordx4 a[156:159], v9, s[16:19], s69 offen offset:3072 sc1
v_mfma_f32_16x16x32_bf16 v[132:135], a[180:183], a[112:115], v[132:135]
v_add_f32 v76, 1.0, v45
v_fma_f32 v53, v76, v53, v76
v_mfma_f32_16x16x32_bf16 v[140:143], a[164:167], a[112:115], v[140:143]
v_add_f32 v76, 1.0, v46
v_fma_f32 v54, v76, v54, v76
v_mfma_f32_16x16x32_bf16 v[140:143], a[180:183], a[116:119], v[140:143]
v_mfma_f32_16x16x32_bf16 a[16:19], a[168:171], a[92:95], a[16:19]
v_add_f32 v76, 1.0, v47
v_fma_f32 v55, v76, v55, v76
v_mfma_f32_16x16x32_bf16 a[16:19], a[184:187], a[96:99], a[16:19]
s_mov_b32 s35, 155648
s_mov_b32 s69, 159744
v_mfma_f32_16x16x32_bf16 a[24:27], a[168:171], a[96:99], a[24:27]
buffer_load_dwordx4 a[160:163], v9, s[16:19], s35 offen offset:0 sc1
v_mfma_f32_16x16x32_bf16 a[24:27], a[184:187], a[100:103], a[24:27]
v_add_f32 v76, 1.0, v48
v_fma_f32 v56, v76, v56, v76
v_mfma_f32_16x16x32_bf16 a[32:35], a[168:171], a[100:103], a[32:35]
ds_read_b128 a[80:83], v3 offset:0
v_add_f32 v76, 1.0, v49
v_mfma_f32_16x16x32_bf16 a[32:35], a[184:187], a[104:107], a[32:35]
ds_read_b128 a[84:87], v4 offset:0
v_fma_f32 v57, v76, v57, v76
v_mfma_f32_16x16x32_bf16 v[144:147], a[168:171], a[104:107], v[144:147]
ds_read_b128 a[88:91], v3 offset:16384
v_add_f32 v76, 1.0, v50
v_mfma_f32_16x16x32_bf16 v[144:147], a[184:187], a[108:111], v[144:147]
buffer_load_dwordx4 a[176:179], v9, s[16:19], s69 offen offset:0 sc1
v_mfma_f32_16x16x32_bf16 v[152:155], a[168:171], a[108:111], v[152:155]
v_fma_f32 v58, v76, v58, v76
v_add_f32 v76, 1.0, v51
v_mfma_f32_16x16x32_bf16 v[152:155], a[184:187], a[112:115], v[152:155]
v_fma_f32 v59, v76, v59, v76
v_add_f32 v76, 1.0, v36
v_mfma_f32_16x16x32_bf16 v[160:163], a[168:171], a[112:115], v[160:163]
v_fma_f32 v28, v76, v28, v76
v_add_f32 v76, 1.0, v37
v_mfma_f32_16x16x32_bf16 v[160:163], a[184:187], a[116:119], v[160:163]
buffer_load_dwordx4 a[164:167], v9, s[16:19], s35 offen offset:1024 sc1
v_mfma_f32_16x16x32_bf16 a[20:23], a[172:175], a[92:95], a[20:23]
ds_read_b128 a[92:95], v4 offset:16384
v_fma_f32 v29, v76, v29, v76
v_mfma_f32_16x16x32_bf16 a[20:23], a[188:191], a[96:99], a[20:23]
v_add_f32 v76, 1.0, v38
v_fma_f32 v30, v76, v30, v76
v_mfma_f32_16x16x32_bf16 a[28:31], a[172:175], a[96:99], a[28:31]
ds_read_b128 a[96:99], v3 offset:32768
v_add_f32 v76, 1.0, v39
v_mfma_f32_16x16x32_bf16 a[28:31], a[188:191], a[100:103], a[28:31]
v_fma_f32 v31, v76, v31, v76
v_add_f32 v76, 1.0, v40
v_mfma_f32_16x16x32_bf16 a[36:39], a[172:175], a[100:103], a[36:39]
ds_read_b128 a[100:103], v4 offset:32768
v_mfma_f32_16x16x32_bf16 a[36:39], a[188:191], a[104:107], a[36:39]
v_fma_f32 v32, v76, v32, v76
v_add_f32 v76, 1.0, v41
v_mfma_f32_16x16x32_bf16 v[148:151], a[172:175], a[104:107], v[148:151]
ds_read_b128 a[104:107], v3 offset:49152
v_mfma_f32_16x16x32_bf16 v[148:151], a[188:191], a[108:111], v[148:151]
buffer_load_dwordx4 a[180:183], v9, s[16:19], s69 offen offset:1024 sc1
v_mfma_f32_16x16x32_bf16 v[156:159], a[172:175], a[108:111], v[156:159]
ds_read_b128 a[108:111], v4 offset:49152
v_fma_f32 v33, v76, v33, v76
v_mfma_f32_16x16x32_bf16 v[156:159], a[188:191], a[112:115], v[156:159]
v_add_f32 v76, 1.0, v42
v_fma_f32 v34, v76, v34, v76
v_mfma_f32_16x16x32_bf16 v[164:167], a[172:175], a[112:115], v[164:167]
v_add_f32 v76, 1.0, v43
v_fma_f32 v35, v76, v35, v76
v_mfma_f32_16x16x32_bf16 v[164:167], a[188:191], a[116:119], v[164:167]
L_tail:
buffer_load_dwordx4 a[168:171], v9, s[16:19], s35 offen offset:2048 sc1
buffer_load_dwordx4 a[184:187], v9, s[16:19], s69 offen offset:2048 sc1
buffer_load_dwordx4 a[172:175], v9, s[16:19], s35 offen offset:3072 sc1
buffer_load_dwordx4 a[188:191], v9, s[16:19], s69 offen offset:3072 sc1
s_waitcnt vmcnt(32) lgkmcnt(7)
v_mfma_f32_16x16x32_bf16 v[80:83], a[192:195], a[80:83], v[80:83]
s_waitcnt vmcnt(31) lgkmcnt(6)
v_rcp_f32 v52, v52
v_mfma_f32_16x16x32_bf16 v[80:83], a[208:211], a[84:87], v[80:83]
s_waitcnt vmcnt(23) lgkmcnt(5)
v_rcp_f32 v53, v53
v_mfma_f32_16x16x32_bf16 v[80:83], a[224:227], a[88:91], v[80:83]
s_waitcnt vmcnt(22) lgkmcnt(4)
v_rcp_f32 v54, v54
v_mfma_f32_16x16x32_bf16 v[80:83], a[240:243], a[92:95], v[80:83]
s_waitcnt vmcnt(15) lgkmcnt(3)
v_rcp_f32 v55, v55
v_mfma_f32_16x16x32_bf16 v[80:83], a[128:131], a[96:99], v[80:83]
s_waitcnt vmcnt(14) lgkmcnt(2)
v_rcp_f32 v56, v56
v_mfma_f32_16x16x32_bf16 v[80:83], a[144:147], a[100:103], v[80:83]
s_waitcnt vmcnt(7) lgkmcnt(1)
v_rcp_f32 v57, v57
v_mfma_f32_16x16x32_bf16 v[80:83], a[160:163], a[104:107], v[80:83]
s_waitcnt vmcnt(6) lgkmcnt(0)
v_rcp_f32 v58, v58
v_mfma_f32_16x16x32_bf16 v[80:83], a[176:179], a[108:111], v[80:83]
s_waitcnt vmcnt(4)
v_rcp_f32 v59, v59
v_mfma_f32_16x16x32_bf16 v[84:87], a[180:183], a[108:111], v[84:87]
v_rcp_f32 v28, v28
v_mfma_f32_16x16x32_bf16 v[84:87], a[164:167], a[104:107], v[84:87]
v_rcp_f32 v29, v29
v_mfma_f32_16x16x32_bf16 v[84:87], a[148:151], a[100:103], v[84:87]
v_rcp_f32 v30, v30
v_mfma_f32_16x16x32_bf16 v[84:87], a[132:135], a[96:99], v[84:87]
v_rcp_f32 v31, v31
v_mfma_f32_16x16x32_bf16 v[84:87], a[244:247], a[92:95], v[84:87]
v_rcp_f32 v32, v32
v_mfma_f32_16x16x32_bf16 v[84:87], a[228:231], a[88:91], v[84:87]
v_rcp_f32 v33, v33
v_mfma_f32_16x16x32_bf16 v[84:87], a[212:215], a[84:87], v[84:87]
v_rcp_f32 v34, v34
v_mfma_f32_16x16x32_bf16 v[84:87], a[196:199], a[80:83], v[84:87]
v_rcp_f32 v35, v35
v_mfma_f32_16x16x32_bf16 v[68:71], a[200:203], a[80:83], v[68:71]
v_fma_f32 v44, -v44, v52, v52
v_fma_f32 v45, -v45, v53, v53
v_mfma_f32_16x16x32_bf16 v[68:71], a[216:219], a[84:87], v[68:71]
v_fma_f32 v46, -v46, v54, v54
v_fma_f32 v47, -v47, v55, v55
v_mfma_f32_16x16x32_bf16 v[68:71], a[232:235], a[88:91], v[68:71]
v_fma_f32 v48, -v48, v56, v56
v_fma_f32 v49, -v49, v57, v57
v_mfma_f32_16x16x32_bf16 v[68:71], a[248:251], a[92:95], v[68:71]
v_fma_f32 v50, -v50, v58, v58
v_fma_f32 v51, -v51, v59, v59
v_mfma_f32_16x16x32_bf16 v[68:71], a[136:139], a[96:99], v[68:71]
v_bfi_b32 v44, s50, v44, v168
v_bfi_b32 v45, s50, v45, v169
v_mfma_f32_16x16x32_bf16 v[68:71], a[152:155], a[100:103], v[68:71]
s_waitcnt vmcnt(3)
v_bfi_b32 v46, s50, v46, v170
v_bfi_b32 v47, s50, v47, v171
v_mfma_f32_16x16x32_bf16 v[68:71], a[168:171], a[104:107], v[68:71]
s_waitcnt vmcnt(2)
v_bfi_b32 v48, s50, v48, v172
v_bfi_b32 v49, s50, v49, v173
v_mfma_f32_16x16x32_bf16 v[68:71], a[184:187], a[108:111], v[68:71]
s_waitcnt vmcnt(0)
v_bfi_b32 v50, s50, v50, v174
v_bfi_b32 v51, s50, v51, v175
v_mfma_f32_16x16x32_bf16 v[72:75], a[188:191], a[108:111], v[72:75]
v_cvt_pk_bf16_f32 v8, v44, v45
v_cvt_pk_bf16_f32 v9, v46, v47
v_mfma_f32_16x16x32_bf16 v[72:75], a[172:175], a[104:107], v[72:75]
v_cvt_pk_bf16_f32 v10, v48, v49
v_cvt_pk_bf16_f32 v11, v50, v51
v_mfma_f32_16x16x32_bf16 v[72:75], a[156:159], a[100:103], v[72:75]
v_fma_f32 v36, -v36, v28, v28
v_fma_f32 v37, -v37, v29, v29
v_mfma_f32_16x16x32_bf16 v[72:75], a[140:143], a[96:99], v[72:75]
v_fma_f32 v38, -v38, v30, v30
v_fma_f32 v39, -v39, v31, v31
v_mfma_f32_16x16x32_bf16 v[72:75], a[252:255], a[92:95], v[72:75]
v_fma_f32 v40, -v40, v32, v32
v_fma_f32 v41, -v41, v33, v33
v_mfma_f32_16x16x32_bf16 v[72:75], a[236:239], a[88:91], v[72:75]
v_fma_f32 v42, -v42, v34, v34
v_fma_f32 v43, -v43, v35, v35
v_mfma_f32_16x16x32_bf16 v[72:75], a[220:223], a[84:87], v[72:75]
v_mfma_f32_16x16x32_bf16 v[72:75], a[204:207], a[80:83], v[72:75]
ds_read_b128 a[80:83], v3 offset:1024
ds_read_b128 a[84:87], v4 offset:1024
ds_read_b128 a[88:91], v3 offset:17408
ds_read_b128 a[92:95], v4 offset:17408
ds_read_b128 a[96:99], v3 offset:33792
ds_read_b128 a[100:103], v4 offset:33792
ds_read_b128 a[104:107], v3 offset:50176
ds_read_b128 a[108:111], v4 offset:50176
buffer_store_dwordx4 v[8:11], v1, s[20:23], 0 offen offset:1024 sc1
v_bfi_b32 v36, s50, v36, v176
v_bfi_b32 v37, s50, v37, v177
v_bfi_b32 v38, s50, v38, v178
v_bfi_b32 v39, s50, v39, v179
v_bfi_b32 v40, s50, v40, v180
v_bfi_b32 v41, s50, v41, v181
v_bfi_b32 v42, s50, v42, v182
v_bfi_b32 v43, s50, v43, v183
v_cvt_pk_bf16_f32 v8, v36, v37
v_cvt_pk_bf16_f32 v9, v38, v39
v_cvt_pk_bf16_f32 v10, v40, v41
v_cvt_pk_bf16_f32 v11, v42, v43
buffer_store_dwordx4 v[8:11], v1, s[20:23], 0 offen offset:3072 sc1
v_pk_fma_f32 v[80:81], v[80:81], s[46:47], v[168:169] neg_lo:[0,0,1] neg_hi:[0,0,1]
v_pk_fma_f32 v[82:83], v[82:83], s[46:47], v[170:171] neg_lo:[0,0,1] neg_hi:[0,0,1]
v_pk_fma_f32 v[84:85], v[84:85], s[46:47], v[172:173] neg_lo:[0,0,1] neg_hi:[0,0,1]
v_pk_fma_f32 v[86:87], v[86:87], s[46:47], v[174:175] neg_lo:[0,0,1] neg_hi:[0,0,1]
v_pk_fma_f32 v[68:69], v[68:69], s[48:49], v[12:13] neg_lo:[0,0,1] neg_hi:[0,0,1]
v_pk_fma_f32 v[70:71], v[70:71], s[48:49], v[14:15] neg_lo:[0,0,1] neg_hi:[0,0,1]
v_pk_fma_f32 v[72:73], v[72:73], s[48:49], v[16:17] neg_lo:[0,0,1] neg_hi:[0,0,1]
v_pk_fma_f32 v[74:75], v[74:75], s[48:49], v[18:19] neg_lo:[0,0,1] neg_hi:[0,0,1]
v_accvgpr_read_b32 v12, a56
v_accvgpr_read_b32 v13, a57
v_accvgpr_read_b32 v14, a58
v_accvgpr_read_b32 v15, a59
v_accvgpr_read_b32 v16, a60
v_accvgpr_read_b32 v17, a61
v_accvgpr_read_b32 v18, a62
v_accvgpr_read_b32 v19, a63
v_accvgpr_read_b32 v168, a16
v_accvgpr_read_b32 v169, a17
v_accvgpr_read_b32 v170, a18
v_accvgpr_read_b32 v171, a19
v_accvgpr_read_b32 v172, a20
v_accvgpr_read_b32 v173, a21
v_accvgpr_read_b32 v174, a22
v_accvgpr_read_b32 v175, a23
v_pk_add_f32 v[184:185], v[96:97], v[184:185]
v_pk_add_f32 v[186:187], v[98:99], v[186:187]
v_pk_add_f32 v[188:189], v[100:101], v[188:189]
v_pk_add_f32 v[190:191], v[102:103], v[190:191]
v_pk_add_f32 v[12:13], v[168:169], v[12:13]
v_pk_add_f32 v[14:15], v[170:171], v[14:15]
v_pk_add_f32 v[16:17], v[172:173], v[16:17]
v_pk_add_f32 v[18:19], v[174:175], v[18:19]
v_pk_mul_f32 v[184:185], v[184:185], s[42:43]
v_pk_mul_f32 v[186:187], v[186:187], s[42:43]
v_pk_mul_f32 v[188:189], v[188:189], s[42:43]
v_pk_mul_f32 v[190:191], v[190:191], s[42:43]
v_pk_mul_f32 v[12:13], v[12:13], s[44:45]
v_pk_mul_f32 v[14:15], v[14:15], s[44:45]
v_pk_mul_f32 v[16:17], v[16:17], s[44:45]
v_pk_mul_f32 v[18:19], v[18:19], s[44:45]
s_waitcnt lgkmcnt(7)
v_mfma_f32_16x16x32_bf16 v[88:91], a[192:195], a[80:83], v[88:91]
s_waitcnt lgkmcnt(6)
v_exp_f32 v44, -|v80|
v_mfma_f32_16x16x32_bf16 v[88:91], a[208:211], a[84:87], v[88:91]
s_waitcnt lgkmcnt(5)
v_exp_f32 v45, -|v81|
v_mfma_f32_16x16x32_bf16 v[88:91], a[224:227], a[88:91], v[88:91]
s_waitcnt lgkmcnt(4)
v_exp_f32 v46, -|v82|
v_mfma_f32_16x16x32_bf16 v[88:91], a[240:243], a[92:95], v[88:91]
s_waitcnt lgkmcnt(3)
v_exp_f32 v47, -|v83|
v_mfma_f32_16x16x32_bf16 v[88:91], a[128:131], a[96:99], v[88:91]
s_waitcnt lgkmcnt(2)
v_exp_f32 v48, -|v84|
v_mfma_f32_16x16x32_bf16 v[88:91], a[144:147], a[100:103], v[88:91]
s_waitcnt lgkmcnt(1)
v_exp_f32 v49, -|v85|
v_mfma_f32_16x16x32_bf16 v[88:91], a[160:163], a[104:107], v[88:91]
s_waitcnt lgkmcnt(0)
v_exp_f32 v50, -|v86|
v_mfma_f32_16x16x32_bf16 v[88:91], a[176:179], a[108:111], v[88:91]
v_exp_f32 v51, -|v87|
v_mfma_f32_16x16x32_bf16 v[92:95], a[180:183], a[108:111], v[92:95]
v_exp_f32 v68, v68
v_mfma_f32_16x16x32_bf16 v[92:95], a[164:167], a[104:107], v[92:95]
v_exp_f32 v69, v69
v_mfma_f32_16x16x32_bf16 v[92:95], a[148:151], a[100:103], v[92:95]
v_exp_f32 v70, v70
v_mfma_f32_16x16x32_bf16 v[92:95], a[132:135], a[96:99], v[92:95]
v_exp_f32 v71, v71
v_mfma_f32_16x16x32_bf16 v[92:95], a[244:247], a[92:95], v[92:95]
v_exp_f32 v72, v72
v_mfma_f32_16x16x32_bf16 v[92:95], a[228:231], a[88:91], v[92:95]
v_exp_f32 v73, v73
v_mfma_f32_16x16x32_bf16 v[92:95], a[212:215], a[84:87], v[92:95]
v_exp_f32 v74, v74
v_mfma_f32_16x16x32_bf16 v[92:95], a[196:199], a[80:83], v[92:95]
v_exp_f32 v75, v75
v_mfma_f32_16x16x32_bf16 v[60:63], a[200:203], a[80:83], v[60:63]
v_exp_f32 v36, -|v184|
v_mfma_f32_16x16x32_bf16 v[60:63], a[216:219], a[84:87], v[60:63]
v_exp_f32 v37, -|v185|
v_mfma_f32_16x16x32_bf16 v[60:63], a[232:235], a[88:91], v[60:63]
v_exp_f32 v38, -|v186|
v_mfma_f32_16x16x32_bf16 v[60:63], a[248:251], a[92:95], v[60:63]
v_exp_f32 v39, -|v187|
v_mfma_f32_16x16x32_bf16 v[60:63], a[136:139], a[96:99], v[60:63]
v_exp_f32 v40, -|v188|
v_mfma_f32_16x16x32_bf16 v[60:63], a[152:155], a[100:103], v[60:63]
v_exp_f32 v41, -|v189|
v_mfma_f32_16x16x32_bf16 v[60:63], a[168:171], a[104:107], v[60:63]
v_exp_f32 v42, -|v190|
v_mfma_f32_16x16x32_bf16 v[60:63], a[184:187], a[108:111], v[60:63]
v_exp_f32 v43, -|v191|
v_mfma_f32_16x16x32_bf16 v[64:67], a[188:191], a[108:111], v[64:67]
v_exp_f32 v28, v12
v_mfma_f32_16x16x32_bf16 v[64:67], a[172:175], a[104:107], v[64:67]
v_exp_f32 v29, v13
v_mfma_f32_16x16x32_bf16 v[64:67], a[156:159], a[100:103], v[64:67]
v_exp_f32 v30, v14
v_mfma_f32_16x16x32_bf16 v[64:67], a[140:143], a[96:99], v[64:67]
v_exp_f32 v31, v15
v_mfma_f32_16x16x32_bf16 v[64:67], a[252:255], a[92:95], v[64:67]
v_exp_f32 v32, v16
v_mfma_f32_16x16x32_bf16 v[64:67], a[236:239], a[88:91], v[64:67]
v_exp_f32 v33, v17
v_mfma_f32_16x16x32_bf16 v[64:67], a[220:223], a[84:87], v[64:67]
v_exp_f32 v34, v18
v_mfma_f32_16x16x32_bf16 v[64:67], a[204:207], a[80:83], v[64:67]
v_exp_f32 v35, v19
ds_read_b128 a[80:83], v3 offset:2048
ds_read_b128 a[84:87], v4 offset:2048
ds_read_b128 a[88:91], v3 offset:18432
ds_read_b128 a[92:95], v4 offset:18432
ds_read_b128 a[96:99], v3 offset:34816
ds_read_b128 a[100:103], v4 offset:34816
ds_read_b128 a[104:107], v3 offset:51200
ds_read_b128 a[108:111], v4 offset:51200
v_pk_add_f32 v[52:53], v[36:37], 1.0 op_sel_hi:[1,0]
v_pk_add_f32 v[54:55], v[38:39], 1.0 op_sel_hi:[1,0]
v_pk_add_f32 v[56:57], v[40:41], 1.0 op_sel_hi:[1,0]
v_pk_add_f32 v[58:59], v[42:43], 1.0 op_sel_hi:[1,0]
v_pk_fma_f32 v[28:29], v[52:53], v[28:29], v[52:53]
v_pk_fma_f32 v[30:31], v[54:55], v[30:31], v[54:55]
v_pk_fma_f32 v[32:33], v[56:57], v[32:33], v[56:57]
v_pk_fma_f32 v[34:35], v[58:59], v[34:35], v[58:59]
v_rcp_f32 v28, v28
v_rcp_f32 v29, v29
v_rcp_f32 v30, v30
v_rcp_f32 v31, v31
v_rcp_f32 v32, v32
v_rcp_f32 v33, v33
v_rcp_f32 v34, v34
v_rcp_f32 v35, v35
v_pk_fma_f32 v[36:37], v[36:37], v[28:29], v[28:29] neg_lo:[1,0,0] neg_hi:[1,0,0]
v_pk_fma_f32 v[38:39], v[38:39], v[30:31], v[30:31] neg_lo:[1,0,0] neg_hi:[1,0,0]
v_pk_fma_f32 v[40:41], v[40:41], v[32:33], v[32:33] neg_lo:[1,0,0] neg_hi:[1,0,0]
v_pk_fma_f32 v[42:43], v[42:43], v[34:35], v[34:35] neg_lo:[1,0,0] neg_hi:[1,0,0]
v_bfi_b32 v36, s50, v36, v184
v_bfi_b32 v37, s50, v37, v185
v_bfi_b32 v38, s50, v38, v186
v_bfi_b32 v39, s50, v39, v187
v_bfi_b32 v40, s50, v40, v188
v_bfi_b32 v41, s50, v41, v189
v_bfi_b32 v42, s50, v42, v190
v_bfi_b32 v43, s50, v43, v191
v_cvt_pk_bf16_f32 v8, v36, v37
v_cvt_pk_bf16_f32 v9, v38, v39
v_cvt_pk_bf16_f32 v10, v40, v41
v_cvt_pk_bf16_f32 v11, v42, v43
buffer_store_dwordx4 v[8:11], v1, s[20:23], s36 offen offset:1024 sc1
v_pk_add_f32 v[52:53], v[44:45], 1.0 op_sel_hi:[1,0]
v_pk_add_f32 v[54:55], v[46:47], 1.0 op_sel_hi:[1,0]
v_pk_add_f32 v[56:57], v[48:49], 1.0 op_sel_hi:[1,0]
v_pk_add_f32 v[58:59], v[50:51], 1.0 op_sel_hi:[1,0]
v_pk_fma_f32 v[68:69], v[52:53], v[68:69], v[52:53]
v_pk_fma_f32 v[70:71], v[54:55], v[70:71], v[54:55]
v_pk_fma_f32 v[72:73], v[56:57], v[72:73], v[56:57]
v_pk_fma_f32 v[74:75], v[58:59], v[74:75], v[58:59]
v_rcp_f32 v68, v68
v_rcp_f32 v69, v69
v_rcp_f32 v70, v70
v_rcp_f32 v71, v71
v_rcp_f32 v72, v72
v_rcp_f32 v73, v73
v_rcp_f32 v74, v74
v_rcp_f32 v75, v75
v_pk_fma_f32 v[44:45], v[44:45], v[68:69], v[68:69] neg_lo:[1,0,0] neg_hi:[1,0,0]
v_pk_fma_f32 v[46:47], v[46:47], v[70:71], v[70:71] neg_lo:[1,0,0] neg_hi:[1,0,0]
v_pk_fma_f32 v[48:49], v[48:49], v[72:73], v[72:73] neg_lo:[1,0,0] neg_hi:[1,0,0]
v_pk_fma_f32 v[50:51], v[50:51], v[74:75], v[74:75] neg_lo:[1,0,0] neg_hi:[1,0,0]
v_bfi_b32 v44, s50, v44, v80
v_bfi_b32 v45, s50, v45, v81
v_bfi_b32 v46, s50, v46, v82
v_bfi_b32 v47, s50, v47, v83
v_bfi_b32 v48, s50, v48, v84
v_bfi_b32 v49, s50, v49, v85
v_bfi_b32 v50, s50, v50, v86
v_bfi_b32 v51, s50, v51, v87
v_cvt_pk_bf16_f32 v76, v44, v45
v_cvt_pk_bf16_f32 v77, v46, v47
v_cvt_pk_bf16_f32 v78, v48, v49
v_cvt_pk_bf16_f32 v79, v50, v51
buffer_store_dwordx4 v[76:79], v1, s[20:23], 0 offen offset:0 sc1
v_pk_fma_f32 v[88:89], v[88:89], s[46:47], v[176:177] neg_lo:[0,0,1] neg_hi:[0,0,1]
v_pk_fma_f32 v[90:91], v[90:91], s[46:47], v[178:179] neg_lo:[0,0,1] neg_hi:[0,0,1]
v_pk_fma_f32 v[92:93], v[92:93], s[46:47], v[180:181] neg_lo:[0,0,1] neg_hi:[0,0,1]
v_pk_fma_f32 v[94:95], v[94:95], s[46:47], v[182:183] neg_lo:[0,0,1] neg_hi:[0,0,1]
v_pk_fma_f32 v[60:61], v[60:61], s[48:49], v[20:21] neg_lo:[0,0,1] neg_hi:[0,0,1]
v_pk_fma_f32 v[62:63], v[62:63], s[48:49], v[22:23] neg_lo:[0,0,1] neg_hi:[0,0,1]
v_pk_fma_f32 v[64:65], v[64:65], s[48:49], v[24:25] neg_lo:[0,0,1] neg_hi:[0,0,1]
v_pk_fma_f32 v[66:67], v[66:67], s[48:49], v[26:27] neg_lo:[0,0,1] neg_hi:[0,0,1]
v_accvgpr_read_b32 v20, a64
v_accvgpr_read_b32 v21, a65
v_accvgpr_read_b32 v22, a66
v_accvgpr_read_b32 v23, a67
v_accvgpr_read_b32 v24, a68
v_accvgpr_read_b32 v25, a69
v_accvgpr_read_b32 v26, a70
v_accvgpr_read_b32 v27, a71
v_accvgpr_read_b32 v176, a24
v_accvgpr_read_b32 v177, a25
v_accvgpr_read_b32 v178, a26
v_accvgpr_read_b32 v179, a27
v_accvgpr_read_b32 v180, a28
v_accvgpr_read_b32 v181, a29
v_accvgpr_read_b32 v182, a30
v_accvgpr_read_b32 v183, a31
v_pk_add_f32 v[192:193], v[104:105], v[192:193]
v_pk_add_f32 v[194:195], v[106:107], v[194:195]
v_pk_add_f32 v[196:197], v[108:109], v[196:197]
v_pk_add_f32 v[198:199], v[110:111], v[198:199]
v_pk_add_f32 v[20:21], v[176:177], v[20:21]
v_pk_add_f32 v[22:23], v[178:179], v[22:23]
v_pk_add_f32 v[24:25], v[180:181], v[24:25]
v_pk_add_f32 v[26:27], v[182:183], v[26:27]
v_pk_mul_f32 v[192:193], v[192:193], s[42:43]
v_pk_mul_f32 v[194:195], v[194:195], s[42:43]
v_pk_mul_f32 v[196:197], v[196:197], s[42:43]
v_pk_mul_f32 v[198:199], v[198:199], s[42:43]
v_pk_mul_f32 v[20:21], v[20:21], s[44:45]
v_pk_mul_f32 v[22:23], v[22:23], s[44:45]
v_pk_mul_f32 v[24:25], v[24:25], s[44:45]
v_pk_mul_f32 v[26:27], v[26:27], s[44:45]
s_waitcnt lgkmcnt(7)
v_mfma_f32_16x16x32_bf16 v[96:99], a[192:195], a[80:83], v[96:99]
s_waitcnt lgkmcnt(6)
v_exp_f32 v44, -|v88|
v_mfma_f32_16x16x32_bf16 v[96:99], a[208:211], a[84:87], v[96:99]
s_waitcnt lgkmcnt(5)
v_exp_f32 v45, -|v89|
v_mfma_f32_16x16x32_bf16 v[96:99], a[224:227], a[88:91], v[96:99]
s_waitcnt lgkmcnt(4)
v_exp_f32 v46, -|v90|
v_mfma_f32_16x16x32_bf16 v[96:99], a[240:243], a[92:95], v[96:99]
s_waitcnt lgkmcnt(3)
v_exp_f32 v47, -|v91|
v_mfma_f32_16x16x32_bf16 v[96:99], a[128:131], a[96:99], v[96:99]
s_waitcnt lgkmcnt(2)
v_exp_f32 v48, -|v92|
v_mfma_f32_16x16x32_bf16 v[96:99], a[144:147], a[100:103], v[96:99]
s_waitcnt lgkmcnt(1)
v_exp_f32 v49, -|v93|
v_mfma_f32_16x16x32_bf16 v[96:99], a[160:163], a[104:107], v[96:99]
s_waitcnt lgkmcnt(0)
v_exp_f32 v50, -|v94|
v_mfma_f32_16x16x32_bf16 v[96:99], a[176:179], a[108:111], v[96:99]
v_exp_f32 v51, -|v95|
v_mfma_f32_16x16x32_bf16 v[100:103], a[180:183], a[108:111], v[100:103]
v_exp_f32 v60, v60
v_mfma_f32_16x16x32_bf16 v[100:103], a[164:167], a[104:107], v[100:103]
v_exp_f32 v61, v61
v_mfma_f32_16x16x32_bf16 v[100:103], a[148:151], a[100:103], v[100:103]
v_exp_f32 v62, v62
v_mfma_f32_16x16x32_bf16 v[100:103], a[132:135], a[96:99], v[100:103]
v_exp_f32 v63, v63
v_mfma_f32_16x16x32_bf16 v[100:103], a[244:247], a[92:95], v[100:103]
v_exp_f32 v64, v64
v_mfma_f32_16x16x32_bf16 v[100:103], a[228:231], a[88:91], v[100:103]
v_exp_f32 v65, v65
v_mfma_f32_16x16x32_bf16 v[100:103], a[212:215], a[84:87], v[100:103]
v_exp_f32 v66, v66
v_mfma_f32_16x16x32_bf16 v[100:103], a[196:199], a[80:83], v[100:103]
v_exp_f32 v67, v67
v_mfma_f32_16x16x32_bf16 v[168:171], a[200:203], a[80:83], v[168:171]
v_exp_f32 v36, -|v192|
v_mfma_f32_16x16x32_bf16 v[168:171], a[216:219], a[84:87], v[168:171]
v_exp_f32 v37, -|v193|
v_mfma_f32_16x16x32_bf16 v[168:171], a[232:235], a[88:91], v[168:171]
v_exp_f32 v38, -|v194|
v_mfma_f32_16x16x32_bf16 v[168:171], a[248:251], a[92:95], v[168:171]
v_exp_f32 v39, -|v195|
v_mfma_f32_16x16x32_bf16 v[168:171], a[136:139], a[96:99], v[168:171]
v_exp_f32 v40, -|v196|
v_mfma_f32_16x16x32_bf16 v[168:171], a[152:155], a[100:103], v[168:171]
v_exp_f32 v41, -|v197|
v_mfma_f32_16x16x32_bf16 v[168:171], a[168:171], a[104:107], v[168:171]
v_exp_f32 v42, -|v198|
v_mfma_f32_16x16x32_bf16 v[168:171], a[184:187], a[108:111], v[168:171]
v_exp_f32 v43, -|v199|
v_mfma_f32_16x16x32_bf16 v[172:175], a[188:191], a[108:111], v[172:175]
v_exp_f32 v28, v20
v_mfma_f32_16x16x32_bf16 v[172:175], a[172:175], a[104:107], v[172:175]
v_exp_f32 v29, v21
v_mfma_f32_16x16x32_bf16 v[172:175], a[156:159], a[100:103], v[172:175]
v_exp_f32 v30, v22
v_mfma_f32_16x16x32_bf16 v[172:175], a[140:143], a[96:99], v[172:175]
v_exp_f32 v31, v23
v_mfma_f32_16x16x32_bf16 v[172:175], a[252:255], a[92:95], v[172:175]
v_exp_f32 v32, v24
v_mfma_f32_16x16x32_bf16 v[172:175], a[236:239], a[88:91], v[172:175]
v_exp_f32 v33, v25
v_mfma_f32_16x16x32_bf16 v[172:175], a[220:223], a[84:87], v[172:175]
v_exp_f32 v34, v26
v_mfma_f32_16x16x32_bf16 v[172:175], a[204:207], a[80:83], v[172:175]
v_exp_f32 v35, v27
ds_read_b128 a[80:83], v3 offset:3072
ds_read_b128 a[84:87], v4 offset:3072
ds_read_b128 a[88:91], v3 offset:19456
ds_read_b128 a[92:95], v4 offset:19456
ds_read_b128 a[96:99], v3 offset:35840
ds_read_b128 a[100:103], v4 offset:35840
ds_read_b128 a[104:107], v3 offset:52224
ds_read_b128 a[108:111], v4 offset:52224
v_pk_add_f32 v[52:53], v[36:37], 1.0 op_sel_hi:[1,0]
v_pk_add_f32 v[54:55], v[38:39], 1.0 op_sel_hi:[1,0]
v_pk_add_f32 v[56:57], v[40:41], 1.0 op_sel_hi:[1,0]
v_pk_add_f32 v[58:59], v[42:43], 1.0 op_sel_hi:[1,0]
v_pk_fma_f32 v[28:29], v[52:53], v[28:29], v[52:53]
v_pk_fma_f32 v[30:31], v[54:55], v[30:31], v[54:55]
v_pk_fma_f32 v[32:33], v[56:57], v[32:33], v[56:57]
v_pk_fma_f32 v[34:35], v[58:59], v[34:35], v[58:59]
v_rcp_f32 v28, v28
v_rcp_f32 v29, v29
v_rcp_f32 v30, v30
v_rcp_f32 v31, v31
v_rcp_f32 v32, v32
v_rcp_f32 v33, v33
v_rcp_f32 v34, v34
v_rcp_f32 v35, v35
v_pk_fma_f32 v[36:37], v[36:37], v[28:29], v[28:29] neg_lo:[1,0,0] neg_hi:[1,0,0]
v_pk_fma_f32 v[38:39], v[38:39], v[30:31], v[30:31] neg_lo:[1,0,0] neg_hi:[1,0,0]
v_pk_fma_f32 v[40:41], v[40:41], v[32:33], v[32:33] neg_lo:[1,0,0] neg_hi:[1,0,0]
v_pk_fma_f32 v[42:43], v[42:43], v[34:35], v[34:35] neg_lo:[1,0,0] neg_hi:[1,0,0]
v_bfi_b32 v36, s50, v36, v192
v_bfi_b32 v37, s50, v37, v193
v_bfi_b32 v38, s50, v38, v194
v_bfi_b32 v39, s50, v39, v195
v_bfi_b32 v40, s50, v40, v196
v_bfi_b32 v41, s50, v41, v197
v_bfi_b32 v42, s50, v42, v198
v_bfi_b32 v43, s50, v43, v199
v_cvt_pk_bf16_f32 v8, v36, v37
v_cvt_pk_bf16_f32 v9, v38, v39
v_cvt_pk_bf16_f32 v10, v40, v41
v_cvt_pk_bf16_f32 v11, v42, v43
buffer_store_dwordx4 v[8:11], v1, s[20:23], s36 offen offset:3072 sc1
v_pk_add_f32 v[52:53], v[44:45], 1.0 op_sel_hi:[1,0]
v_pk_add_f32 v[54:55], v[46:47], 1.0 op_sel_hi:[1,0]
v_pk_add_f32 v[56:57], v[48:49], 1.0 op_sel_hi:[1,0]
v_pk_add_f32 v[58:59], v[50:51], 1.0 op_sel_hi:[1,0]
v_pk_fma_f32 v[60:61], v[52:53], v[60:61], v[52:53]
v_pk_fma_f32 v[62:63], v[54:55], v[62:63], v[54:55]
v_pk_fma_f32 v[64:65], v[56:57], v[64:65], v[56:57]
v_pk_fma_f32 v[66:67], v[58:59], v[66:67], v[58:59]
v_rcp_f32 v60, v60
v_rcp_f32 v61, v61
v_rcp_f32 v62, v62
v_rcp_f32 v63, v63
v_rcp_f32 v64, v64
v_rcp_f32 v65, v65
v_rcp_f32 v66, v66
v_rcp_f32 v67, v67
v_pk_fma_f32 v[44:45], v[44:45], v[60:61], v[60:61] neg_lo:[1,0,0] neg_hi:[1,0,0]
v_pk_fma_f32 v[46:47], v[46:47], v[62:63], v[62:63] neg_lo:[1,0,0] neg_hi:[1,0,0]
v_pk_fma_f32 v[48:49], v[48:49], v[64:65], v[64:65] neg_lo:[1,0,0] neg_hi:[1,0,0]
v_pk_fma_f32 v[50:51], v[50:51], v[66:67], v[66:67] neg_lo:[1,0,0] neg_hi:[1,0,0]
v_bfi_b32 v44, s50, v44, v88
v_bfi_b32 v45, s50, v45, v89
v_bfi_b32 v46, s50, v46, v90
v_bfi_b32 v47, s50, v47, v91
v_bfi_b32 v48, s50, v48, v92
v_bfi_b32 v49, s50, v49, v93
v_bfi_b32 v50, s50, v50, v94
v_bfi_b32 v51, s50, v51, v95
v_cvt_pk_bf16_f32 v76, v44, v45
v_cvt_pk_bf16_f32 v77, v46, v47
v_cvt_pk_bf16_f32 v78, v48, v49
v_cvt_pk_bf16_f32 v79, v50, v51
buffer_store_dwordx4 v[76:79], v1, s[20:23], 0 offen offset:2048 sc1
v_pk_fma_f32 v[96:97], v[96:97], s[46:47], v[184:185] neg_lo:[0,0,1] neg_hi:[0,0,1]
v_pk_fma_f32 v[98:99], v[98:99], s[46:47], v[186:187] neg_lo:[0,0,1] neg_hi:[0,0,1]
v_pk_fma_f32 v[100:101], v[100:101], s[46:47], v[188:189] neg_lo:[0,0,1] neg_hi:[0,0,1]
v_pk_fma_f32 v[102:103], v[102:103], s[46:47], v[190:191] neg_lo:[0,0,1] neg_hi:[0,0,1]
v_pk_fma_f32 v[168:169], v[168:169], s[48:49], v[12:13] neg_lo:[0,0,1] neg_hi:[0,0,1]
v_pk_fma_f32 v[170:171], v[170:171], s[48:49], v[14:15] neg_lo:[0,0,1] neg_hi:[0,0,1]
v_pk_fma_f32 v[172:173], v[172:173], s[48:49], v[16:17] neg_lo:[0,0,1] neg_hi:[0,0,1]
v_pk_fma_f32 v[174:175], v[174:175], s[48:49], v[18:19] neg_lo:[0,0,1] neg_hi:[0,0,1]
v_accvgpr_read_b32 v12, a72
v_accvgpr_read_b32 v13, a73
v_accvgpr_read_b32 v14, a74
v_accvgpr_read_b32 v15, a75
v_accvgpr_read_b32 v16, a76
v_accvgpr_read_b32 v17, a77
v_accvgpr_read_b32 v18, a78
v_accvgpr_read_b32 v19, a79
v_accvgpr_read_b32 v184, a32
v_accvgpr_read_b32 v185, a33
v_accvgpr_read_b32 v186, a34
v_accvgpr_read_b32 v187, a35
v_accvgpr_read_b32 v188, a36
v_accvgpr_read_b32 v189, a37
v_accvgpr_read_b32 v190, a38
v_accvgpr_read_b32 v191, a39
v_pk_add_f32 v[200:201], v[112:113], v[200:201]
v_pk_add_f32 v[202:203], v[114:115], v[202:203]
v_pk_add_f32 v[204:205], v[116:117], v[204:205]
v_pk_add_f32 v[206:207], v[118:119], v[206:207]
v_pk_add_f32 v[12:13], v[184:185], v[12:13]
v_pk_add_f32 v[14:15], v[186:187], v[14:15]
v_pk_add_f32 v[16:17], v[188:189], v[16:17]
v_pk_add_f32 v[18:19], v[190:191], v[18:19]
v_pk_mul_f32 v[200:201], v[200:201], s[42:43]
v_pk_mul_f32 v[202:203], v[202:203], s[42:43]
v_pk_mul_f32 v[204:205], v[204:205], s[42:43]
v_pk_mul_f32 v[206:207], v[206:207], s[42:43]
v_pk_mul_f32 v[12:13], v[12:13], s[44:45]
v_pk_mul_f32 v[14:15], v[14:15], s[44:45]
v_pk_mul_f32 v[16:17], v[16:17], s[44:45]
v_pk_mul_f32 v[18:19], v[18:19], s[44:45]
s_waitcnt lgkmcnt(7)
v_mfma_f32_16x16x32_bf16 v[104:107], a[192:195], a[80:83], v[104:107]
s_waitcnt lgkmcnt(6)
v_exp_f32 v44, -|v96|
v_mfma_f32_16x16x32_bf16 v[104:107], a[208:211], a[84:87], v[104:107]
s_waitcnt lgkmcnt(5)
v_exp_f32 v45, -|v97|
v_mfma_f32_16x16x32_bf16 v[104:107], a[224:227], a[88:91], v[104:107]
s_waitcnt lgkmcnt(4)
v_exp_f32 v46, -|v98|
v_mfma_f32_16x16x32_bf16 v[104:107], a[240:243], a[92:95], v[104:107]
s_waitcnt lgkmcnt(3)
v_exp_f32 v47, -|v99|
v_mfma_f32_16x16x32_bf16 v[104:107], a[128:131], a[96:99], v[104:107]
s_waitcnt lgkmcnt(2)
v_exp_f32 v48, -|v100|
v_mfma_f32_16x16x32_bf16 v[104:107], a[144:147], a[100:103], v[104:107]
s_waitcnt lgkmcnt(1)
v_exp_f32 v49, -|v101|
v_mfma_f32_16x16x32_bf16 v[104:107], a[160:163], a[104:107], v[104:107]
s_waitcnt lgkmcnt(0)
v_exp_f32 v50, -|v102|
v_mfma_f32_16x16x32_bf16 v[104:107], a[176:179], a[108:111], v[104:107]
v_exp_f32 v51, -|v103|
v_mfma_f32_16x16x32_bf16 v[108:111], a[180:183], a[108:111], v[108:111]
v_exp_f32 v168, v168
v_mfma_f32_16x16x32_bf16 v[108:111], a[164:167], a[104:107], v[108:111]
v_exp_f32 v169, v169
v_mfma_f32_16x16x32_bf16 v[108:111], a[148:151], a[100:103], v[108:111]
v_exp_f32 v170, v170
v_mfma_f32_16x16x32_bf16 v[108:111], a[132:135], a[96:99], v[108:111]
v_exp_f32 v171, v171
v_mfma_f32_16x16x32_bf16 v[108:111], a[244:247], a[92:95], v[108:111]
v_exp_f32 v172, v172
v_mfma_f32_16x16x32_bf16 v[108:111], a[228:231], a[88:91], v[108:111]
v_exp_f32 v173, v173
v_mfma_f32_16x16x32_bf16 v[108:111], a[212:215], a[84:87], v[108:111]
v_exp_f32 v174, v174
v_mfma_f32_16x16x32_bf16 v[108:111], a[196:199], a[80:83], v[108:111]
v_exp_f32 v175, v175
v_mfma_f32_16x16x32_bf16 v[176:179], a[200:203], a[80:83], v[176:179]
v_exp_f32 v36, -|v200|
v_mfma_f32_16x16x32_bf16 v[176:179], a[216:219], a[84:87], v[176:179]
v_exp_f32 v37, -|v201|
v_mfma_f32_16x16x32_bf16 v[176:179], a[232:235], a[88:91], v[176:179]
v_exp_f32 v38, -|v202|
v_mfma_f32_16x16x32_bf16 v[176:179], a[248:251], a[92:95], v[176:179]
v_exp_f32 v39, -|v203|
v_mfma_f32_16x16x32_bf16 v[176:179], a[136:139], a[96:99], v[176:179]
v_exp_f32 v40, -|v204|
v_mfma_f32_16x16x32_bf16 v[176:179], a[152:155], a[100:103], v[176:179]
v_exp_f32 v41, -|v205|
v_mfma_f32_16x16x32_bf16 v[176:179], a[168:171], a[104:107], v[176:179]
v_exp_f32 v42, -|v206|
v_mfma_f32_16x16x32_bf16 v[176:179], a[184:187], a[108:111], v[176:179]
v_exp_f32 v43, -|v207|
v_mfma_f32_16x16x32_bf16 v[180:183], a[188:191], a[108:111], v[180:183]
v_exp_f32 v28, v12
v_mfma_f32_16x16x32_bf16 v[180:183], a[172:175], a[104:107], v[180:183]
v_exp_f32 v29, v13
v_mfma_f32_16x16x32_bf16 v[180:183], a[156:159], a[100:103], v[180:183]
v_exp_f32 v30, v14
v_mfma_f32_16x16x32_bf16 v[180:183], a[140:143], a[96:99], v[180:183]
v_exp_f32 v31, v15
v_mfma_f32_16x16x32_bf16 v[180:183], a[252:255], a[92:95], v[180:183]
v_exp_f32 v32, v16
v_mfma_f32_16x16x32_bf16 v[180:183], a[236:239], a[88:91], v[180:183]
v_exp_f32 v33, v17
v_mfma_f32_16x16x32_bf16 v[180:183], a[220:223], a[84:87], v[180:183]
v_exp_f32 v34, v18
v_mfma_f32_16x16x32_bf16 v[180:183], a[204:207], a[80:83], v[180:183]
v_exp_f32 v35, v19
ds_read_b128 a[80:83], v5 offset:0
ds_read_b128 a[84:87], v6 offset:0
ds_read_b128 a[88:91], v5 offset:16384
ds_read_b128 a[92:95], v6 offset:16384
ds_read_b128 a[96:99], v5 offset:32768
ds_read_b128 a[100:103], v6 offset:32768
ds_read_b128 a[104:107], v5 offset:49152
ds_read_b128 a[108:111], v6 offset:49152
v_pk_add_f32 v[52:53], v[36:37], 1.0 op_sel_hi:[1,0]
v_pk_add_f32 v[54:55], v[38:39], 1.0 op_sel_hi:[1,0]
v_pk_add_f32 v[56:57], v[40:41], 1.0 op_sel_hi:[1,0]
v_pk_add_f32 v[58:59], v[42:43], 1.0 op_sel_hi:[1,0]
v_pk_fma_f32 v[28:29], v[52:53], v[28:29], v[52:53]
v_pk_fma_f32 v[30:31], v[54:55], v[30:31], v[54:55]
v_pk_fma_f32 v[32:33], v[56:57], v[32:33], v[56:57]
v_pk_fma_f32 v[34:35], v[58:59], v[34:35], v[58:59]
v_rcp_f32 v28, v28
v_rcp_f32 v29, v29
v_rcp_f32 v30, v30
v_rcp_f32 v31, v31
v_rcp_f32 v32, v32
v_rcp_f32 v33, v33
v_rcp_f32 v34, v34
v_rcp_f32 v35, v35
v_pk_fma_f32 v[36:37], v[36:37], v[28:29], v[28:29] neg_lo:[1,0,0] neg_hi:[1,0,0]
v_pk_fma_f32 v[38:39], v[38:39], v[30:31], v[30:31] neg_lo:[1,0,0] neg_hi:[1,0,0]
v_pk_fma_f32 v[40:41], v[40:41], v[32:33], v[32:33] neg_lo:[1,0,0] neg_hi:[1,0,0]
v_pk_fma_f32 v[42:43], v[42:43], v[34:35], v[34:35] neg_lo:[1,0,0] neg_hi:[1,0,0]
v_bfi_b32 v36, s50, v36, v200
v_bfi_b32 v37, s50, v37, v201
v_bfi_b32 v38, s50, v38, v202
v_bfi_b32 v39, s50, v39, v203
v_bfi_b32 v40, s50, v40, v204
v_bfi_b32 v41, s50, v41, v205
v_bfi_b32 v42, s50, v42, v206
v_bfi_b32 v43, s50, v43, v207
v_cvt_pk_bf16_f32 v8, v36, v37
v_cvt_pk_bf16_f32 v9, v38, v39
v_cvt_pk_bf16_f32 v10, v40, v41
v_cvt_pk_bf16_f32 v11, v42, v43
buffer_store_dwordx4 v[8:11], v1, s[20:23], s37 offen offset:1024 sc1
v_pk_add_f32 v[52:53], v[44:45], 1.0 op_sel_hi:[1,0]
v_pk_add_f32 v[54:55], v[46:47], 1.0 op_sel_hi:[1,0]
v_pk_add_f32 v[56:57], v[48:49], 1.0 op_sel_hi:[1,0]
v_pk_add_f32 v[58:59], v[50:51], 1.0 op_sel_hi:[1,0]
v_pk_fma_f32 v[168:169], v[52:53], v[168:169], v[52:53]
v_pk_fma_f32 v[170:171], v[54:55], v[170:171], v[54:55]
v_pk_fma_f32 v[172:173], v[56:57], v[172:173], v[56:57]
v_pk_fma_f32 v[174:175], v[58:59], v[174:175], v[58:59]
v_rcp_f32 v168, v168
v_rcp_f32 v169, v169
v_rcp_f32 v170, v170
v_rcp_f32 v171, v171
v_rcp_f32 v172, v172
v_rcp_f32 v173, v173
v_rcp_f32 v174, v174
v_rcp_f32 v175, v175
v_pk_fma_f32 v[44:45], v[44:45], v[168:169], v[168:169] neg_lo:[1,0,0] neg_hi:[1,0,0]
v_pk_fma_f32 v[46:47], v[46:47], v[170:171], v[170:171] neg_lo:[1,0,0] neg_hi:[1,0,0]
v_pk_fma_f32 v[48:49], v[48:49], v[172:173], v[172:173] neg_lo:[1,0,0] neg_hi:[1,0,0]
v_pk_fma_f32 v[50:51], v[50:51], v[174:175], v[174:175] neg_lo:[1,0,0] neg_hi:[1,0,0]
v_bfi_b32 v44, s50, v44, v96
v_bfi_b32 v45, s50, v45, v97
v_bfi_b32 v46, s50, v46, v98
v_bfi_b32 v47, s50, v47, v99
v_bfi_b32 v48, s50, v48, v100
v_bfi_b32 v49, s50, v49, v101
v_bfi_b32 v50, s50, v50, v102
v_bfi_b32 v51, s50, v51, v103
v_cvt_pk_bf16_f32 v76, v44, v45
v_cvt_pk_bf16_f32 v77, v46, v47
v_cvt_pk_bf16_f32 v78, v48, v49
v_cvt_pk_bf16_f32 v79, v50, v51
buffer_store_dwordx4 v[76:79], v1, s[20:23], s36 offen offset:0 sc1
v_pk_fma_f32 v[104:105], v[104:105], s[46:47], v[192:193] neg_lo:[0,0,1] neg_hi:[0,0,1]
v_pk_fma_f32 v[106:107], v[106:107], s[46:47], v[194:195] neg_lo:[0,0,1] neg_hi:[0,0,1]
v_pk_fma_f32 v[108:109], v[108:109], s[46:47], v[196:197] neg_lo:[0,0,1] neg_hi:[0,0,1]
v_pk_fma_f32 v[110:111], v[110:111], s[46:47], v[198:199] neg_lo:[0,0,1] neg_hi:[0,0,1]
v_pk_fma_f32 v[176:177], v[176:177], s[48:49], v[20:21] neg_lo:[0,0,1] neg_hi:[0,0,1]
v_pk_fma_f32 v[178:179], v[178:179], s[48:49], v[22:23] neg_lo:[0,0,1] neg_hi:[0,0,1]
v_pk_fma_f32 v[180:181], v[180:181], s[48:49], v[24:25] neg_lo:[0,0,1] neg_hi:[0,0,1]
v_pk_fma_f32 v[182:183], v[182:183], s[48:49], v[26:27] neg_lo:[0,0,1] neg_hi:[0,0,1]
v_pk_add_f32 v[208:209], v[120:121], v[208:209]
v_pk_add_f32 v[210:211], v[122:123], v[210:211]
v_pk_add_f32 v[212:213], v[124:125], v[212:213]
v_pk_add_f32 v[214:215], v[126:127], v[214:215]
v_pk_add_f32 v[232:233], v[144:145], v[232:233]
v_pk_add_f32 v[234:235], v[146:147], v[234:235]
v_pk_add_f32 v[236:237], v[148:149], v[236:237]
v_pk_add_f32 v[238:239], v[150:151], v[238:239]
v_pk_mul_f32 v[208:209], v[208:209], s[42:43]
v_pk_mul_f32 v[210:211], v[210:211], s[42:43]
v_pk_mul_f32 v[212:213], v[212:213], s[42:43]
v_pk_mul_f32 v[214:215], v[214:215], s[42:43]
v_pk_mul_f32 v[232:233], v[232:233], s[44:45]
v_pk_mul_f32 v[234:235], v[234:235], s[44:45]
v_pk_mul_f32 v[236:237], v[236:237], s[44:45]
v_pk_mul_f32 v[238:239], v[238:239], s[44:45]
s_waitcnt lgkmcnt(7)
v_mfma_f32_16x16x32_bf16 v[112:115], a[192:195], a[80:83], v[112:115]
s_waitcnt lgkmcnt(6)
v_exp_f32 v44, -|v104|
v_mfma_f32_16x16x32_bf16 v[112:115], a[208:211], a[84:87], v[112:115]
s_waitcnt lgkmcnt(5)
v_exp_f32 v45, -|v105|
v_mfma_f32_16x16x32_bf16 v[112:115], a[224:227], a[88:91], v[112:115]
s_waitcnt lgkmcnt(4)
v_exp_f32 v46, -|v106|
v_mfma_f32_16x16x32_bf16 v[112:115], a[240:243], a[92:95], v[112:115]
s_waitcnt lgkmcnt(3)
v_exp_f32 v47, -|v107|
v_mfma_f32_16x16x32_bf16 v[112:115], a[128:131], a[96:99], v[112:115]
s_waitcnt lgkmcnt(2)
v_exp_f32 v48, -|v108|
v_mfma_f32_16x16x32_bf16 v[112:115], a[144:147], a[100:103], v[112:115]
s_waitcnt lgkmcnt(1)
v_exp_f32 v49, -|v109|
v_mfma_f32_16x16x32_bf16 v[112:115], a[160:163], a[104:107], v[112:115]
s_waitcnt lgkmcnt(0)
v_exp_f32 v50, -|v110|
v_mfma_f32_16x16x32_bf16 v[112:115], a[176:179], a[108:111], v[112:115]
v_exp_f32 v51, -|v111|
v_mfma_f32_16x16x32_bf16 v[116:119], a[180:183], a[108:111], v[116:119]
v_exp_f32 v176, v176
v_mfma_f32_16x16x32_bf16 v[116:119], a[164:167], a[104:107], v[116:119]
v_exp_f32 v177, v177
v_mfma_f32_16x16x32_bf16 v[116:119], a[148:151], a[100:103], v[116:119]
v_exp_f32 v178, v178
v_mfma_f32_16x16x32_bf16 v[116:119], a[132:135], a[96:99], v[116:119]
v_exp_f32 v179, v179
v_mfma_f32_16x16x32_bf16 v[116:119], a[244:247], a[92:95], v[116:119]
v_exp_f32 v180, v180
v_mfma_f32_16x16x32_bf16 v[116:119], a[228:231], a[88:91], v[116:119]
v_exp_f32 v181, v181
v_mfma_f32_16x16x32_bf16 v[116:119], a[212:215], a[84:87], v[116:119]
v_exp_f32 v182, v182
v_mfma_f32_16x16x32_bf16 v[116:119], a[196:199], a[80:83], v[116:119]
v_exp_f32 v183, v183
v_mfma_f32_16x16x32_bf16 v[184:187], a[200:203], a[80:83], v[184:187]
v_exp_f32 v36, -|v208|
v_mfma_f32_16x16x32_bf16 v[184:187], a[216:219], a[84:87], v[184:187]
v_exp_f32 v37, -|v209|
v_mfma_f32_16x16x32_bf16 v[184:187], a[232:235], a[88:91], v[184:187]
v_exp_f32 v38, -|v210|
v_mfma_f32_16x16x32_bf16 v[184:187], a[248:251], a[92:95], v[184:187]
v_exp_f32 v39, -|v211|
v_mfma_f32_16x16x32_bf16 v[184:187], a[136:139], a[96:99], v[184:187]
v_exp_f32 v40, -|v212|
v_mfma_f32_16x16x32_bf16 v[184:187], a[152:155], a[100:103], v[184:187]
v_exp_f32 v41, -|v213|
v_mfma_f32_16x16x32_bf16 v[184:187], a[168:171], a[104:107], v[184:187]
v_exp_f32 v42, -|v214|
v_mfma_f32_16x16x32_bf16 v[184:187], a[184:187], a[108:111], v[184:187]
v_exp_f32 v43, -|v215|
v_mfma_f32_16x16x32_bf16 v[188:191], a[188:191], a[108:111], v[188:191]
v_exp_f32 v28, v232
v_mfma_f32_16x16x32_bf16 v[188:191], a[172:175], a[104:107], v[188:191]
v_exp_f32 v29, v233
v_mfma_f32_16x16x32_bf16 v[188:191], a[156:159], a[100:103], v[188:191]
v_exp_f32 v30, v234
v_mfma_f32_16x16x32_bf16 v[188:191], a[140:143], a[96:99], v[188:191]
v_exp_f32 v31, v235
v_mfma_f32_16x16x32_bf16 v[188:191], a[252:255], a[92:95], v[188:191]
v_exp_f32 v32, v236
v_mfma_f32_16x16x32_bf16 v[188:191], a[236:239], a[88:91], v[188:191]
v_exp_f32 v33, v237
v_mfma_f32_16x16x32_bf16 v[188:191], a[220:223], a[84:87], v[188:191]
v_exp_f32 v34, v238
v_mfma_f32_16x16x32_bf16 v[188:191], a[204:207], a[80:83], v[188:191]
v_exp_f32 v35, v239
ds_read_b128 a[80:83], v5 offset:1024
ds_read_b128 a[84:87], v6 offset:1024
ds_read_b128 a[88:91], v5 offset:17408
ds_read_b128 a[92:95], v6 offset:17408
ds_read_b128 a[96:99], v5 offset:33792
ds_read_b128 a[100:103], v6 offset:33792
ds_read_b128 a[104:107], v5 offset:50176
ds_read_b128 a[108:111], v6 offset:50176
v_pk_add_f32 v[52:53], v[36:37], 1.0 op_sel_hi:[1,0]
v_pk_add_f32 v[54:55], v[38:39], 1.0 op_sel_hi:[1,0]
v_pk_add_f32 v[56:57], v[40:41], 1.0 op_sel_hi:[1,0]
v_pk_add_f32 v[58:59], v[42:43], 1.0 op_sel_hi:[1,0]
v_pk_fma_f32 v[28:29], v[52:53], v[28:29], v[52:53]
v_pk_fma_f32 v[30:31], v[54:55], v[30:31], v[54:55]
v_pk_fma_f32 v[32:33], v[56:57], v[32:33], v[56:57]
v_pk_fma_f32 v[34:35], v[58:59], v[34:35], v[58:59]
v_rcp_f32 v28, v28
v_rcp_f32 v29, v29
v_rcp_f32 v30, v30
v_rcp_f32 v31, v31
v_rcp_f32 v32, v32
v_rcp_f32 v33, v33
v_rcp_f32 v34, v34
v_rcp_f32 v35, v35
v_pk_fma_f32 v[36:37], v[36:37], v[28:29], v[28:29] neg_lo:[1,0,0] neg_hi:[1,0,0]
v_pk_fma_f32 v[38:39], v[38:39], v[30:31], v[30:31] neg_lo:[1,0,0] neg_hi:[1,0,0]
v_pk_fma_f32 v[40:41], v[40:41], v[32:33], v[32:33] neg_lo:[1,0,0] neg_hi:[1,0,0]
v_pk_fma_f32 v[42:43], v[42:43], v[34:35], v[34:35] neg_lo:[1,0,0] neg_hi:[1,0,0]
v_bfi_b32 v36, s50, v36, v208
v_bfi_b32 v37, s50, v37, v209
v_bfi_b32 v38, s50, v38, v210
v_bfi_b32 v39, s50, v39, v211
v_bfi_b32 v40, s50, v40, v212
v_bfi_b32 v41, s50, v41, v213
v_bfi_b32 v42, s50, v42, v214
v_bfi_b32 v43, s50, v43, v215
v_cvt_pk_bf16_f32 v8, v36, v37
v_cvt_pk_bf16_f32 v9, v38, v39
v_cvt_pk_bf16_f32 v10, v40, v41
v_cvt_pk_bf16_f32 v11, v42, v43
buffer_store_dwordx4 v[8:11], v1, s[20:23], s37 offen offset:3072 sc1
v_pk_add_f32 v[52:53], v[44:45], 1.0 op_sel_hi:[1,0]
v_pk_add_f32 v[54:55], v[46:47], 1.0 op_sel_hi:[1,0]
v_pk_add_f32 v[56:57], v[48:49], 1.0 op_sel_hi:[1,0]
v_pk_add_f32 v[58:59], v[50:51], 1.0 op_sel_hi:[1,0]
v_pk_fma_f32 v[176:177], v[52:53], v[176:177], v[52:53]
v_pk_fma_f32 v[178:179], v[54:55], v[178:179], v[54:55]
v_pk_fma_f32 v[180:181], v[56:57], v[180:181], v[56:57]
v_pk_fma_f32 v[182:183], v[58:59], v[182:183], v[58:59]
v_rcp_f32 v176, v176
v_rcp_f32 v177, v177
v_rcp_f32 v178, v178
v_rcp_f32 v179, v179
v_rcp_f32 v180, v180
v_rcp_f32 v181, v181
v_rcp_f32 v182, v182
v_rcp_f32 v183, v183
v_pk_fma_f32 v[44:45], v[44:45], v[176:177], v[176:177] neg_lo:[1,0,0] neg_hi:[1,0,0]
v_pk_fma_f32 v[46:47], v[46:47], v[178:179], v[178:179] neg_lo:[1,0,0] neg_hi:[1,0,0]
v_pk_fma_f32 v[48:49], v[48:49], v[180:181], v[180:181] neg_lo:[1,0,0] neg_hi:[1,0,0]
v_pk_fma_f32 v[50:51], v[50:51], v[182:183], v[182:183] neg_lo:[1,0,0] neg_hi:[1,0,0]
v_bfi_b32 v44, s50, v44, v104
v_bfi_b32 v45, s50, v45, v105
v_bfi_b32 v46, s50, v46, v106
v_bfi_b32 v47, s50, v47, v107
v_bfi_b32 v48, s50, v48, v108
v_bfi_b32 v49, s50, v49, v109
v_bfi_b32 v50, s50, v50, v110
v_bfi_b32 v51, s50, v51, v111
v_cvt_pk_bf16_f32 v76, v44, v45
v_cvt_pk_bf16_f32 v77, v46, v47
v_cvt_pk_bf16_f32 v78, v48, v49
v_cvt_pk_bf16_f32 v79, v50, v51
buffer_store_dwordx4 v[76:79], v1, s[20:23], s36 offen offset:2048 sc1
v_pk_fma_f32 v[112:113], v[112:113], s[46:47], v[200:201] neg_lo:[0,0,1] neg_hi:[0,0,1]
v_pk_fma_f32 v[114:115], v[114:115], s[46:47], v[202:203] neg_lo:[0,0,1] neg_hi:[0,0,1]
v_pk_fma_f32 v[116:117], v[116:117], s[46:47], v[204:205] neg_lo:[0,0,1] neg_hi:[0,0,1]
v_pk_fma_f32 v[118:119], v[118:119], s[46:47], v[206:207] neg_lo:[0,0,1] neg_hi:[0,0,1]
v_pk_fma_f32 v[184:185], v[184:185], s[48:49], v[12:13] neg_lo:[0,0,1] neg_hi:[0,0,1]
v_pk_fma_f32 v[186:187], v[186:187], s[48:49], v[14:15] neg_lo:[0,0,1] neg_hi:[0,0,1]
v_pk_fma_f32 v[188:189], v[188:189], s[48:49], v[16:17] neg_lo:[0,0,1] neg_hi:[0,0,1]
v_pk_fma_f32 v[190:191], v[190:191], s[48:49], v[18:19] neg_lo:[0,0,1] neg_hi:[0,0,1]
v_pk_add_f32 v[216:217], v[128:129], v[216:217]
v_pk_add_f32 v[218:219], v[130:131], v[218:219]
v_pk_add_f32 v[220:221], v[132:133], v[220:221]
v_pk_add_f32 v[222:223], v[134:135], v[222:223]
v_pk_add_f32 v[240:241], v[152:153], v[240:241]
v_pk_add_f32 v[242:243], v[154:155], v[242:243]
v_pk_add_f32 v[244:245], v[156:157], v[244:245]
v_pk_add_f32 v[246:247], v[158:159], v[246:247]
v_pk_mul_f32 v[216:217], v[216:217], s[42:43]
v_pk_mul_f32 v[218:219], v[218:219], s[42:43]
v_pk_mul_f32 v[220:221], v[220:221], s[42:43]
v_pk_mul_f32 v[222:223], v[222:223], s[42:43]
v_pk_mul_f32 v[240:241], v[240:241], s[44:45]
v_pk_mul_f32 v[242:243], v[242:243], s[44:45]
v_pk_mul_f32 v[244:245], v[244:245], s[44:45]
v_pk_mul_f32 v[246:247], v[246:247], s[44:45]
s_waitcnt lgkmcnt(7)
v_mfma_f32_16x16x32_bf16 v[120:123], a[192:195], a[80:83], v[120:123]
s_waitcnt lgkmcnt(6)
v_exp_f32 v44, -|v112|
v_mfma_f32_16x16x32_bf16 v[120:123], a[208:211], a[84:87], v[120:123]
s_waitcnt lgkmcnt(5)
v_exp_f32 v45, -|v113|
v_mfma_f32_16x16x32_bf16 v[120:123], a[224:227], a[88:91], v[120:123]
s_waitcnt lgkmcnt(4)
v_exp_f32 v46, -|v114|
v_mfma_f32_16x16x32_bf16 v[120:123], a[240:243], a[92:95], v[120:123]
s_waitcnt lgkmcnt(3)
v_exp_f32 v47, -|v115|
v_mfma_f32_16x16x32_bf16 v[120:123], a[128:131], a[96:99], v[120:123]
s_waitcnt lgkmcnt(2)
v_exp_f32 v48, -|v116|
v_mfma_f32_16x16x32_bf16 v[120:123], a[144:147], a[100:103], v[120:123]
s_waitcnt lgkmcnt(1)
v_exp_f32 v49, -|v117|
v_mfma_f32_16x16x32_bf16 v[120:123], a[160:163], a[104:107], v[120:123]
s_waitcnt lgkmcnt(0)
v_exp_f32 v50, -|v118|
v_mfma_f32_16x16x32_bf16 v[120:123], a[176:179], a[108:111], v[120:123]
v_exp_f32 v51, -|v119|
v_mfma_f32_16x16x32_bf16 v[124:127], a[180:183], a[108:111], v[124:127]
v_exp_f32 v184, v184
v_mfma_f32_16x16x32_bf16 v[124:127], a[164:167], a[104:107], v[124:127]
v_exp_f32 v185, v185
v_mfma_f32_16x16x32_bf16 v[124:127], a[148:151], a[100:103], v[124:127]
v_exp_f32 v186, v186
v_mfma_f32_16x16x32_bf16 v[124:127], a[132:135], a[96:99], v[124:127]
v_exp_f32 v187, v187
v_mfma_f32_16x16x32_bf16 v[124:127], a[244:247], a[92:95], v[124:127]
v_exp_f32 v188, v188
v_mfma_f32_16x16x32_bf16 v[124:127], a[228:231], a[88:91], v[124:127]
v_exp_f32 v189, v189
v_mfma_f32_16x16x32_bf16 v[124:127], a[212:215], a[84:87], v[124:127]
v_exp_f32 v190, v190
v_mfma_f32_16x16x32_bf16 v[124:127], a[196:199], a[80:83], v[124:127]
v_exp_f32 v191, v191
v_mfma_f32_16x16x32_bf16 v[144:147], a[200:203], a[80:83], v[144:147]
v_exp_f32 v36, -|v216|
v_mfma_f32_16x16x32_bf16 v[144:147], a[216:219], a[84:87], v[144:147]
v_exp_f32 v37, -|v217|
v_mfma_f32_16x16x32_bf16 v[144:147], a[232:235], a[88:91], v[144:147]
v_exp_f32 v38, -|v218|
v_mfma_f32_16x16x32_bf16 v[144:147], a[248:251], a[92:95], v[144:147]
v_exp_f32 v39, -|v219|
v_mfma_f32_16x16x32_bf16 v[144:147], a[136:139], a[96:99], v[144:147]
v_exp_f32 v40, -|v220|
v_mfma_f32_16x16x32_bf16 v[144:147], a[152:155], a[100:103], v[144:147]
v_exp_f32 v41, -|v221|
v_mfma_f32_16x16x32_bf16 v[144:147], a[168:171], a[104:107], v[144:147]
v_exp_f32 v42, -|v222|
v_mfma_f32_16x16x32_bf16 v[144:147], a[184:187], a[108:111], v[144:147]
v_exp_f32 v43, -|v223|
v_mfma_f32_16x16x32_bf16 v[148:151], a[188:191], a[108:111], v[148:151]
v_exp_f32 v28, v240
v_mfma_f32_16x16x32_bf16 v[148:151], a[172:175], a[104:107], v[148:151]
v_exp_f32 v29, v241
v_mfma_f32_16x16x32_bf16 v[148:151], a[156:159], a[100:103], v[148:151]
v_exp_f32 v30, v242
v_mfma_f32_16x16x32_bf16 v[148:151], a[140:143], a[96:99], v[148:151]
v_exp_f32 v31, v243
v_mfma_f32_16x16x32_bf16 v[148:151], a[252:255], a[92:95], v[148:151]
v_exp_f32 v32, v244
v_mfma_f32_16x16x32_bf16 v[148:151], a[236:239], a[88:91], v[148:151]
v_exp_f32 v33, v245
v_mfma_f32_16x16x32_bf16 v[148:151], a[220:223], a[84:87], v[148:151]
v_exp_f32 v34, v246
v_mfma_f32_16x16x32_bf16 v[148:151], a[204:207], a[80:83], v[148:151]
v_exp_f32 v35, v247
ds_read_b128 a[80:83], v5 offset:2048
ds_read_b128 a[84:87], v6 offset:2048
ds_read_b128 a[88:91], v5 offset:18432
ds_read_b128 a[92:95], v6 offset:18432
ds_read_b128 a[96:99], v5 offset:34816
ds_read_b128 a[100:103], v6 offset:34816
ds_read_b128 a[104:107], v5 offset:51200
ds_read_b128 a[108:111], v6 offset:51200
v_pk_add_f32 v[52:53], v[36:37], 1.0 op_sel_hi:[1,0]
v_pk_add_f32 v[54:55], v[38:39], 1.0 op_sel_hi:[1,0]
v_pk_add_f32 v[56:57], v[40:41], 1.0 op_sel_hi:[1,0]
v_pk_add_f32 v[58:59], v[42:43], 1.0 op_sel_hi:[1,0]
v_pk_fma_f32 v[28:29], v[52:53], v[28:29], v[52:53]
v_pk_fma_f32 v[30:31], v[54:55], v[30:31], v[54:55]
v_pk_fma_f32 v[32:33], v[56:57], v[32:33], v[56:57]
v_pk_fma_f32 v[34:35], v[58:59], v[34:35], v[58:59]
v_rcp_f32 v28, v28
v_rcp_f32 v29, v29
v_rcp_f32 v30, v30
v_rcp_f32 v31, v31
v_rcp_f32 v32, v32
v_rcp_f32 v33, v33
v_rcp_f32 v34, v34
v_rcp_f32 v35, v35
v_pk_fma_f32 v[36:37], v[36:37], v[28:29], v[28:29] neg_lo:[1,0,0] neg_hi:[1,0,0]
v_pk_fma_f32 v[38:39], v[38:39], v[30:31], v[30:31] neg_lo:[1,0,0] neg_hi:[1,0,0]
v_pk_fma_f32 v[40:41], v[40:41], v[32:33], v[32:33] neg_lo:[1,0,0] neg_hi:[1,0,0]
v_pk_fma_f32 v[42:43], v[42:43], v[34:35], v[34:35] neg_lo:[1,0,0] neg_hi:[1,0,0]
v_bfi_b32 v36, s50, v36, v216
v_bfi_b32 v37, s50, v37, v217
v_bfi_b32 v38, s50, v38, v218
v_bfi_b32 v39, s50, v39, v219
v_bfi_b32 v40, s50, v40, v220
v_bfi_b32 v41, s50, v41, v221
v_bfi_b32 v42, s50, v42, v222
v_bfi_b32 v43, s50, v43, v223
v_cvt_pk_bf16_f32 v8, v36, v37
v_cvt_pk_bf16_f32 v9, v38, v39
v_cvt_pk_bf16_f32 v10, v40, v41
v_cvt_pk_bf16_f32 v11, v42, v43
buffer_store_dwordx4 v[8:11], v2, s[20:23], s38 offen offset:1024 sc1
v_pk_add_f32 v[52:53], v[44:45], 1.0 op_sel_hi:[1,0]
v_pk_add_f32 v[54:55], v[46:47], 1.0 op_sel_hi:[1,0]
v_pk_add_f32 v[56:57], v[48:49], 1.0 op_sel_hi:[1,0]
v_pk_add_f32 v[58:59], v[50:51], 1.0 op_sel_hi:[1,0]
v_pk_fma_f32 v[184:185], v[52:53], v[184:185], v[52:53]
v_pk_fma_f32 v[186:187], v[54:55], v[186:187], v[54:55]
v_pk_fma_f32 v[188:189], v[56:57], v[188:189], v[56:57]
v_pk_fma_f32 v[190:191], v[58:59], v[190:191], v[58:59]
v_rcp_f32 v184, v184
v_rcp_f32 v185, v185
v_rcp_f32 v186, v186
v_rcp_f32 v187, v187
v_rcp_f32 v188, v188
v_rcp_f32 v189, v189
v_rcp_f32 v190, v190
v_rcp_f32 v191, v191
v_pk_fma_f32 v[44:45], v[44:45], v[184:185], v[184:185] neg_lo:[1,0,0] neg_hi:[1,0,0]
v_pk_fma_f32 v[46:47], v[46:47], v[186:187], v[186:187] neg_lo:[1,0,0] neg_hi:[1,0,0]
v_pk_fma_f32 v[48:49], v[48:49], v[188:189], v[188:189] neg_lo:[1,0,0] neg_hi:[1,0,0]
v_pk_fma_f32 v[50:51], v[50:51], v[190:191], v[190:191] neg_lo:[1,0,0] neg_hi:[1,0,0]
v_bfi_b32 v44, s50, v44, v112
v_bfi_b32 v45, s50, v45, v113
v_bfi_b32 v46, s50, v46, v114
v_bfi_b32 v47, s50, v47, v115
v_bfi_b32 v48, s50, v48, v116
v_bfi_b32 v49, s50, v49, v117
v_bfi_b32 v50, s50, v50, v118
v_bfi_b32 v51, s50, v51, v119
v_cvt_pk_bf16_f32 v76, v44, v45
v_cvt_pk_bf16_f32 v77, v46, v47
v_cvt_pk_bf16_f32 v78, v48, v49
v_cvt_pk_bf16_f32 v79, v50, v51
buffer_store_dwordx4 v[76:79], v1, s[20:23], s37 offen offset:0 sc1
v_pk_fma_f32 v[120:121], v[120:121], s[46:47], v[208:209] neg_lo:[0,0,1] neg_hi:[0,0,1]
v_pk_fma_f32 v[122:123], v[122:123], s[46:47], v[210:211] neg_lo:[0,0,1] neg_hi:[0,0,1]
v_pk_fma_f32 v[124:125], v[124:125], s[46:47], v[212:213] neg_lo:[0,0,1] neg_hi:[0,0,1]
v_pk_fma_f32 v[126:127], v[126:127], s[46:47], v[214:215] neg_lo:[0,0,1] neg_hi:[0,0,1]
v_pk_fma_f32 v[144:145], v[144:145], s[48:49], v[232:233] neg_lo:[0,0,1] neg_hi:[0,0,1]
v_pk_fma_f32 v[146:147], v[146:147], s[48:49], v[234:235] neg_lo:[0,0,1] neg_hi:[0,0,1]
v_pk_fma_f32 v[148:149], v[148:149], s[48:49], v[236:237] neg_lo:[0,0,1] neg_hi:[0,0,1]
v_pk_fma_f32 v[150:151], v[150:151], s[48:49], v[238:239] neg_lo:[0,0,1] neg_hi:[0,0,1]
v_pk_add_f32 v[224:225], v[136:137], v[224:225]
v_pk_add_f32 v[226:227], v[138:139], v[226:227]
v_pk_add_f32 v[228:229], v[140:141], v[228:229]
v_pk_add_f32 v[230:231], v[142:143], v[230:231]
v_pk_add_f32 v[248:249], v[160:161], v[248:249]
v_pk_add_f32 v[250:251], v[162:163], v[250:251]
v_pk_add_f32 v[252:253], v[164:165], v[252:253]
v_pk_add_f32 v[254:255], v[166:167], v[254:255]
v_pk_mul_f32 v[224:225], v[224:225], s[42:43]
v_pk_mul_f32 v[226:227], v[226:227], s[42:43]
v_pk_mul_f32 v[228:229], v[228:229], s[42:43]
v_pk_mul_f32 v[230:231], v[230:231], s[42:43]
v_pk_mul_f32 v[248:249], v[248:249], s[44:45]
v_pk_mul_f32 v[250:251], v[250:251], s[44:45]
v_pk_mul_f32 v[252:253], v[252:253], s[44:45]
v_pk_mul_f32 v[254:255], v[254:255], s[44:45]
s_waitcnt lgkmcnt(7)
v_mfma_f32_16x16x32_bf16 v[128:131], a[192:195], a[80:83], v[128:131]
s_waitcnt lgkmcnt(6)
v_exp_f32 v44, -|v120|
v_mfma_f32_16x16x32_bf16 v[128:131], a[208:211], a[84:87], v[128:131]
s_waitcnt lgkmcnt(5)
v_exp_f32 v45, -|v121|
v_mfma_f32_16x16x32_bf16 v[128:131], a[224:227], a[88:91], v[128:131]
s_waitcnt lgkmcnt(4)
v_exp_f32 v46, -|v122|
v_mfma_f32_16x16x32_bf16 v[128:131], a[240:243], a[92:95], v[128:131]
s_waitcnt lgkmcnt(3)
v_exp_f32 v47, -|v123|
v_mfma_f32_16x16x32_bf16 v[128:131], a[128:131], a[96:99], v[128:131]
s_waitcnt lgkmcnt(2)
v_exp_f32 v48, -|v124|
v_mfma_f32_16x16x32_bf16 v[128:131], a[144:147], a[100:103], v[128:131]
s_waitcnt lgkmcnt(1)
v_exp_f32 v49, -|v125|
v_mfma_f32_16x16x32_bf16 v[128:131], a[160:163], a[104:107], v[128:131]
s_waitcnt lgkmcnt(0)
v_exp_f32 v50, -|v126|
v_mfma_f32_16x16x32_bf16 v[128:131], a[176:179], a[108:111], v[128:131]
v_exp_f32 v51, -|v127|
v_mfma_f32_16x16x32_bf16 v[132:135], a[180:183], a[108:111], v[132:135]
v_exp_f32 v144, v144
v_mfma_f32_16x16x32_bf16 v[132:135], a[164:167], a[104:107], v[132:135]
v_exp_f32 v145, v145
v_mfma_f32_16x16x32_bf16 v[132:135], a[148:151], a[100:103], v[132:135]
v_exp_f32 v146, v146
v_mfma_f32_16x16x32_bf16 v[132:135], a[132:135], a[96:99], v[132:135]
v_exp_f32 v147, v147
v_mfma_f32_16x16x32_bf16 v[132:135], a[244:247], a[92:95], v[132:135]
v_exp_f32 v148, v148
v_mfma_f32_16x16x32_bf16 v[132:135], a[228:231], a[88:91], v[132:135]
v_exp_f32 v149, v149
v_mfma_f32_16x16x32_bf16 v[132:135], a[212:215], a[84:87], v[132:135]
v_exp_f32 v150, v150
v_mfma_f32_16x16x32_bf16 v[132:135], a[196:199], a[80:83], v[132:135]
v_exp_f32 v151, v151
v_mfma_f32_16x16x32_bf16 v[152:155], a[200:203], a[80:83], v[152:155]
v_exp_f32 v36, -|v224|
v_mfma_f32_16x16x32_bf16 v[152:155], a[216:219], a[84:87], v[152:155]
v_exp_f32 v37, -|v225|
v_mfma_f32_16x16x32_bf16 v[152:155], a[232:235], a[88:91], v[152:155]
v_exp_f32 v38, -|v226|
v_mfma_f32_16x16x32_bf16 v[152:155], a[248:251], a[92:95], v[152:155]
v_exp_f32 v39, -|v227|
v_mfma_f32_16x16x32_bf16 v[152:155], a[136:139], a[96:99], v[152:155]
v_exp_f32 v40, -|v228|
v_mfma_f32_16x16x32_bf16 v[152:155], a[152:155], a[100:103], v[152:155]
v_exp_f32 v41, -|v229|
v_mfma_f32_16x16x32_bf16 v[152:155], a[168:171], a[104:107], v[152:155]
v_exp_f32 v42, -|v230|
v_mfma_f32_16x16x32_bf16 v[152:155], a[184:187], a[108:111], v[152:155]
v_exp_f32 v43, -|v231|
v_mfma_f32_16x16x32_bf16 v[156:159], a[188:191], a[108:111], v[156:159]
v_exp_f32 v28, v248
v_mfma_f32_16x16x32_bf16 v[156:159], a[172:175], a[104:107], v[156:159]
v_exp_f32 v29, v249
v_mfma_f32_16x16x32_bf16 v[156:159], a[156:159], a[100:103], v[156:159]
v_exp_f32 v30, v250
v_mfma_f32_16x16x32_bf16 v[156:159], a[140:143], a[96:99], v[156:159]
v_exp_f32 v31, v251
v_mfma_f32_16x16x32_bf16 v[156:159], a[252:255], a[92:95], v[156:159]
v_exp_f32 v32, v252
v_mfma_f32_16x16x32_bf16 v[156:159], a[236:239], a[88:91], v[156:159]
v_exp_f32 v33, v253
v_mfma_f32_16x16x32_bf16 v[156:159], a[220:223], a[84:87], v[156:159]
v_exp_f32 v34, v254
v_mfma_f32_16x16x32_bf16 v[156:159], a[204:207], a[80:83], v[156:159]
v_exp_f32 v35, v255
ds_read_b128 a[80:83], v5 offset:3072
ds_read_b128 a[84:87], v6 offset:3072
ds_read_b128 a[88:91], v5 offset:19456
ds_read_b128 a[92:95], v6 offset:19456
ds_read_b128 a[96:99], v5 offset:35840
ds_read_b128 a[100:103], v6 offset:35840
ds_read_b128 a[104:107], v5 offset:52224
ds_read_b128 a[108:111], v6 offset:52224
v_pk_add_f32 v[52:53], v[36:37], 1.0 op_sel_hi:[1,0]
v_pk_add_f32 v[54:55], v[38:39], 1.0 op_sel_hi:[1,0]
v_pk_add_f32 v[56:57], v[40:41], 1.0 op_sel_hi:[1,0]
v_pk_add_f32 v[58:59], v[42:43], 1.0 op_sel_hi:[1,0]
v_pk_fma_f32 v[28:29], v[52:53], v[28:29], v[52:53]
v_pk_fma_f32 v[30:31], v[54:55], v[30:31], v[54:55]
v_pk_fma_f32 v[32:33], v[56:57], v[32:33], v[56:57]
v_pk_fma_f32 v[34:35], v[58:59], v[34:35], v[58:59]
v_pk_add_f32 v[52:53], v[44:45], 1.0 op_sel_hi:[1,0]
v_pk_add_f32 v[54:55], v[46:47], 1.0 op_sel_hi:[1,0]
v_pk_add_f32 v[56:57], v[48:49], 1.0 op_sel_hi:[1,0]
v_pk_add_f32 v[58:59], v[50:51], 1.0 op_sel_hi:[1,0]
v_pk_fma_f32 v[144:145], v[52:53], v[144:145], v[52:53]
v_pk_fma_f32 v[146:147], v[54:55], v[146:147], v[54:55]
v_pk_fma_f32 v[148:149], v[56:57], v[148:149], v[56:57]
v_pk_fma_f32 v[150:151], v[58:59], v[150:151], v[58:59]
v_rcp_f32 v144, v144
v_rcp_f32 v145, v145
v_rcp_f32 v146, v146
v_rcp_f32 v147, v147
v_rcp_f32 v148, v148
v_rcp_f32 v149, v149
v_rcp_f32 v150, v150
v_rcp_f32 v151, v151
v_pk_fma_f32 v[44:45], v[44:45], v[144:145], v[144:145] neg_lo:[1,0,0] neg_hi:[1,0,0]
v_pk_fma_f32 v[46:47], v[46:47], v[146:147], v[146:147] neg_lo:[1,0,0] neg_hi:[1,0,0]
v_pk_fma_f32 v[48:49], v[48:49], v[148:149], v[148:149] neg_lo:[1,0,0] neg_hi:[1,0,0]
v_pk_fma_f32 v[50:51], v[50:51], v[150:151], v[150:151] neg_lo:[1,0,0] neg_hi:[1,0,0]
v_bfi_b32 v44, s50, v44, v120
v_bfi_b32 v45, s50, v45, v121
v_bfi_b32 v46, s50, v46, v122
v_bfi_b32 v47, s50, v47, v123
v_bfi_b32 v48, s50, v48, v124
v_bfi_b32 v49, s50, v49, v125
v_bfi_b32 v50, s50, v50, v126
v_bfi_b32 v51, s50, v51, v127
v_cvt_pk_bf16_f32 v76, v44, v45
v_cvt_pk_bf16_f32 v77, v46, v47
v_cvt_pk_bf16_f32 v78, v48, v49
v_cvt_pk_bf16_f32 v79, v50, v51
buffer_store_dwordx4 v[76:79], v1, s[20:23], s37 offen offset:2048 sc1
v_pk_fma_f32 v[128:129], v[128:129], s[46:47], v[216:217] neg_lo:[0,0,1] neg_hi:[0,0,1]
v_pk_fma_f32 v[130:131], v[130:131], s[46:47], v[218:219] neg_lo:[0,0,1] neg_hi:[0,0,1]
v_pk_fma_f32 v[132:133], v[132:133], s[46:47], v[220:221] neg_lo:[0,0,1] neg_hi:[0,0,1]
v_pk_fma_f32 v[134:135], v[134:135], s[46:47], v[222:223] neg_lo:[0,0,1] neg_hi:[0,0,1]
v_pk_fma_f32 v[152:153], v[152:153], s[48:49], v[240:241] neg_lo:[0,0,1] neg_hi:[0,0,1]
v_pk_fma_f32 v[154:155], v[154:155], s[48:49], v[242:243] neg_lo:[0,0,1] neg_hi:[0,0,1]
v_pk_fma_f32 v[156:157], v[156:157], s[48:49], v[244:245] neg_lo:[0,0,1] neg_hi:[0,0,1]
v_pk_fma_f32 v[158:159], v[158:159], s[48:49], v[246:247] neg_lo:[0,0,1] neg_hi:[0,0,1]
s_waitcnt lgkmcnt(7)
v_mfma_f32_16x16x32_bf16 v[136:139], a[192:195], a[80:83], v[136:139]
s_waitcnt lgkmcnt(6)
v_rcp_f32 v28, v28
v_mfma_f32_16x16x32_bf16 v[136:139], a[208:211], a[84:87], v[136:139]
s_waitcnt lgkmcnt(5)
v_rcp_f32 v29, v29
v_mfma_f32_16x16x32_bf16 v[136:139], a[224:227], a[88:91], v[136:139]
s_waitcnt lgkmcnt(4)
v_rcp_f32 v30, v30
v_mfma_f32_16x16x32_bf16 v[136:139], a[240:243], a[92:95], v[136:139]
s_waitcnt lgkmcnt(3)
v_rcp_f32 v31, v31
v_mfma_f32_16x16x32_bf16 v[136:139], a[128:131], a[96:99], v[136:139]
s_waitcnt lgkmcnt(2)
v_rcp_f32 v32, v32
v_mfma_f32_16x16x32_bf16 v[136:139], a[144:147], a[100:103], v[136:139]
s_waitcnt lgkmcnt(1)
v_rcp_f32 v33, v33
v_mfma_f32_16x16x32_bf16 v[136:139], a[160:163], a[104:107], v[136:139]
s_waitcnt lgkmcnt(0)
v_rcp_f32 v34, v34
v_mfma_f32_16x16x32_bf16 v[136:139], a[176:179], a[108:111], v[136:139]
v_rcp_f32 v35, v35
v_mfma_f32_16x16x32_bf16 v[140:143], a[180:183], a[108:111], v[140:143]
v_exp_f32 v44, -|v128|
v_mfma_f32_16x16x32_bf16 v[140:143], a[164:167], a[104:107], v[140:143]
v_exp_f32 v45, -|v129|
v_mfma_f32_16x16x32_bf16 v[140:143], a[148:151], a[100:103], v[140:143]
v_exp_f32 v46, -|v130|
v_mfma_f32_16x16x32_bf16 v[140:143], a[132:135], a[96:99], v[140:143]
v_exp_f32 v47, -|v131|
v_mfma_f32_16x16x32_bf16 v[140:143], a[244:247], a[92:95], v[140:143]
v_exp_f32 v48, -|v132|
v_mfma_f32_16x16x32_bf16 v[140:143], a[228:231], a[88:91], v[140:143]
v_exp_f32 v49, -|v133|
v_mfma_f32_16x16x32_bf16 v[140:143], a[212:215], a[84:87], v[140:143]
v_exp_f32 v50, -|v134|
v_mfma_f32_16x16x32_bf16 v[140:143], a[196:199], a[80:83], v[140:143]
v_exp_f32 v51, -|v135|
v_mfma_f32_16x16x32_bf16 v[160:163], a[200:203], a[80:83], v[160:163]
v_exp_f32 v152, v152
v_mfma_f32_16x16x32_bf16 v[160:163], a[216:219], a[84:87], v[160:163]
v_exp_f32 v153, v153
v_mfma_f32_16x16x32_bf16 v[160:163], a[232:235], a[88:91], v[160:163]
v_exp_f32 v154, v154
v_mfma_f32_16x16x32_bf16 v[160:163], a[248:251], a[92:95], v[160:163]
v_exp_f32 v155, v155
v_mfma_f32_16x16x32_bf16 v[160:163], a[136:139], a[96:99], v[160:163]
v_exp_f32 v156, v156
v_mfma_f32_16x16x32_bf16 v[160:163], a[152:155], a[100:103], v[160:163]
v_exp_f32 v157, v157
v_mfma_f32_16x16x32_bf16 v[160:163], a[168:171], a[104:107], v[160:163]
v_exp_f32 v158, v158
v_mfma_f32_16x16x32_bf16 v[160:163], a[184:187], a[108:111], v[160:163]
v_exp_f32 v159, v159
v_mfma_f32_16x16x32_bf16 v[164:167], a[188:191], a[108:111], v[164:167]
v_fma_f32 v36, -v36, v28, v28
v_fma_f32 v37, -v37, v29, v29
v_mfma_f32_16x16x32_bf16 v[164:167], a[172:175], a[104:107], v[164:167]
v_fma_f32 v38, -v38, v30, v30
v_fma_f32 v39, -v39, v31, v31
v_mfma_f32_16x16x32_bf16 v[164:167], a[156:159], a[100:103], v[164:167]
v_fma_f32 v40, -v40, v32, v32
v_fma_f32 v41, -v41, v33, v33
v_mfma_f32_16x16x32_bf16 v[164:167], a[140:143], a[96:99], v[164:167]
v_fma_f32 v42, -v42, v34, v34
v_fma_f32 v43, -v43, v35, v35
v_mfma_f32_16x16x32_bf16 v[164:167], a[252:255], a[92:95], v[164:167]
v_bfi_b32 v36, s50, v36, v224
v_bfi_b32 v37, s50, v37, v225
v_mfma_f32_16x16x32_bf16 v[164:167], a[236:239], a[88:91], v[164:167]
v_bfi_b32 v38, s50, v38, v226
v_bfi_b32 v39, s50, v39, v227
v_mfma_f32_16x16x32_bf16 v[164:167], a[220:223], a[84:87], v[164:167]
v_bfi_b32 v40, s50, v40, v228
v_bfi_b32 v41, s50, v41, v229
v_mfma_f32_16x16x32_bf16 v[164:167], a[204:207], a[80:83], v[164:167]
v_bfi_b32 v42, s50, v42, v230
v_bfi_b32 v43, s50, v43, v231
v_cvt_pk_bf16_f32 v8, v36, v37
v_cvt_pk_bf16_f32 v9, v38, v39
v_cvt_pk_bf16_f32 v10, v40, v41
v_cvt_pk_bf16_f32 v11, v42, v43
buffer_store_dwordx4 v[8:11], v2, s[20:23], s38 offen offset:3072 sc1
v_pk_add_f32 v[52:53], v[44:45], 1.0 op_sel_hi:[1,0]
v_pk_add_f32 v[54:55], v[46:47], 1.0 op_sel_hi:[1,0]
v_pk_add_f32 v[56:57], v[48:49], 1.0 op_sel_hi:[1,0]
v_pk_add_f32 v[58:59], v[50:51], 1.0 op_sel_hi:[1,0]
v_pk_fma_f32 v[152:153], v[52:53], v[152:153], v[52:53]
v_pk_fma_f32 v[154:155], v[54:55], v[154:155], v[54:55]
v_pk_fma_f32 v[156:157], v[56:57], v[156:157], v[56:57]
v_pk_fma_f32 v[158:159], v[58:59], v[158:159], v[58:59]
v_rcp_f32 v152, v152
v_rcp_f32 v153, v153
v_rcp_f32 v154, v154
v_rcp_f32 v155, v155
v_rcp_f32 v156, v156
v_rcp_f32 v157, v157
v_rcp_f32 v158, v158
v_rcp_f32 v159, v159
v_pk_fma_f32 v[44:45], v[44:45], v[152:153], v[152:153] neg_lo:[1,0,0] neg_hi:[1,0,0]
v_pk_fma_f32 v[46:47], v[46:47], v[154:155], v[154:155] neg_lo:[1,0,0] neg_hi:[1,0,0]
v_pk_fma_f32 v[48:49], v[48:49], v[156:157], v[156:157] neg_lo:[1,0,0] neg_hi:[1,0,0]
v_pk_fma_f32 v[50:51], v[50:51], v[158:159], v[158:159] neg_lo:[1,0,0] neg_hi:[1,0,0]
v_bfi_b32 v44, s50, v44, v128
v_bfi_b32 v45, s50, v45, v129
v_bfi_b32 v46, s50, v46, v130
v_bfi_b32 v47, s50, v47, v131
v_bfi_b32 v48, s50, v48, v132
v_bfi_b32 v49, s50, v49, v133
v_bfi_b32 v50, s50, v50, v134
v_bfi_b32 v51, s50, v51, v135
v_cvt_pk_bf16_f32 v76, v44, v45
v_cvt_pk_bf16_f32 v77, v46, v47
v_cvt_pk_bf16_f32 v78, v48, v49
v_cvt_pk_bf16_f32 v79, v50, v51
buffer_store_dwordx4 v[76:79], v1, s[20:23], s38 offen offset:0 sc1
v_pk_fma_f32 v[136:137], v[136:137], s[46:47], v[224:225] neg_lo:[0,0,1] neg_hi:[0,0,1]
v_pk_fma_f32 v[138:139], v[138:139], s[46:47], v[226:227] neg_lo:[0,0,1] neg_hi:[0,0,1]
v_pk_fma_f32 v[140:141], v[140:141], s[46:47], v[228:229] neg_lo:[0,0,1] neg_hi:[0,0,1]
v_pk_fma_f32 v[142:143], v[142:143], s[46:47], v[230:231] neg_lo:[0,0,1] neg_hi:[0,0,1]
v_pk_fma_f32 v[160:161], v[160:161], s[48:49], v[248:249] neg_lo:[0,0,1] neg_hi:[0,0,1]
v_pk_fma_f32 v[162:163], v[162:163], s[48:49], v[250:251] neg_lo:[0,0,1] neg_hi:[0,0,1]
v_pk_fma_f32 v[164:165], v[164:165], s[48:49], v[252:253] neg_lo:[0,0,1] neg_hi:[0,0,1]
v_pk_fma_f32 v[166:167], v[166:167], s[48:49], v[254:255] neg_lo:[0,0,1] neg_hi:[0,0,1]
v_exp_f32 v44, -|v136|
v_exp_f32 v45, -|v137|
v_exp_f32 v46, -|v138|
v_exp_f32 v47, -|v139|
v_exp_f32 v48, -|v140|
v_exp_f32 v49, -|v141|
v_exp_f32 v50, -|v142|
v_exp_f32 v51, -|v143|
v_exp_f32 v160, v160
v_exp_f32 v161, v161
v_exp_f32 v162, v162
v_exp_f32 v163, v163
v_exp_f32 v164, v164
v_exp_f32 v165, v165
v_exp_f32 v166, v166
v_exp_f32 v167, v167
v_pk_add_f32 v[52:53], v[44:45], 1.0 op_sel_hi:[1,0]
v_pk_add_f32 v[54:55], v[46:47], 1.0 op_sel_hi:[1,0]
v_pk_add_f32 v[56:57], v[48:49], 1.0 op_sel_hi:[1,0]
v_pk_add_f32 v[58:59], v[50:51], 1.0 op_sel_hi:[1,0]
v_pk_fma_f32 v[160:161], v[52:53], v[160:161], v[52:53]
v_pk_fma_f32 v[162:163], v[54:55], v[162:163], v[54:55]
v_pk_fma_f32 v[164:165], v[56:57], v[164:165], v[56:57]
v_pk_fma_f32 v[166:167], v[58:59], v[166:167], v[58:59]
v_rcp_f32 v160, v160
v_rcp_f32 v161, v161
v_rcp_f32 v162, v162
v_rcp_f32 v163, v163
v_rcp_f32 v164, v164
v_rcp_f32 v165, v165
v_rcp_f32 v166, v166
v_rcp_f32 v167, v167
v_pk_fma_f32 v[44:45], v[44:45], v[160:161], v[160:161] neg_lo:[1,0,0] neg_hi:[1,0,0]
v_pk_fma_f32 v[46:47], v[46:47], v[162:163], v[162:163] neg_lo:[1,0,0] neg_hi:[1,0,0]
v_pk_fma_f32 v[48:49], v[48:49], v[164:165], v[164:165] neg_lo:[1,0,0] neg_hi:[1,0,0]
v_pk_fma_f32 v[50:51], v[50:51], v[166:167], v[166:167] neg_lo:[1,0,0] neg_hi:[1,0,0]
v_bfi_b32 v44, s50, v44, v136
v_bfi_b32 v45, s50, v45, v137
v_bfi_b32 v46, s50, v46, v138
v_bfi_b32 v47, s50, v47, v139
v_bfi_b32 v48, s50, v48, v140
v_bfi_b32 v49, s50, v49, v141
v_bfi_b32 v50, s50, v50, v142
v_bfi_b32 v51, s50, v51, v143
v_cvt_pk_bf16_f32 v76, v44, v45
v_cvt_pk_bf16_f32 v77, v46, v47
v_cvt_pk_bf16_f32 v78, v48, v49
v_cvt_pk_bf16_f32 v79, v50, v51
buffer_store_dwordx4 v[76:79], v2, s[20:23], s38 offen offset:2048 sc1
s_endpgm
L_slow:
s_mov_b32 s52, 0
L_spin:
s_sleep 2
buffer_load_dword v248, v249, s[24:27], 0 offen sc1
s_waitcnt vmcnt(0)
v_readfirstlane_b32 s68, v248
s_add_u32 s52, s52, 1
s_nop 0
s_cmp_ge_u32 s68, 128
s_cbranch_scc1 L_back
s_cmp_lt_u32 s52, 100
s_cbranch_scc1 L_spin
v_and_b32 v228, 15, v0
v_lshrrev_b32 v229, 2, v228
v_and_b32 v228, 3, v228
v_lshl_add_u32 v228, v229, 3, v228
v_lshlrev_b32 v228, 1, v228
v_lshrrev_b32 v229, 4, v0
v_lshl_add_u32 v228, v229, 11, v228
v_add_u32 v228, s51, v228
s_mov_b32 s52, 0
L_fb:
s_lshr_b32 s53, s52, 2
s_and_b32 s54, s52, 3
s_lshl_b32 s55, s53, 15
s_lshr_b32 s56, s54, 1
s_lshl_b32 s56, s56, 9
s_add_u32 s55, s55, s56
s_and_b32 s56, s54, 1
s_lshl_b32 s56, s56, 3
s_add_u32 s55, s55, s56
buffer_load_ushort v168, v228, s[12:15], s55 offen offset:0
buffer_load_ushort v169, v228, s[12:15], s55 offen offset:1024
s_add_u32 s55, s55, 8192
buffer_load_ushort v170, v228, s[12:15], s55 offen offset:0
buffer_load_ushort v171, v228, s[12:15], s55 offen offset:1024
s_add_u32 s55, s55, 8192
buffer_load_ushort v172, v228, s[12:15], s55 offen offset:0
buffer_load_ushort v173, v228, s[12:15], s55 offen offset:1024
s_add_u32 s55, s55, 8192
buffer_load_ushort v174, v228, s[12:15], s55 offen offset:0
buffer_load_ushort v175, v228, s[12:15], s55 offen offset:1024
s_add_u32 s55, s55, 237568
buffer_load_ushort v176, v228, s[12:15], s55 offen offset:0
buffer_load_ushort v177, v228, s[12:15], s55 offen offset:1024
s_add_u32 s55, s55, 8192
buffer_load_ushort v178, v228, s[12:15], s55 offen offset:0
buffer_load_ushort v179, v228, s[12:15], s55 offen offset:1024
s_add_u32 s55, s55, 8192
buffer_load_ushort v180, v228, s[12:15], s55 offen offset:0
buffer_load_ushort v181, v228, s[12:15], s55 offen offset:1024
s_add_u32 s55, s55, 8192
buffer_load_ushort v182, v228, s[12:15], s55 offen offset:0
buffer_load_ushort v183, v228, s[12:15], s55 offen offset:1024
s_add_u32 s55, s55, 237568
buffer_load_ushort v184, v228, s[12:15], s55 offen offset:0
buffer_load_ushort v185, v228, s[12:15], s55 offen offset:1024
s_add_u32 s55, s55, 8192
buffer_load_ushort v186, v228, s[12:15], s55 offen offset:0
buffer_load_ushort v187, v228, s[12:15], s55 offen offset:1024
s_add_u32 s55, s55, 8192
buffer_load_ushort v188, v228, s[12:15], s55 offen offset:0
buffer_load_ushort v189, v228, s[12:15], s55 offen offset:1024
s_add_u32 s55, s55, 8192
buffer_load_ushort v190, v228, s[12:15], s55 offen offset:0
buffer_load_ushort v191, v228, s[12:15], s55 offen offset:1024
s_add_u32 s55, s55, 237568
buffer_load_ushort v192, v228, s[12:15], s55 offen offset:0
buffer_load_ushort v193, v228, s[12:15], s55 offen offset:1024
s_add_u32 s55, s55, 8192
buffer_load_ushort v194, v228, s[12:15], s55 offen offset:0
buffer_load_ushort v195, v228, s[12:15], s55 offen offset:1024
s_add_u32 s55, s55, 8192
buffer_load_ushort v196, v228, s[12:15], s55 offen offset:0
buffer_load_ushort v197, v228, s[12:15], s55 offen offset:1024
s_add_u32 s55, s55, 8192
buffer_load_ushort v198, v228, s[12:15], s55 offen offset:0
buffer_load_ushort v199, v228, s[12:15], s55 offen offset:1024
s_add_u32 s55, s55, 237568
buffer_load_ushort v200, v228, s[12:15], s55 offen offset:0
buffer_load_ushort v201, v228, s[12:15], s55 offen offset:1024
s_add_u32 s55, s55, 8192
buffer_load_ushort v202, v228, s[12:15], s55 offen offset:0
buffer_load_ushort v203, v228, s[12:15], s55 offen offset:1024
s_add_u32 s55, s55, 8192
buffer_load_ushort v204, v228, s[12:15], s55 offen offset:0
buffer_load_ushort v205, v228, s[12:15], s55 offen offset:1024
s_add_u32 s55, s55, 8192
buffer_load_ushort v206, v228, s[12:15], s55 offen offset:0
buffer_load_ushort v207, v228, s[12:15], s55 offen offset:1024
s_add_u32 s55, s55, 237568
s_waitcnt vmcnt(0)
v_lshlrev_b32 v168, 16, v168
v_lshlrev_b32 v169, 16, v169
v_lshlrev_b32 v170, 16, v170
v_lshlrev_b32 v171, 16, v171
v_lshlrev_b32 v172, 16, v172
v_lshlrev_b32 v173, 16, v173
v_lshlrev_b32 v174, 16, v174
v_lshlrev_b32 v175, 16, v175
v_lshlrev_b32 v176, 16, v176
v_lshlrev_b32 v177, 16, v177
v_lshlrev_b32 v178, 16, v178
v_lshlrev_b32 v179, 16, v179
v_lshlrev_b32 v180, 16, v180
v_lshlrev_b32 v181, 16, v181
v_lshlrev_b32 v182, 16, v182
v_lshlrev_b32 v183, 16, v183
v_lshlrev_b32 v184, 16, v184
v_lshlrev_b32 v185, 16, v185
v_lshlrev_b32 v186, 16, v186
v_lshlrev_b32 v187, 16, v187
v_lshlrev_b32 v188, 16, v188
v_lshlrev_b32 v189, 16, v189
v_lshlrev_b32 v190, 16, v190
v_lshlrev_b32 v191, 16, v191
v_lshlrev_b32 v192, 16, v192
v_lshlrev_b32 v193, 16, v193
v_lshlrev_b32 v194, 16, v194
v_lshlrev_b32 v195, 16, v195
v_lshlrev_b32 v196, 16, v196
v_lshlrev_b32 v197, 16, v197
v_lshlrev_b32 v198, 16, v198
v_lshlrev_b32 v199, 16, v199
v_lshlrev_b32 v200, 16, v200
v_lshlrev_b32 v201, 16, v201
v_lshlrev_b32 v202, 16, v202
v_lshlrev_b32 v203, 16, v203
v_lshlrev_b32 v204, 16, v204
v_lshlrev_b32 v205, 16, v205
v_lshlrev_b32 v206, 16, v206
v_lshlrev_b32 v207, 16, v207
v_add_f32 v230, v168, v176
v_add_f32 v230, v184, v230
v_add_f32 v231, v169, v177
v_add_f32 v231, v185, v231
v_cvt_pk_bf16_f32 v208, v230, v231
v_sub_f32 v230, v176, v168
v_sub_f32 v230, v230, v184
v_sub_f32 v231, v177, v169
v_sub_f32 v231, v231, v185
v_cvt_pk_bf16_f32 v212, v230, v231
v_add_f32 v230, v192, v200
v_add_f32 v231, v193, v201
v_cvt_pk_bf16_f32 v216, v230, v231
v_sub_f32 v230, v192, v200
v_sub_f32 v231, v193, v201
v_cvt_pk_bf16_f32 v220, v230, v231
v_cvt_pk_bf16_f32 v224, v168, v169
v_add_f32 v230, v170, v178
v_add_f32 v230, v186, v230
v_add_f32 v231, v171, v179
v_add_f32 v231, v187, v231
v_cvt_pk_bf16_f32 v209, v230, v231
v_sub_f32 v230, v178, v170
v_sub_f32 v230, v230, v186
v_sub_f32 v231, v179, v171
v_sub_f32 v231, v231, v187
v_cvt_pk_bf16_f32 v213, v230, v231
v_add_f32 v230, v194, v202
v_add_f32 v231, v195, v203
v_cvt_pk_bf16_f32 v217, v230, v231
v_sub_f32 v230, v194, v202
v_sub_f32 v231, v195, v203
v_cvt_pk_bf16_f32 v221, v230, v231
v_cvt_pk_bf16_f32 v225, v170, v171
v_add_f32 v230, v172, v180
v_add_f32 v230, v188, v230
v_add_f32 v231, v173, v181
v_add_f32 v231, v189, v231
v_cvt_pk_bf16_f32 v210, v230, v231
v_sub_f32 v230, v180, v172
v_sub_f32 v230, v230, v188
v_sub_f32 v231, v181, v173
v_sub_f32 v231, v231, v189
v_cvt_pk_bf16_f32 v214, v230, v231
v_add_f32 v230, v196, v204
v_add_f32 v231, v197, v205
v_cvt_pk_bf16_f32 v218, v230, v231
v_sub_f32 v230, v196, v204
v_sub_f32 v231, v197, v205
v_cvt_pk_bf16_f32 v222, v230, v231
v_cvt_pk_bf16_f32 v226, v172, v173
v_add_f32 v230, v174, v182
v_add_f32 v230, v190, v230
v_add_f32 v231, v175, v183
v_add_f32 v231, v191, v231
v_cvt_pk_bf16_f32 v211, v230, v231
v_sub_f32 v230, v182, v174
v_sub_f32 v230, v230, v190
v_sub_f32 v231, v183, v175
v_sub_f32 v231, v231, v191
v_cvt_pk_bf16_f32 v215, v230, v231
v_add_f32 v230, v198, v206
v_add_f32 v231, v199, v207
v_cvt_pk_bf16_f32 v219, v230, v231
v_sub_f32 v230, v198, v206
v_sub_f32 v231, v199, v207
v_cvt_pk_bf16_f32 v223, v230, v231
v_cvt_pk_bf16_f32 v227, v174, v175
s_lshl_b32 s55, s53, 14
s_lshl_b32 s56, s54, 10
s_add_u32 s55, s55, s56
s_add_u32 s57, s55, 8192
buffer_store_dwordx4 v[208:211], v9, s[16:19], s57 offen sc1
s_add_u32 s57, s55, 0
buffer_store_dwordx4 v[212:215], v9, s[16:19], s57 offen sc1
s_add_u32 s57, s55, 12288
buffer_store_dwordx4 v[216:219], v9, s[16:19], s57 offen sc1
s_add_u32 s57, s55, 4096
buffer_store_dwordx4 v[220:223], v9, s[16:19], s57 offen sc1
s_lshl_b32 s57, s53, 12
s_add_u32 s57, s57, s56
s_add_u32 s57, s57, 131072
buffer_store_dwordx4 v[224:227], v9, s[16:19], s57 offen sc1
s_waitcnt vmcnt(0)
s_add_u32 s52, s52, 1
s_cmp_lt_u32 s52, 32
s_cbranch_scc1 L_fb
s_branch L_back
L_end:
s_endpgm

.section .rodata,"a"
.p2align 6
.amdhsa_kernel standalone__autoregressive_conv_wavernn__speech_kernel
  .amdhsa_next_free_vgpr 512
  .amdhsa_next_free_sgpr 102
  .amdhsa_accum_offset 256
  .amdhsa_group_segment_fixed_size 0
  .amdhsa_float_denorm_mode_32 3
  .amdhsa_kernarg_size 40
  .amdhsa_user_sgpr_count 2
  .amdhsa_user_sgpr_kernarg_segment_ptr 1
  .amdhsa_system_sgpr_workgroup_id_x 1
.end_amdhsa_kernel
```
